```python
import torch

def _softmax(x, axis=-1):
    return torch.softmax(x, dim=axis)

def _gelu(x):
    return torch.nn.functional.gelu(x, approximate='tanh')

def _silu(x):
    return torch.nn.functional.silu(x)

def _sigmoid(x):
    return torch.sigmoid(x)

def _layernorm(x, axis=-1, eps=1e-05):
    m = x.mean(dim=axis, keepdim=True)
    v = x.var(dim=axis, keepdim=True, unbiased=False)
    return (x - m) / torch.sqrt(v + eps)

def _scatter_add(tgt, idx, src, axis=0):
    return tgt.clone().index_add_(axis, idx, src)

def _segment_sum(src, seg, n):
    out = torch.zeros((n,) + src.shape[1:], dtype=src.dtype)
    return out.index_add_(0, seg, src)

def _pad(x, pw):
    flat = tuple((v for pair in reversed(pw) for v in pair))
    return torch.nn.functional.pad(x, flat)
kernel_name = 'gated_mix__memory_aug_recurrent_mem_tr__sliding_local_dilated__prompt'

def setup_inputs():

    _w = lambda a: (lambda t: t.to(torch.bfloat16) if t.is_floating_point() else t)(torch.as_tensor(a))

    def _A_setup():
        B, S, Dm = (1, 2048, 512)
        H, Dh = (32, 128)
        M, seg = (8, 32)
        seg = min(seg, S)
        S = S // seg * seg
        return {'x': _w((lambda *s: torch.randn(*s, dtype=torch.bfloat16) * 0.05)(B, S, Dm)), 'mem0': _w((lambda *s: torch.randn(*s, dtype=torch.bfloat16) * 1.6)(B, M, Dm)), 'Wq': _w((lambda *s: torch.randn(*s, dtype=torch.bfloat16) * 0.8)(Dm, H, Dh) * Dm ** (-0.5)), 'Wk': _w((lambda *s: torch.randn(*s, dtype=torch.bfloat16) * 0.8)(Dm, H, Dh) * Dm ** (-0.5)), 'Wv': _w((lambda *s: torch.randn(*s, dtype=torch.bfloat16) * 1.6)(Dm, H, Dh) * Dm ** (-0.5)), 'Wo': _w((lambda *s: torch.randn(*s, dtype=torch.bfloat16) * 1.6)(H, Dh, Dm) * (H * Dh) ** (-0.5)), 'seg_len': seg}
    _A_in = _A_setup()

    def _B_setup():
        B, S, D = (1, 2048, 512)
        return {'x': _w((lambda *s: torch.randn(*s, dtype=torch.bfloat16) * 0.05)(B, S, D)), 'wqkv': _w((lambda *s: torch.randn(*s, dtype=torch.bfloat16) * 0.8)(D, 3 * D)), 'wo': _w((lambda *s: torch.randn(*s, dtype=torch.bfloat16) * 0.05)(D, D))}
    _B_in = _B_setup()
    return {'A_x': _A_in['x'], 'A_mem0': _A_in['mem0'], 'A_Wq': _A_in['Wq'], 'A_Wk': _A_in['Wk'], 'A_Wv': _A_in['Wv'], 'A_Wo': _A_in['Wo'], 'A_seg_len': _A_in['seg_len'], 'B_x': _B_in['x'], 'B_wqkv': _B_in['wqkv'], 'B_wo': _B_in['wo'], 'gate_w': _w((lambda *s: torch.randn(*s, dtype=torch.bfloat16) * 0.05)(512) * 16.0)}

def reference(A_x, A_mem0, A_Wq, A_Wk, A_Wv, A_Wo, A_seg_len, B_x, B_wqkv, B_wo, gate_w):

    def _A_ref(x, mem0, Wq, Wk, Wv, Wo, seg_len):
        B, S, Dm = x.shape
        H, Dh = (Wq.shape[1], Wq.shape[2])
        M = mem0.shape[1]
        scale = Dh ** (-0.5)
        n_seg = S // seg_len
        L = M + seg_len
        idx = torch.arange(L)
        mask = (idx[:, None] < M) | (idx[:, None] >= idx[None, :])
        mem = mem0
        outs = []
        for s in range(n_seg):
            xs = x[:, s * seg_len:(s + 1) * seg_len, :].clone()
            h = torch.concatenate([mem, xs], axis=1)
            q = torch.einsum('btd,dhe->bhte', h, Wq)
            k = torch.einsum('btd,dhe->bhte', h, Wk)
            v = torch.einsum('btd,dhe->bhte', h, Wv)
            scores = torch.einsum('bhqe,bhke->bhqk', q, k) * scale
            scores = torch.where(mask[None, None], scores, -1000000000.0)
            p = _softmax(scores, axis=-1)
            o = torch.einsum('bhqk,bhke->bhqe', p, v)
            o = torch.einsum('bhte,hed->btd', o, Wo)
            mem = o[:, :M, :].clone()
            outs.append(o[:, M:, :])
        return torch.concatenate(outs, axis=1)

    def _B_ref(x, wqkv, wo):
        B, S, D = x.shape
        H = 32
        Dh = D // H
        W, dil = (8, 2)
        qkv = (lambda x, *d: x.permute(*d))((x @ wqkv).reshape(B, S, 3, H, Dh), 2, 0, 3, 1, 4)
        q, k, v = (qkv[0], qkv[1], qkv[2])
        scale = Dh ** (-0.5)
        pos = torch.arange(S)
        off = torch.arange(W) * dil
        idx = pos[:, None] - off[None, :]
        mask = idx >= 0
        idx_c = torch.where(mask, idx, 0).reshape(-1)
        kg = k[:, :, idx_c, :].reshape(B, H, S, W, Dh)
        vg = v[:, :, idx_c, :].reshape(B, H, S, W, Dh)
        logits = torch.einsum('bhsd,bhswd->bhsw', q, kg) * scale
        logits = torch.where(mask[None, None, :, :], logits, -1000000000.0)
        attn = _softmax(logits, axis=-1)
        o = torch.einsum('bhsw,bhswd->bhsd', attn, vg)
        return (lambda x, *d: x.permute(*d))(o, 0, 2, 1, 3).reshape(B, S, D) @ wo
    x = A_x
    g = _sigmoid((x * gate_w).sum(-1, keepdims=True))
    a = _A_ref(x, A_mem0, A_Wq, A_Wk, A_Wv, A_Wo, A_seg_len)
    b = _B_ref(x, B_wqkv, B_wo)
    return g * a + (1 - g) * b
```

```asm
; @launch grid=(256,1,1) block=(256,1,1) lds=163840
.amdgcn_target "amdgcn-amd-amdhsa--gfx950"
.text
.p2align 8
.globl gated_mix__memory_aug_recurrent_mem_tr__sliding_local_dilated__prompt_kernel
.type gated_mix__memory_aug_recurrent_mem_tr__sliding_local_dilated__prompt_kernel,@function
gated_mix__memory_aug_recurrent_mem_tr__sliding_local_dilated__prompt_kernel:
    s_cmp_ge_u32 s2, 256
    s_cbranch_scc1 CH_EXIT
    s_load_dwordx4 s[4:7], s[0:1], 16
    s_load_dwordx4 s[8:11], s[0:1], 32
    s_load_dwordx2 s[12:13], s[0:1], 8
    s_load_dwordx2 s[14:15], s[0:1], 96
    s_load_dwordx2 s[16:17], s[0:1], 104
    s_load_dwordx2 s[74:75], s[0:1], 0
    s_load_dwordx4 s[76:79], s[0:1], 64
    s_load_dwordx4 s[80:83], s[0:1], 80
    s_getreg_b32 s20, hwreg(HW_REG_XCC_ID)
    s_and_b32 s20, s20, 15
    v_lshrrev_b32 v1, 6, v0
    v_lshlrev_b32 v121, 6, v0
    v_readfirstlane_b32 s22, v1
    s_mov_b32 s90, 1
    s_mov_b32 s67, 0
    s_cmp_eq_u32 s20, 3
    s_cbranch_scc0 WORK
TAKE:
    s_getpc_b64 s[18:19]
CH_PC:
    s_add_u32 s18, s18, CH_TABLE-CH_PC
    s_addc_u32 s19, s19, 0
    v_mul_u32_u24 v127, 80, v0
    global_load_dwordx4 v[0:3], v127, s[18:19] offset:0
    global_load_dwordx4 v[4:7], v127, s[18:19] offset:16
    global_load_dwordx4 v[8:11], v127, s[18:19] offset:32
    global_load_dwordx4 v[12:15], v127, s[18:19] offset:48
    global_load_dwordx4 v[16:19], v127, s[18:19] offset:64
    s_getpc_b64 s[52:53]
PT_PC:
    s_add_u32 s52, s52, CHAIN-PT_PC
    s_addc_u32 s53, s53, 0
    global_load_dword v120, v121, s[52:53]
    s_waitcnt lgkmcnt(0)
    v_mov_b32 v122, 192
    v_mov_b32 v123, 1
    v_mov_b32 v125, 162816
    s_cmp_eq_u32 s22, 0
    s_cselect_b64 exec, 1, 0
    global_atomic_add v124, v122, v123, s[14:15] sc0
    s_mov_b64 exec, -1
    s_cmp_lg_u32 s22, 0
    s_cbranch_scc1 TK3
    s_mov_b64 exec, 1
    s_waitcnt vmcnt(0)
    ds_write_b32 v125, v124
    s_cmp_eq_u32 s67, 0
    s_cbranch_scc1 TK4
    v_mov_b32 v122, 196
    global_atomic_or v122, v123, s[14:15]
    s_waitcnt vmcnt(0)
TK4:
    s_mov_b64 exec, -1
    s_waitcnt lgkmcnt(0)
TK3:
    s_barrier
    ds_read_b32 v124, v125
    s_waitcnt lgkmcnt(0)
    v_readfirstlane_b32 s21, v124
    s_barrier
    s_cmp_ge_u32 s21, 32
    s_cbranch_scc0 CHAIN
    s_waitcnt vmcnt(0)
    s_cmp_eq_u32 s67, 0
    s_cbranch_scc0 STAFFED
WORK:
    s_waitcnt lgkmcnt(0)
    s_add_u32 s2, s16, 1835008
    s_addc_u32 s3, s17, 0
    s_mov_b32 s90, 1
    s_lshl_b32 s51, 1, s20
    s_and_b32 s51, s51, 4
    s_cbranch_scc0 shy_1
    v_mov_b32 v4, 128
    s_mov_b32 s25, 0
    s_cmp_lg_u32 s22, 0
    s_cbranch_scc1 wd_3
wt_2:
    global_load_dword v5, v4, s[14:15] sc1
    s_add_u32 s25, s25, 1
    s_cmp_gt_u32 s25, 24
    s_cbranch_scc1 wd_3
    s_waitcnt vmcnt(0)
    v_readfirstlane_b32 s51, v5
    s_nop 1
    s_cmp_ge_u32 s51, 192
    s_cbranch_scc1 wd_3
    s_sleep 4
    s_branch wt_2
wd_3:
    s_barrier
    s_waitcnt vmcnt(0)
shy_1:
    v_mov_b32 v4, 128
    v_mov_b32 v5, 1
    v_mov_b32 v6, 162816
    s_cmp_lg_u32 s22, 0
    s_cbranch_scc1 tk_4
    s_mov_b64 exec, 1
    global_atomic_add v7, v4, v5, s[14:15] sc0
    s_waitcnt vmcnt(0)
    ds_write_b32 v6, v7
    s_mov_b64 exec, -1
    s_waitcnt lgkmcnt(0)
tk_4:
    s_barrier
    ds_read_b32 v7, v6
    s_waitcnt lgkmcnt(0)
    v_readfirstlane_b32 s26, v7
    s_barrier
    s_cmp_lt_u32 s26, 192
    s_cselect_b32 s90, 1, 0
    s_cbranch_scc1 PH1
    s_branch PH1_END
PH1:
    v_mov_b32 v4, 16
    v_mov_b32 v5, 1
    v_mov_b32 v6, 162816
    s_cmp_lg_u32 s22, 0
    s_cbranch_scc1 tk_5
    s_mov_b64 exec, 1
    global_atomic_add v7, v4, v5, s[14:15] sc0
    s_waitcnt vmcnt(0)
    ds_write_b32 v6, v7
    s_mov_b64 exec, -1
    s_waitcnt lgkmcnt(0)
tk_5:
    s_barrier
    ds_read_b32 v7, v6
    s_waitcnt lgkmcnt(0)
    v_readfirstlane_b32 s26, v7
    s_barrier
    s_cmp_ge_u32 s26, 160
    s_cbranch_scc1 PH1_NONE
    s_cmp_lg_u32 s26, 0
    s_cbranch_scc1 PH1_NOINIT
    v_mbcnt_lo_u32_b32 v1, -1, 0
    v_mbcnt_hi_u32_b32 v1, -1, v1
    v_lshlrev_b32 v1, 4, v1
    s_mul_i32 s51, s22, 5120
    v_add_u32 v1, s51, v1
    v_add_u32 v2, 4096, v1
    v_mov_b32 v8, 0
    v_mov_b32 v9, 0
    v_mov_b32 v10, 0
    v_mov_b32 v11, 0
    global_store_dwordx4 v1, v[8:11], s[2:3] offset:0 sc1
    global_store_dwordx4 v1, v[8:11], s[2:3] offset:1024 sc1
    global_store_dwordx4 v1, v[8:11], s[2:3] offset:2048 sc1
    global_store_dwordx4 v1, v[8:11], s[2:3] offset:3072 sc1
    global_store_dwordx4 v2, v[8:11], s[2:3] sc1
    s_waitcnt vmcnt(0)
    s_barrier
    v_mov_b32 v4, 12
    v_mov_b32 v5, 1
    s_cmp_eq_u32 s22, 0
    s_cselect_b64 exec, 1, 0
    global_atomic_add v4, v5, s[14:15]
    s_mov_b64 exec, -1
    v_mov_b32 v4, 196
    v_mov_b32 v5, 256
    s_cmp_eq_u32 s22, 0
    s_cselect_b64 exec, 1, 0
    global_atomic_or v4, v5, s[14:15]
    s_mov_b64 exec, -1
PH1_NOINIT:
    s_cmp_ge_u32 s26, 152
    s_cbranch_scc1 PH1_GATE
    s_lshr_b32 s51, s26, 0
    s_and_b32 s52, s51, 31
    s_lshl_b32 s52, s52, 7
    s_lshr_b32 s51, s51, 5
    s_lshl_b32 s53, s51, 3
    s_add_u32 s52, s52, s53
    s_and_b32 s53, s26, 0
    s_lshl_b32 s53, s53, 2
    s_add_u32 s52, s52, s53
    v_mov_b32 v26, s52
    s_cmp_lt_u32 s51, 2
    s_cselect_b32 s86, 1, 0
    s_cmp_eq_u32 s22, 0
    s_cselect_b32 s86, s86, 0
    s_mov_b32 s87, 0
    s_mov_b32 s88, 0
    s_mov_b32 s89, 0
    s_sub_u32 s51, s26, 64
    s_lshr_b32 s27, s51, 1
    s_add_u32 s27, s27, 64
    s_and_b32 s30, s51, 1
    s_lshr_b32 s52, s26, 0
    s_and_b32 s53, s26, 0
    s_cmp_lt_u32 s26, 64
    s_cselect_b32 s27, s52, s27
    s_cselect_b32 s30, s53, s30
    s_cselect_b32 s46, 0, 1
    s_lshr_b32 s35, 64, s46
    s_lshl_b32 s43, 32768, s46
    s_and_b32 s51, s27, 31
    s_lshr_b32 s52, s27, 5
    s_mov_b32 s28, 8192
    s_mov_b32 s62, 4194304
    s_mov_b32 s63, 0x20000
    s_mov_b32 s29, 0
    s_mov_b32 s31, 262144
    s_mov_b32 s32, 4096
    s_lshl_b32 s53, s51, 13
    s_lshl_b32 s54, s22, 10
    s_cmp_eq_u32 s52, 1
    s_cbranch_scc1 W1_v
    s_cmp_eq_u32 s52, 2
    s_cbranch_scc1 W1_q
    s_cmp_eq_u32 s52, 3
    s_cbranch_scc1 W1_b
    s_mov_b32 s60, s6
    s_and_b32 s61, s7, 0xffff
    s_add_u32 s53, s53, 2097152
    s_branch W1_dec
W1_v:
    s_mov_b32 s60, s8
    s_and_b32 s61, s9, 0xffff
    s_add_u32 s53, s53, 18874368
    s_mov_b32 s29, 1
    s_lshl_b32 s54, s54, 1
    s_mov_b32 s32, 1024
    s_branch W1_dec
W1_q:
    s_mov_b32 s60, s4
    s_and_b32 s61, s5, 0xffff
    s_add_u32 s53, s53, 35651584
    s_branch W1_dec
W1_b:
    s_mov_b32 s60, s76
    s_and_b32 s61, s77, 0xffff
    s_mov_b32 s62, 1572864
    s_mov_b32 s28, 3072
    s_lshl_b32 s53, s51, 12
    s_add_u32 s53, s53, 80805888
    s_mov_b32 s31, 98304
    s_mov_b32 s32, 49152
W1_dec:
    s_add_u32 s53, s53, s54
    s_mul_i32 s54, s31, s30
    s_add_u32 s53, s53, s54
    s_lshl_b32 s31, s31, s46
    s_add_u32 s44, s16, s53
    s_addc_u32 s45, s17, 0
    s_add_u32 s36, s16, 87105536
    s_addc_u32 s37, s17, 0
    v_mbcnt_lo_u32_b32 v1, -1, 0
    v_mbcnt_hi_u32_b32 v1, -1, v1
    v_and_b32 v2, 15, v1
    v_lshrrev_b32 v3, 4, v1
    v_lshlrev_b32 v4, 4, v1
    v_add_u32 v9, s32, v4
    v_lshlrev_b32 v5, 3, v3
    v_mul_lo_u32 v5, v5, s28
    v_lshlrev_b32 v22, 4, v2
    v_add_u32 v5, v5, v22
    s_lshl_b32 s51, s51, 8
    v_add_u32 v5, s51, v5
    v_mov_b32 v7, 0x05040100
    v_mov_b32 v8, 0x07060302
    s_lshl_b32 s51, s22, 7
    s_mul_i32 s51, s51, s28
    buffer_load_dwordx4 v[32:35], v5, s[60:63], s51 offen
    s_add_u32 s51, s51, s28
    buffer_load_dwordx4 v[36:39], v5, s[60:63], s51 offen
    s_add_u32 s51, s51, s28
    buffer_load_dwordx4 v[40:43], v5, s[60:63], s51 offen
    s_add_u32 s51, s51, s28
    buffer_load_dwordx4 v[44:47], v5, s[60:63], s51 offen
    s_add_u32 s51, s51, s28
    buffer_load_dwordx4 v[48:51], v5, s[60:63], s51 offen
    s_add_u32 s51, s51, s28
    buffer_load_dwordx4 v[52:55], v5, s[60:63], s51 offen
    s_add_u32 s51, s51, s28
    buffer_load_dwordx4 v[56:59], v5, s[60:63], s51 offen
    s_add_u32 s51, s51, s28
    buffer_load_dwordx4 v[60:63], v5, s[60:63], s51 offen
    s_add_u32 s51, s51, s28
    s_mul_i32 s52, s28, 24
    s_add_u32 s51, s51, s52
    buffer_load_dwordx4 v[64:67], v5, s[60:63], s51 offen
    s_add_u32 s51, s51, s28
    buffer_load_dwordx4 v[68:71], v5, s[60:63], s51 offen
    s_add_u32 s51, s51, s28
    buffer_load_dwordx4 v[72:75], v5, s[60:63], s51 offen
    s_add_u32 s51, s51, s28
    buffer_load_dwordx4 v[76:79], v5, s[60:63], s51 offen
    s_add_u32 s51, s51, s28
    buffer_load_dwordx4 v[80:83], v5, s[60:63], s51 offen
    s_add_u32 s51, s51, s28
    buffer_load_dwordx4 v[84:87], v5, s[60:63], s51 offen
    s_add_u32 s51, s51, s28
    buffer_load_dwordx4 v[88:91], v5, s[60:63], s51 offen
    s_add_u32 s51, s51, s28
    buffer_load_dwordx4 v[92:95], v5, s[60:63], s51 offen
    s_add_u32 s51, s51, s28
    s_mul_i32 s52, s28, 24
    s_add_u32 s51, s51, s52
    buffer_load_dwordx4 v[96:99], v5, s[60:63], s51 offen
    s_add_u32 s51, s51, s28
    buffer_load_dwordx4 v[100:103], v5, s[60:63], s51 offen
    s_add_u32 s51, s51, s28
    buffer_load_dwordx4 v[104:107], v5, s[60:63], s51 offen
    s_add_u32 s51, s51, s28
    buffer_load_dwordx4 v[108:111], v5, s[60:63], s51 offen
    s_add_u32 s51, s51, s28
    buffer_load_dwordx4 v[112:115], v5, s[60:63], s51 offen
    s_add_u32 s51, s51, s28
    buffer_load_dwordx4 v[116:119], v5, s[60:63], s51 offen
    s_add_u32 s51, s51, s28
    buffer_load_dwordx4 v[120:123], v5, s[60:63], s51 offen
    s_add_u32 s51, s51, s28
    buffer_load_dwordx4 v[124:127], v5, s[60:63], s51 offen
    s_add_u32 s51, s51, s28
    s_mul_i32 s52, s28, 24
    s_add_u32 s51, s51, s52
    buffer_load_dwordx4 v[128:131], v5, s[60:63], s51 offen
    s_add_u32 s51, s51, s28
    buffer_load_dwordx4 v[132:135], v5, s[60:63], s51 offen
    s_add_u32 s51, s51, s28
    buffer_load_dwordx4 v[136:139], v5, s[60:63], s51 offen
    s_add_u32 s51, s51, s28
    buffer_load_dwordx4 v[140:143], v5, s[60:63], s51 offen
    s_add_u32 s51, s51, s28
    buffer_load_dwordx4 v[144:147], v5, s[60:63], s51 offen
    s_add_u32 s51, s51, s28
    buffer_load_dwordx4 v[148:151], v5, s[60:63], s51 offen
    s_add_u32 s51, s51, s28
    buffer_load_dwordx4 v[152:155], v5, s[60:63], s51 offen
    s_add_u32 s51, s51, s28
    buffer_load_dwordx4 v[156:159], v5, s[60:63], s51 offen
    s_add_u32 s51, s51, s28
    s_lshl_b32 s51, s22, 12
    v_lshrrev_b32 v22, 2, v2
    v_mul_u32_u24 v22, 32784, v22
    v_and_b32 v23, 3, v2
    v_lshlrev_b32 v23, 6, v23
    v_lshlrev_b32 v24, 8, v3
    v_add3_u32 v22, v22, v23, v24
    s_cmp_eq_u32 s29, 1
    s_cselect_b64 vcc, -1, 0
    v_cndmask_b32 v6, v22, v4, vcc
    v_add_u32 v6, s51, v6
    v_add_u32 v25, 65536, v6
    s_and_b32 s52, s22, 1
    s_lshl_b32 s52, s52, 7
    s_add_u32 s52, s52, 0
    v_xor_b32 v10, s52, v4
    s_and_b32 s52, s22, 1
    s_lshl_b32 s52, s52, 7
    s_add_u32 s52, s52, 16
    v_xor_b32 v11, s52, v4
    s_and_b32 s52, s22, 1
    s_lshl_b32 s52, s52, 7
    s_add_u32 s52, s52, 32
    v_xor_b32 v12, s52, v4
    s_and_b32 s52, s22, 1
    s_lshl_b32 s52, s52, 7
    s_add_u32 s52, s52, 48
    v_xor_b32 v13, s52, v4
    s_and_b32 s52, s22, 1
    s_lshl_b32 s52, s52, 7
    s_add_u32 s52, s52, 64
    v_xor_b32 v14, s52, v4
    s_and_b32 s52, s22, 1
    s_lshl_b32 s52, s52, 7
    s_add_u32 s52, s52, 80
    v_xor_b32 v15, s52, v4
    s_and_b32 s52, s22, 1
    s_lshl_b32 s52, s52, 7
    s_add_u32 s52, s52, 96
    v_xor_b32 v16, s52, v4
    s_and_b32 s52, s22, 1
    s_lshl_b32 s52, s52, 7
    s_add_u32 s52, s52, 112
    v_xor_b32 v17, s52, v4
    v_add_u32 v22, 0, v3
    v_xor_b32 v22, v22, v2
    v_lshlrev_b32 v22, 4, v22
    v_lshl_add_u32 v18, v2, 10, v22
    v_add_u32 v22, 4, v3
    v_xor_b32 v22, v22, v2
    v_lshlrev_b32 v22, 4, v22
    v_lshl_add_u32 v19, v2, 10, v22
    v_add_u32 v22, 8, v3
    v_xor_b32 v22, v22, v2
    v_lshlrev_b32 v22, 4, v22
    v_lshl_add_u32 v20, v2, 10, v22
    v_add_u32 v22, 12, v3
    v_xor_b32 v22, v22, v2
    v_lshlrev_b32 v22, 4, v22
    v_lshl_add_u32 v21, v2, 10, v22
    s_cmp_eq_u32 s29, 1
    s_cbranch_scc1 W1_pN
    s_waitcnt vmcnt(24)
    v_perm_b32 v160, v36, v32, v7
    v_perm_b32 v161, v44, v40, v7
    v_perm_b32 v162, v52, v48, v7
    v_perm_b32 v163, v60, v56, v7
    ds_write_b128 v6, v[160:163] offset:0
    v_perm_b32 v164, v36, v32, v8
    v_perm_b32 v165, v44, v40, v8
    v_perm_b32 v166, v52, v48, v8
    v_perm_b32 v167, v60, v56, v8
    ds_write_b128 v6, v[164:167] offset:16
    v_perm_b32 v168, v37, v33, v7
    v_perm_b32 v169, v45, v41, v7
    v_perm_b32 v170, v53, v49, v7
    v_perm_b32 v171, v61, v57, v7
    ds_write_b128 v6, v[168:171] offset:32
    v_perm_b32 v172, v37, v33, v8
    v_perm_b32 v173, v45, v41, v8
    v_perm_b32 v174, v53, v49, v8
    v_perm_b32 v175, v61, v57, v8
    ds_write_b128 v6, v[172:175] offset:48
    v_perm_b32 v160, v38, v34, v7
    v_perm_b32 v161, v46, v42, v7
    v_perm_b32 v162, v54, v50, v7
    v_perm_b32 v163, v62, v58, v7
    ds_write_b128 v6, v[160:163] offset:16384
    v_perm_b32 v164, v38, v34, v8
    v_perm_b32 v165, v46, v42, v8
    v_perm_b32 v166, v54, v50, v8
    v_perm_b32 v167, v62, v58, v8
    ds_write_b128 v6, v[164:167] offset:16400
    v_perm_b32 v168, v39, v35, v7
    v_perm_b32 v169, v47, v43, v7
    v_perm_b32 v170, v55, v51, v7
    v_perm_b32 v171, v63, v59, v7
    ds_write_b128 v6, v[168:171] offset:16416
    v_perm_b32 v172, v39, v35, v8
    v_perm_b32 v173, v47, v43, v8
    v_perm_b32 v174, v55, v51, v8
    v_perm_b32 v175, v63, v59, v8
    ds_write_b128 v6, v[172:175] offset:16432
    s_waitcnt vmcnt(16)
    v_perm_b32 v160, v68, v64, v7
    v_perm_b32 v161, v76, v72, v7
    v_perm_b32 v162, v84, v80, v7
    v_perm_b32 v163, v92, v88, v7
    ds_write_b128 v6, v[160:163] offset:1024
    v_perm_b32 v164, v68, v64, v8
    v_perm_b32 v165, v76, v72, v8
    v_perm_b32 v166, v84, v80, v8
    v_perm_b32 v167, v92, v88, v8
    ds_write_b128 v6, v[164:167] offset:1040
    v_perm_b32 v168, v69, v65, v7
    v_perm_b32 v169, v77, v73, v7
    v_perm_b32 v170, v85, v81, v7
    v_perm_b32 v171, v93, v89, v7
    ds_write_b128 v6, v[168:171] offset:1056
    v_perm_b32 v172, v69, v65, v8
    v_perm_b32 v173, v77, v73, v8
    v_perm_b32 v174, v85, v81, v8
    v_perm_b32 v175, v93, v89, v8
    ds_write_b128 v6, v[172:175] offset:1072
    v_perm_b32 v160, v70, v66, v7
    v_perm_b32 v161, v78, v74, v7
    v_perm_b32 v162, v86, v82, v7
    v_perm_b32 v163, v94, v90, v7
    ds_write_b128 v6, v[160:163] offset:17408
    v_perm_b32 v164, v70, v66, v8
    v_perm_b32 v165, v78, v74, v8
    v_perm_b32 v166, v86, v82, v8
    v_perm_b32 v167, v94, v90, v8
    ds_write_b128 v6, v[164:167] offset:17424
    v_perm_b32 v168, v71, v67, v7
    v_perm_b32 v169, v79, v75, v7
    v_perm_b32 v170, v87, v83, v7
    v_perm_b32 v171, v95, v91, v7
    ds_write_b128 v6, v[168:171] offset:17440
    v_perm_b32 v172, v71, v67, v8
    v_perm_b32 v173, v79, v75, v8
    v_perm_b32 v174, v87, v83, v8
    v_perm_b32 v175, v95, v91, v8
    ds_write_b128 v6, v[172:175] offset:17456
    s_waitcnt vmcnt(8)
    v_perm_b32 v160, v100, v96, v7
    v_perm_b32 v161, v108, v104, v7
    v_perm_b32 v162, v116, v112, v7
    v_perm_b32 v163, v124, v120, v7
    ds_write_b128 v6, v[160:163] offset:2048
    v_perm_b32 v164, v100, v96, v8
    v_perm_b32 v165, v108, v104, v8
    v_perm_b32 v166, v116, v112, v8
    v_perm_b32 v167, v124, v120, v8
    ds_write_b128 v6, v[164:167] offset:2064
    v_perm_b32 v168, v101, v97, v7
    v_perm_b32 v169, v109, v105, v7
    v_perm_b32 v170, v117, v113, v7
    v_perm_b32 v171, v125, v121, v7
    ds_write_b128 v6, v[168:171] offset:2080
    v_perm_b32 v172, v101, v97, v8
    v_perm_b32 v173, v109, v105, v8
    v_perm_b32 v174, v117, v113, v8
    v_perm_b32 v175, v125, v121, v8
    ds_write_b128 v6, v[172:175] offset:2096
    v_perm_b32 v160, v102, v98, v7
    v_perm_b32 v161, v110, v106, v7
    v_perm_b32 v162, v118, v114, v7
    v_perm_b32 v163, v126, v122, v7
    ds_write_b128 v6, v[160:163] offset:18432
    v_perm_b32 v164, v102, v98, v8
    v_perm_b32 v165, v110, v106, v8
    v_perm_b32 v166, v118, v114, v8
    v_perm_b32 v167, v126, v122, v8
    ds_write_b128 v6, v[164:167] offset:18448
    v_perm_b32 v168, v103, v99, v7
    v_perm_b32 v169, v111, v107, v7
    v_perm_b32 v170, v119, v115, v7
    v_perm_b32 v171, v127, v123, v7
    ds_write_b128 v6, v[168:171] offset:18464
    v_perm_b32 v172, v103, v99, v8
    v_perm_b32 v173, v111, v107, v8
    v_perm_b32 v174, v119, v115, v8
    v_perm_b32 v175, v127, v123, v8
    ds_write_b128 v6, v[172:175] offset:18480
    s_waitcnt vmcnt(0)
    v_perm_b32 v160, v132, v128, v7
    v_perm_b32 v161, v140, v136, v7
    v_perm_b32 v162, v148, v144, v7
    v_perm_b32 v163, v156, v152, v7
    ds_write_b128 v6, v[160:163] offset:3072
    v_perm_b32 v164, v132, v128, v8
    v_perm_b32 v165, v140, v136, v8
    v_perm_b32 v166, v148, v144, v8
    v_perm_b32 v167, v156, v152, v8
    ds_write_b128 v6, v[164:167] offset:3088
    v_perm_b32 v168, v133, v129, v7
    v_perm_b32 v169, v141, v137, v7
    v_perm_b32 v170, v149, v145, v7
    v_perm_b32 v171, v157, v153, v7
    ds_write_b128 v6, v[168:171] offset:3104
    v_perm_b32 v172, v133, v129, v8
    v_perm_b32 v173, v141, v137, v8
    v_perm_b32 v174, v149, v145, v8
    v_perm_b32 v175, v157, v153, v8
    ds_write_b128 v6, v[172:175] offset:3120
    v_perm_b32 v160, v134, v130, v7
    v_perm_b32 v161, v142, v138, v7
    v_perm_b32 v162, v150, v146, v7
    v_perm_b32 v163, v158, v154, v7
    ds_write_b128 v6, v[160:163] offset:19456
    v_perm_b32 v164, v134, v130, v8
    v_perm_b32 v165, v142, v138, v8
    v_perm_b32 v166, v150, v146, v8
    v_perm_b32 v167, v158, v154, v8
    ds_write_b128 v6, v[164:167] offset:19472
    v_perm_b32 v168, v135, v131, v7
    v_perm_b32 v169, v143, v139, v7
    v_perm_b32 v170, v151, v147, v7
    v_perm_b32 v171, v159, v155, v7
    ds_write_b128 v6, v[168:171] offset:19488
    v_perm_b32 v172, v135, v131, v8
    v_perm_b32 v173, v143, v139, v8
    v_perm_b32 v174, v151, v147, v8
    v_perm_b32 v175, v159, v155, v8
    ds_write_b128 v6, v[172:175] offset:19504
    s_branch W1_pJ
W1_pN:
    s_waitcnt vmcnt(24)
    v_perm_b32 v160, v36, v32, v7
    v_perm_b32 v161, v44, v40, v7
    v_perm_b32 v162, v52, v48, v7
    v_perm_b32 v163, v60, v56, v7
    ds_write_b128 v6, v[160:163] offset:0
    v_perm_b32 v164, v36, v32, v8
    v_perm_b32 v165, v44, v40, v8
    v_perm_b32 v166, v52, v48, v8
    v_perm_b32 v167, v60, v56, v8
    ds_write_b128 v6, v[164:167] offset:16384
    v_perm_b32 v168, v37, v33, v7
    v_perm_b32 v169, v45, v41, v7
    v_perm_b32 v170, v53, v49, v7
    v_perm_b32 v171, v61, v57, v7
    ds_write_b128 v6, v[168:171] offset:32768
    v_perm_b32 v172, v37, v33, v8
    v_perm_b32 v173, v45, v41, v8
    v_perm_b32 v174, v53, v49, v8
    v_perm_b32 v175, v61, v57, v8
    ds_write_b128 v6, v[172:175] offset:49152
    v_perm_b32 v160, v38, v34, v7
    v_perm_b32 v161, v46, v42, v7
    v_perm_b32 v162, v54, v50, v7
    v_perm_b32 v163, v62, v58, v7
    ds_write_b128 v25, v[160:163] offset:0
    v_perm_b32 v164, v38, v34, v8
    v_perm_b32 v165, v46, v42, v8
    v_perm_b32 v166, v54, v50, v8
    v_perm_b32 v167, v62, v58, v8
    ds_write_b128 v25, v[164:167] offset:16384
    v_perm_b32 v168, v39, v35, v7
    v_perm_b32 v169, v47, v43, v7
    v_perm_b32 v170, v55, v51, v7
    v_perm_b32 v171, v63, v59, v7
    ds_write_b128 v25, v[168:171] offset:32768
    v_perm_b32 v172, v39, v35, v8
    v_perm_b32 v173, v47, v43, v8
    v_perm_b32 v174, v55, v51, v8
    v_perm_b32 v175, v63, v59, v8
    ds_write_b128 v25, v[172:175] offset:49152
    s_waitcnt vmcnt(16)
    v_perm_b32 v160, v68, v64, v7
    v_perm_b32 v161, v76, v72, v7
    v_perm_b32 v162, v84, v80, v7
    v_perm_b32 v163, v92, v88, v7
    ds_write_b128 v6, v[160:163] offset:1024
    v_perm_b32 v164, v68, v64, v8
    v_perm_b32 v165, v76, v72, v8
    v_perm_b32 v166, v84, v80, v8
    v_perm_b32 v167, v92, v88, v8
    ds_write_b128 v6, v[164:167] offset:17408
    v_perm_b32 v168, v69, v65, v7
    v_perm_b32 v169, v77, v73, v7
    v_perm_b32 v170, v85, v81, v7
    v_perm_b32 v171, v93, v89, v7
    ds_write_b128 v6, v[168:171] offset:33792
    v_perm_b32 v172, v69, v65, v8
    v_perm_b32 v173, v77, v73, v8
    v_perm_b32 v174, v85, v81, v8
    v_perm_b32 v175, v93, v89, v8
    ds_write_b128 v6, v[172:175] offset:50176
    v_perm_b32 v160, v70, v66, v7
    v_perm_b32 v161, v78, v74, v7
    v_perm_b32 v162, v86, v82, v7
    v_perm_b32 v163, v94, v90, v7
    ds_write_b128 v25, v[160:163] offset:1024
    v_perm_b32 v164, v70, v66, v8
    v_perm_b32 v165, v78, v74, v8
    v_perm_b32 v166, v86, v82, v8
    v_perm_b32 v167, v94, v90, v8
    ds_write_b128 v25, v[164:167] offset:17408
    v_perm_b32 v168, v71, v67, v7
    v_perm_b32 v169, v79, v75, v7
    v_perm_b32 v170, v87, v83, v7
    v_perm_b32 v171, v95, v91, v7
    ds_write_b128 v25, v[168:171] offset:33792
    v_perm_b32 v172, v71, v67, v8
    v_perm_b32 v173, v79, v75, v8
    v_perm_b32 v174, v87, v83, v8
    v_perm_b32 v175, v95, v91, v8
    ds_write_b128 v25, v[172:175] offset:50176
    s_waitcnt vmcnt(8)
    v_perm_b32 v160, v100, v96, v7
    v_perm_b32 v161, v108, v104, v7
    v_perm_b32 v162, v116, v112, v7
    v_perm_b32 v163, v124, v120, v7
    ds_write_b128 v6, v[160:163] offset:2048
    v_perm_b32 v164, v100, v96, v8
    v_perm_b32 v165, v108, v104, v8
    v_perm_b32 v166, v116, v112, v8
    v_perm_b32 v167, v124, v120, v8
    ds_write_b128 v6, v[164:167] offset:18432
    v_perm_b32 v168, v101, v97, v7
    v_perm_b32 v169, v109, v105, v7
    v_perm_b32 v170, v117, v113, v7
    v_perm_b32 v171, v125, v121, v7
    ds_write_b128 v6, v[168:171] offset:34816
    v_perm_b32 v172, v101, v97, v8
    v_perm_b32 v173, v109, v105, v8
    v_perm_b32 v174, v117, v113, v8
    v_perm_b32 v175, v125, v121, v8
    ds_write_b128 v6, v[172:175] offset:51200
    v_perm_b32 v160, v102, v98, v7
    v_perm_b32 v161, v110, v106, v7
    v_perm_b32 v162, v118, v114, v7
    v_perm_b32 v163, v126, v122, v7
    ds_write_b128 v25, v[160:163] offset:2048
    v_perm_b32 v164, v102, v98, v8
    v_perm_b32 v165, v110, v106, v8
    v_perm_b32 v166, v118, v114, v8
    v_perm_b32 v167, v126, v122, v8
    ds_write_b128 v25, v[164:167] offset:18432
    v_perm_b32 v168, v103, v99, v7
    v_perm_b32 v169, v111, v107, v7
    v_perm_b32 v170, v119, v115, v7
    v_perm_b32 v171, v127, v123, v7
    ds_write_b128 v25, v[168:171] offset:34816
    v_perm_b32 v172, v103, v99, v8
    v_perm_b32 v173, v111, v107, v8
    v_perm_b32 v174, v119, v115, v8
    v_perm_b32 v175, v127, v123, v8
    ds_write_b128 v25, v[172:175] offset:51200
    s_waitcnt vmcnt(0)
    v_perm_b32 v160, v132, v128, v7
    v_perm_b32 v161, v140, v136, v7
    v_perm_b32 v162, v148, v144, v7
    v_perm_b32 v163, v156, v152, v7
    ds_write_b128 v6, v[160:163] offset:3072
    v_perm_b32 v164, v132, v128, v8
    v_perm_b32 v165, v140, v136, v8
    v_perm_b32 v166, v148, v144, v8
    v_perm_b32 v167, v156, v152, v8
    ds_write_b128 v6, v[164:167] offset:19456
    v_perm_b32 v168, v133, v129, v7
    v_perm_b32 v169, v141, v137, v7
    v_perm_b32 v170, v149, v145, v7
    v_perm_b32 v171, v157, v153, v7
    ds_write_b128 v6, v[168:171] offset:35840
    v_perm_b32 v172, v133, v129, v8
    v_perm_b32 v173, v141, v137, v8
    v_perm_b32 v174, v149, v145, v8
    v_perm_b32 v175, v157, v153, v8
    ds_write_b128 v6, v[172:175] offset:52224
    v_perm_b32 v160, v134, v130, v7
    v_perm_b32 v161, v142, v138, v7
    v_perm_b32 v162, v150, v146, v7
    v_perm_b32 v163, v158, v154, v7
    ds_write_b128 v25, v[160:163] offset:3072
    v_perm_b32 v164, v134, v130, v8
    v_perm_b32 v165, v142, v138, v8
    v_perm_b32 v166, v150, v146, v8
    v_perm_b32 v167, v158, v154, v8
    ds_write_b128 v25, v[164:167] offset:19456
    v_perm_b32 v168, v135, v131, v7
    v_perm_b32 v169, v143, v139, v7
    v_perm_b32 v170, v151, v147, v7
    v_perm_b32 v171, v159, v155, v7
    ds_write_b128 v25, v[168:171] offset:35840
    v_perm_b32 v172, v135, v131, v8
    v_perm_b32 v173, v143, v139, v8
    v_perm_b32 v174, v151, v147, v8
    v_perm_b32 v175, v159, v155, v8
    ds_write_b128 v25, v[172:175] offset:52224
W1_pJ:
    s_mov_b32 s52, 32784
    s_cmp_eq_u32 s29, 1
    s_cselect_b32 s52, 32768, s52
    s_mul_i32 s52, s52, s22
    v_add_u32 v22, s52, v4
    s_waitcnt lgkmcnt(0)
    s_barrier
    ds_read_b128 a[0:3], v22 offset:0
    ds_read_b128 a[4:7], v22 offset:16384
    ds_read_b128 a[8:11], v22 offset:1024
    ds_read_b128 a[12:15], v22 offset:17408
    ds_read_b128 a[16:19], v22 offset:2048
    ds_read_b128 a[20:23], v22 offset:18432
    ds_read_b128 a[24:27], v22 offset:3072
    ds_read_b128 a[28:31], v22 offset:19456
    s_waitcnt lgkmcnt(4)
    ds_read_b128 a[32:35], v22 offset:4096
    ds_read_b128 a[36:39], v22 offset:20480
    ds_read_b128 a[40:43], v22 offset:5120
    ds_read_b128 a[44:47], v22 offset:21504
    ds_read_b128 a[48:51], v22 offset:6144
    ds_read_b128 a[52:55], v22 offset:22528
    ds_read_b128 a[56:59], v22 offset:7168
    ds_read_b128 a[60:63], v22 offset:23552
    s_waitcnt lgkmcnt(4)
    ds_read_b128 a[64:67], v22 offset:8192
    ds_read_b128 a[68:71], v22 offset:24576
    ds_read_b128 a[72:75], v22 offset:9216
    ds_read_b128 a[76:79], v22 offset:25600
    ds_read_b128 a[80:83], v22 offset:10240
    ds_read_b128 a[84:87], v22 offset:26624
    ds_read_b128 a[88:91], v22 offset:11264
    ds_read_b128 a[92:95], v22 offset:27648
    s_waitcnt lgkmcnt(4)
    ds_read_b128 a[96:99], v22 offset:12288
    ds_read_b128 a[100:103], v22 offset:28672
    ds_read_b128 a[104:107], v22 offset:13312
    ds_read_b128 a[108:111], v22 offset:29696
    ds_read_b128 a[112:115], v22 offset:14336
    ds_read_b128 a[116:119], v22 offset:30720
    ds_read_b128 a[120:123], v22 offset:15360
    ds_read_b128 a[124:127], v22 offset:31744
    s_waitcnt lgkmcnt(4)
    s_waitcnt lgkmcnt(0)
    s_barrier
    s_lshl_b32 s51, s30, 15
    s_lshl_b32 s52, s22, 13
    s_add_u32 s51, s51, s52
    s_add_u32 s38, s74, s51
    s_addc_u32 s39, s75, 0
    s_mov_b32 s42, 0
    s_mov_b32 s33, 0
    s_lshl_b32 s51, s22, 13
    s_add_u32 s51, s51, s42
    s_mov_b32 m0, s51
    s_add_u32 s40, s38, 4096
    s_addc_u32 s41, s39, 0
    s_nop 0
    global_load_lds_dwordx4 v10, s[38:39] offset:0
    global_load_lds_dwordx4 v11, s[38:39] offset:1024
    global_load_lds_dwordx4 v12, s[38:39] offset:2048
    global_load_lds_dwordx4 v13, s[38:39] offset:3072
    s_add_u32 s51, m0, 4096
    s_mov_b32 m0, s51
    s_nop 0
    global_load_lds_dwordx4 v14, s[40:41] offset:0
    global_load_lds_dwordx4 v15, s[40:41] offset:1024
    global_load_lds_dwordx4 v16, s[40:41] offset:2048
    global_load_lds_dwordx4 v17, s[40:41] offset:3072
    s_add_u32 s38, s38, s43
    s_addc_u32 s39, s39, 0
    s_add_u32 s42, s42, 32768
    s_lshl_b32 s51, s22, 13
    s_add_u32 s51, s51, s42
    s_mov_b32 m0, s51
    s_add_u32 s40, s38, 4096
    s_addc_u32 s41, s39, 0
    s_nop 0
    global_load_lds_dwordx4 v10, s[38:39] offset:0
    global_load_lds_dwordx4 v11, s[38:39] offset:1024
    global_load_lds_dwordx4 v12, s[38:39] offset:2048
    global_load_lds_dwordx4 v13, s[38:39] offset:3072
    s_add_u32 s51, m0, 4096
    s_mov_b32 m0, s51
    s_nop 0
    global_load_lds_dwordx4 v14, s[40:41] offset:0
    global_load_lds_dwordx4 v15, s[40:41] offset:1024
    global_load_lds_dwordx4 v16, s[40:41] offset:2048
    global_load_lds_dwordx4 v17, s[40:41] offset:3072
    s_add_u32 s38, s38, s43
    s_addc_u32 s39, s39, 0
    s_add_u32 s42, s42, 32768
    s_lshl_b32 s51, s22, 13
    s_add_u32 s51, s51, s42
    s_mov_b32 m0, s51
    s_add_u32 s40, s38, 4096
    s_addc_u32 s41, s39, 0
    s_nop 0
    global_load_lds_dwordx4 v10, s[38:39] offset:0
    global_load_lds_dwordx4 v11, s[38:39] offset:1024
    global_load_lds_dwordx4 v12, s[38:39] offset:2048
    global_load_lds_dwordx4 v13, s[38:39] offset:3072
    s_add_u32 s51, m0, 4096
    s_mov_b32 m0, s51
    s_nop 0
    global_load_lds_dwordx4 v14, s[40:41] offset:0
    global_load_lds_dwordx4 v15, s[40:41] offset:1024
    global_load_lds_dwordx4 v16, s[40:41] offset:2048
    global_load_lds_dwordx4 v17, s[40:41] offset:3072
    s_add_u32 s38, s38, s43
    s_addc_u32 s39, s39, 0
    s_add_u32 s42, s42, 32768
    s_mov_b32 s34, 0
    v_mov_b32 v28, 12
    s_mov_b32 s25, 0
wt_6:
    global_load_dword v29, v28, s[14:15] sc1
    s_add_u32 s25, s25, 1
    s_cmp_gt_u32 s25, 300000
    s_cbranch_scc1 W_ABORT
    s_waitcnt vmcnt(0)
    v_readfirstlane_b32 s51, v29
    s_nop 1
    s_cmp_ge_u32 s51, 1
    s_cbranch_scc1 wd_7
    s_sleep 2
    s_branch wt_6
wd_7:
    s_waitcnt vmcnt(0)
    s_barrier
    ds_read_b128 v[32:35], v18 offset:0
    ds_read_b128 v[36:39], v18 offset:16384
    ds_read_b128 v[40:43], v19 offset:0
    ds_read_b128 v[44:47], v19 offset:16384
    ds_read_b128 v[48:51], v20 offset:0
    ds_read_b128 v[52:55], v20 offset:16384
    s_cmp_eq_u32 s29, 1
    s_cbranch_scc1 W1_top1
    s_cmp_ge_u32 s27, 64
    s_cbranch_scc1 W1_top2
W1_top0:
    ds_read_b128 v[56:59], v21 offset:0
    s_waitcnt lgkmcnt(6)
    v_mfma_f32_16x16x32_bf16 v[64:67], a[0:3], v[32:35], 0
    v_mfma_f32_16x16x32_bf16 v[68:71], a[4:7], v[32:35], 0
    ds_read_b128 v[60:63], v21 offset:16384
    s_waitcnt lgkmcnt(6)
    v_mfma_f32_16x16x32_bf16 v[72:75], a[0:3], v[36:39], 0
    v_mfma_f32_16x16x32_bf16 v[76:79], a[4:7], v[36:39], 0
    ds_read_b128 v[32:35], v18 offset:256
    s_waitcnt lgkmcnt(6)
    v_mfma_f32_16x16x32_bf16 v[64:67], a[8:11], v[40:43], v[64:67]
    v_mfma_f32_16x16x32_bf16 v[68:71], a[12:15], v[40:43], v[68:71]
    ds_read_b128 v[36:39], v18 offset:16640
    s_waitcnt lgkmcnt(6)
    v_mfma_f32_16x16x32_bf16 v[72:75], a[8:11], v[44:47], v[72:75]
    v_mfma_f32_16x16x32_bf16 v[76:79], a[12:15], v[44:47], v[76:79]
    ds_read_b128 v[40:43], v19 offset:256
    s_waitcnt lgkmcnt(6)
    v_mfma_f32_16x16x32_bf16 v[64:67], a[16:19], v[48:51], v[64:67]
    v_cvt_pk_bf16_f32 v96, v80, v81
    v_cvt_pk_bf16_f32 v97, v82, v83
    v_mfma_f32_16x16x32_bf16 v[68:71], a[20:23], v[48:51], v[68:71]
    ds_read_b128 v[44:47], v19 offset:16640
    s_waitcnt lgkmcnt(6)
    v_mfma_f32_16x16x32_bf16 v[72:75], a[16:19], v[52:55], v[72:75]
    v_mfma_f32_16x16x32_bf16 v[76:79], a[20:23], v[52:55], v[76:79]
    ds_read_b128 v[48:51], v20 offset:256
    s_waitcnt lgkmcnt(6)
    v_mfma_f32_16x16x32_bf16 v[64:67], a[24:27], v[56:59], v[64:67]
    v_cvt_pk_bf16_f32 v98, v84, v85
    v_cvt_pk_bf16_f32 v99, v86, v87
    v_mfma_f32_16x16x32_bf16 v[68:71], a[28:31], v[56:59], v[68:71]
    ds_read_b128 v[52:55], v20 offset:16640
    s_waitcnt lgkmcnt(6)
    v_mfma_f32_16x16x32_bf16 v[72:75], a[24:27], v[60:63], v[72:75]
    v_mfma_f32_16x16x32_bf16 v[76:79], a[28:31], v[60:63], v[76:79]
    ds_read_b128 v[56:59], v21 offset:256
    s_waitcnt lgkmcnt(6)
    v_mfma_f32_16x16x32_bf16 v[64:67], a[32:35], v[32:35], v[64:67]
    v_cvt_pk_bf16_f32 v100, v88, v89
    v_cvt_pk_bf16_f32 v101, v90, v91
    v_mfma_f32_16x16x32_bf16 v[68:71], a[36:39], v[32:35], v[68:71]
    ds_read_b128 v[60:63], v21 offset:16640
    s_waitcnt lgkmcnt(6)
    v_mfma_f32_16x16x32_bf16 v[72:75], a[32:35], v[36:39], v[72:75]
    v_mfma_f32_16x16x32_bf16 v[76:79], a[36:39], v[36:39], v[76:79]
    ds_read_b128 v[32:35], v18 offset:512
    s_waitcnt lgkmcnt(6)
    v_mfma_f32_16x16x32_bf16 v[64:67], a[40:43], v[40:43], v[64:67]
    v_cvt_pk_bf16_f32 v102, v92, v93
    v_cvt_pk_bf16_f32 v103, v94, v95
    v_mfma_f32_16x16x32_bf16 v[68:71], a[44:47], v[40:43], v[68:71]
    ds_read_b128 v[36:39], v18 offset:16896
    s_waitcnt lgkmcnt(6)
    v_mfma_f32_16x16x32_bf16 v[72:75], a[40:43], v[44:47], v[72:75]
    v_mfma_f32_16x16x32_bf16 v[76:79], a[44:47], v[44:47], v[76:79]
    ds_read_b128 v[40:43], v19 offset:512
    s_waitcnt lgkmcnt(6)
    v_mfma_f32_16x16x32_bf16 v[64:67], a[48:51], v[48:51], v[64:67]
    global_store_dwordx4 v4, v[96:99], s[36:37] sc1
    v_mfma_f32_16x16x32_bf16 v[68:71], a[52:55], v[48:51], v[68:71]
    ds_read_b128 v[44:47], v19 offset:16896
    s_waitcnt lgkmcnt(6)
    v_mfma_f32_16x16x32_bf16 v[72:75], a[48:51], v[52:55], v[72:75]
    v_mfma_f32_16x16x32_bf16 v[76:79], a[52:55], v[52:55], v[76:79]
    ds_read_b128 v[48:51], v20 offset:512
    s_waitcnt lgkmcnt(6)
    v_mfma_f32_16x16x32_bf16 v[64:67], a[56:59], v[56:59], v[64:67]
    global_store_dwordx4 v9, v[100:103], s[36:37] sc1
    s_add_u32 s36, s36, s31
    s_addc_u32 s37, s37, 0
    s_cmp_eq_u32 s33, 0
    s_cselect_b64 s[36:37], s[44:45], s[36:37]
    v_mfma_f32_16x16x32_bf16 v[68:71], a[60:63], v[56:59], v[68:71]
    ds_read_b128 v[52:55], v20 offset:16896
    s_waitcnt lgkmcnt(6)
    v_mfma_f32_16x16x32_bf16 v[72:75], a[56:59], v[60:63], v[72:75]
    v_mfma_f32_16x16x32_bf16 v[76:79], a[60:63], v[60:63], v[76:79]
    s_waitcnt vmcnt(12)
    s_barrier
    s_sub_u32 s52, s33, 2
    s_max_i32 s52, s52, 0
    s_min_u32 s52, s52, 64
    v_mov_b32 v27, s52
    s_mov_b64 exec, s[86:87]
    global_store_dword v26, v27, s[2:3] sc1
    s_mov_b64 exec, -1
    s_lshl_b32 s51, s22, 13
    s_add_u32 s51, s51, s42
    s_mov_b32 m0, s51
    s_add_u32 s40, s38, 4096
    s_addc_u32 s41, s39, 0
    ds_read_b128 v[56:59], v21 offset:512
    s_waitcnt lgkmcnt(6)
    v_mfma_f32_16x16x32_bf16 v[64:67], a[64:67], v[32:35], v[64:67]
    global_load_lds_dwordx4 v10, s[38:39] offset:0
    v_mfma_f32_16x16x32_bf16 v[68:71], a[68:71], v[32:35], v[68:71]
    ds_read_b128 v[60:63], v21 offset:16896
    s_waitcnt lgkmcnt(6)
    v_mfma_f32_16x16x32_bf16 v[72:75], a[64:67], v[36:39], v[72:75]
    v_mfma_f32_16x16x32_bf16 v[76:79], a[68:71], v[36:39], v[76:79]
    ds_read_b128 v[32:35], v18 offset:768
    s_waitcnt lgkmcnt(6)
    v_mfma_f32_16x16x32_bf16 v[64:67], a[72:75], v[40:43], v[64:67]
    global_load_lds_dwordx4 v11, s[38:39] offset:1024
    v_mfma_f32_16x16x32_bf16 v[68:71], a[76:79], v[40:43], v[68:71]
    ds_read_b128 v[36:39], v18 offset:17152
    s_waitcnt lgkmcnt(6)
    v_mfma_f32_16x16x32_bf16 v[72:75], a[72:75], v[44:47], v[72:75]
    v_mfma_f32_16x16x32_bf16 v[76:79], a[76:79], v[44:47], v[76:79]
    ds_read_b128 v[40:43], v19 offset:768
    s_waitcnt lgkmcnt(6)
    v_mfma_f32_16x16x32_bf16 v[64:67], a[80:83], v[48:51], v[64:67]
    global_load_lds_dwordx4 v12, s[38:39] offset:2048
    v_mfma_f32_16x16x32_bf16 v[68:71], a[84:87], v[48:51], v[68:71]
    ds_read_b128 v[44:47], v19 offset:17152
    s_waitcnt lgkmcnt(6)
    v_mfma_f32_16x16x32_bf16 v[72:75], a[80:83], v[52:55], v[72:75]
    v_mfma_f32_16x16x32_bf16 v[76:79], a[84:87], v[52:55], v[76:79]
    ds_read_b128 v[48:51], v20 offset:768
    s_waitcnt lgkmcnt(6)
    v_mfma_f32_16x16x32_bf16 v[64:67], a[88:91], v[56:59], v[64:67]
    global_load_lds_dwordx4 v13, s[38:39] offset:3072
    v_mfma_f32_16x16x32_bf16 v[68:71], a[92:95], v[56:59], v[68:71]
    ds_read_b128 v[52:55], v20 offset:17152
    s_waitcnt lgkmcnt(6)
    v_mfma_f32_16x16x32_bf16 v[72:75], a[88:91], v[60:63], v[72:75]
    v_mfma_f32_16x16x32_bf16 v[76:79], a[92:95], v[60:63], v[76:79]
    ds_read_b128 v[56:59], v21 offset:768
    s_waitcnt lgkmcnt(6)
    v_mfma_f32_16x16x32_bf16 v[64:67], a[96:99], v[32:35], v[64:67]
    s_add_u32 s51, m0, 4096
    s_mov_b32 m0, s51
    s_nop 0
    global_load_lds_dwordx4 v14, s[40:41] offset:0
    v_mfma_f32_16x16x32_bf16 v[68:71], a[100:103], v[32:35], v[68:71]
    ds_read_b128 v[60:63], v21 offset:17152
    s_waitcnt lgkmcnt(6)
    v_mfma_f32_16x16x32_bf16 v[72:75], a[96:99], v[36:39], v[72:75]
    v_mfma_f32_16x16x32_bf16 v[76:79], a[100:103], v[36:39], v[76:79]
    s_add_u32 s34, s34, 32768
    s_cmp_eq_u32 s34, 131072
    s_cselect_b32 s52, -3, 1
    s_cselect_b32 s34, 0, s34
    s_lshl_b32 s52, s52, 15
    v_add_u32 v18, s52, v18
    v_add_u32 v19, s52, v19
    v_add_u32 v20, s52, v20
    v_add_u32 v21, s52, v21
    ds_read_b128 v[32:35], v18 offset:0
    s_waitcnt lgkmcnt(6)
    v_mfma_f32_16x16x32_bf16 v[64:67], a[104:107], v[40:43], v[64:67]
    global_load_lds_dwordx4 v15, s[40:41] offset:1024
    v_mfma_f32_16x16x32_bf16 v[68:71], a[108:111], v[40:43], v[68:71]
    ds_read_b128 v[36:39], v18 offset:16384
    s_waitcnt lgkmcnt(6)
    v_mfma_f32_16x16x32_bf16 v[72:75], a[104:107], v[44:47], v[72:75]
    v_mfma_f32_16x16x32_bf16 v[76:79], a[108:111], v[44:47], v[76:79]
    ds_read_b128 v[40:43], v19 offset:0
    s_waitcnt lgkmcnt(6)
    v_mfma_f32_16x16x32_bf16 v[64:67], a[112:115], v[48:51], v[64:67]
    global_load_lds_dwordx4 v16, s[40:41] offset:2048
    v_mfma_f32_16x16x32_bf16 v[68:71], a[116:119], v[48:51], v[68:71]
    ds_read_b128 v[44:47], v19 offset:16384
    s_waitcnt lgkmcnt(6)
    v_mfma_f32_16x16x32_bf16 v[72:75], a[112:115], v[52:55], v[72:75]
    v_mfma_f32_16x16x32_bf16 v[76:79], a[116:119], v[52:55], v[76:79]
    ds_read_b128 v[48:51], v20 offset:0
    s_waitcnt lgkmcnt(6)
    v_mfma_f32_16x16x32_bf16 v[64:67], a[120:123], v[56:59], v[64:67]
    global_load_lds_dwordx4 v17, s[40:41] offset:3072
    v_mfma_f32_16x16x32_bf16 v[68:71], a[124:127], v[56:59], v[68:71]
    ds_read_b128 v[52:55], v20 offset:16384
    s_waitcnt lgkmcnt(6)
    v_mfma_f32_16x16x32_bf16 v[72:75], a[120:123], v[60:63], v[72:75]
    v_mfma_f32_16x16x32_bf16 v[76:79], a[124:127], v[60:63], v[76:79]
    s_add_u32 s52, s33, 4
    s_cmp_lt_u32 s52, s35
    s_cselect_b32 s52, s43, 0
    s_add_u32 s38, s38, s52
    s_addc_u32 s39, s39, 0
    s_add_u32 s42, s42, 32768
    s_cmp_eq_u32 s42, 131072
    s_cselect_b32 s42, 0, s42
    s_add_u32 s33, s33, 1
    ds_read_b128 v[56:59], v21 offset:0
    s_waitcnt lgkmcnt(6)
    v_mfma_f32_16x16x32_bf16 v[80:83], a[0:3], v[32:35], 0
    v_mfma_f32_16x16x32_bf16 v[84:87], a[4:7], v[32:35], 0
    ds_read_b128 v[60:63], v21 offset:16384
    s_waitcnt lgkmcnt(6)
    v_mfma_f32_16x16x32_bf16 v[88:91], a[0:3], v[36:39], 0
    v_mfma_f32_16x16x32_bf16 v[92:95], a[4:7], v[36:39], 0
    ds_read_b128 v[32:35], v18 offset:256
    s_waitcnt lgkmcnt(6)
    v_mfma_f32_16x16x32_bf16 v[80:83], a[8:11], v[40:43], v[80:83]
    v_mfma_f32_16x16x32_bf16 v[84:87], a[12:15], v[40:43], v[84:87]
    ds_read_b128 v[36:39], v18 offset:16640
    s_waitcnt lgkmcnt(6)
    v_mfma_f32_16x16x32_bf16 v[88:91], a[8:11], v[44:47], v[88:91]
    v_mfma_f32_16x16x32_bf16 v[92:95], a[12:15], v[44:47], v[92:95]
    ds_read_b128 v[40:43], v19 offset:256
    s_waitcnt lgkmcnt(6)
    v_mfma_f32_16x16x32_bf16 v[80:83], a[16:19], v[48:51], v[80:83]
    v_cvt_pk_bf16_f32 v96, v64, v65
    v_cvt_pk_bf16_f32 v97, v66, v67
    v_mfma_f32_16x16x32_bf16 v[84:87], a[20:23], v[48:51], v[84:87]
    ds_read_b128 v[44:47], v19 offset:16640
    s_waitcnt lgkmcnt(6)
    v_mfma_f32_16x16x32_bf16 v[88:91], a[16:19], v[52:55], v[88:91]
    v_mfma_f32_16x16x32_bf16 v[92:95], a[20:23], v[52:55], v[92:95]
    ds_read_b128 v[48:51], v20 offset:256
    s_waitcnt lgkmcnt(6)
    v_mfma_f32_16x16x32_bf16 v[80:83], a[24:27], v[56:59], v[80:83]
    v_cvt_pk_bf16_f32 v98, v68, v69
    v_cvt_pk_bf16_f32 v99, v70, v71
    v_mfma_f32_16x16x32_bf16 v[84:87], a[28:31], v[56:59], v[84:87]
    ds_read_b128 v[52:55], v20 offset:16640
    s_waitcnt lgkmcnt(6)
    v_mfma_f32_16x16x32_bf16 v[88:91], a[24:27], v[60:63], v[88:91]
    v_mfma_f32_16x16x32_bf16 v[92:95], a[28:31], v[60:63], v[92:95]
    ds_read_b128 v[56:59], v21 offset:256
    s_waitcnt lgkmcnt(6)
    v_mfma_f32_16x16x32_bf16 v[80:83], a[32:35], v[32:35], v[80:83]
    v_cvt_pk_bf16_f32 v100, v72, v73
    v_cvt_pk_bf16_f32 v101, v74, v75
    v_mfma_f32_16x16x32_bf16 v[84:87], a[36:39], v[32:35], v[84:87]
    ds_read_b128 v[60:63], v21 offset:16640
    s_waitcnt lgkmcnt(6)
    v_mfma_f32_16x16x32_bf16 v[88:91], a[32:35], v[36:39], v[88:91]
    v_mfma_f32_16x16x32_bf16 v[92:95], a[36:39], v[36:39], v[92:95]
    ds_read_b128 v[32:35], v18 offset:512
    s_waitcnt lgkmcnt(6)
    v_mfma_f32_16x16x32_bf16 v[80:83], a[40:43], v[40:43], v[80:83]
    v_cvt_pk_bf16_f32 v102, v76, v77
    v_cvt_pk_bf16_f32 v103, v78, v79
    v_mfma_f32_16x16x32_bf16 v[84:87], a[44:47], v[40:43], v[84:87]
    ds_read_b128 v[36:39], v18 offset:16896
    s_waitcnt lgkmcnt(6)
    v_mfma_f32_16x16x32_bf16 v[88:91], a[40:43], v[44:47], v[88:91]
    v_mfma_f32_16x16x32_bf16 v[92:95], a[44:47], v[44:47], v[92:95]
    ds_read_b128 v[40:43], v19 offset:512
    s_waitcnt lgkmcnt(6)
    v_mfma_f32_16x16x32_bf16 v[80:83], a[48:51], v[48:51], v[80:83]
    global_store_dwordx4 v4, v[96:99], s[36:37] sc1
    v_mfma_f32_16x16x32_bf16 v[84:87], a[52:55], v[48:51], v[84:87]
    ds_read_b128 v[44:47], v19 offset:16896
    s_waitcnt lgkmcnt(6)
    v_mfma_f32_16x16x32_bf16 v[88:91], a[48:51], v[52:55], v[88:91]
    v_mfma_f32_16x16x32_bf16 v[92:95], a[52:55], v[52:55], v[92:95]
    ds_read_b128 v[48:51], v20 offset:512
    s_waitcnt lgkmcnt(6)
    v_mfma_f32_16x16x32_bf16 v[80:83], a[56:59], v[56:59], v[80:83]
    global_store_dwordx4 v9, v[100:103], s[36:37] sc1
    s_add_u32 s36, s36, s31
    s_addc_u32 s37, s37, 0
    s_cmp_eq_u32 s33, 0
    s_cselect_b64 s[36:37], s[44:45], s[36:37]
    v_mfma_f32_16x16x32_bf16 v[84:87], a[60:63], v[56:59], v[84:87]
    ds_read_b128 v[52:55], v20 offset:16896
    s_waitcnt lgkmcnt(6)
    v_mfma_f32_16x16x32_bf16 v[88:91], a[56:59], v[60:63], v[88:91]
    v_mfma_f32_16x16x32_bf16 v[92:95], a[60:63], v[60:63], v[92:95]
    s_waitcnt vmcnt(12)
    s_barrier
    s_sub_u32 s52, s33, 2
    s_max_i32 s52, s52, 0
    s_min_u32 s52, s52, 64
    v_mov_b32 v27, s52
    s_mov_b64 exec, s[86:87]
    global_store_dword v26, v27, s[2:3] sc1
    s_mov_b64 exec, -1
    s_lshl_b32 s51, s22, 13
    s_add_u32 s51, s51, s42
    s_mov_b32 m0, s51
    s_add_u32 s40, s38, 4096
    s_addc_u32 s41, s39, 0
    ds_read_b128 v[56:59], v21 offset:512
    s_waitcnt lgkmcnt(6)
    v_mfma_f32_16x16x32_bf16 v[80:83], a[64:67], v[32:35], v[80:83]
    global_load_lds_dwordx4 v10, s[38:39] offset:0
    v_mfma_f32_16x16x32_bf16 v[84:87], a[68:71], v[32:35], v[84:87]
    ds_read_b128 v[60:63], v21 offset:16896
    s_waitcnt lgkmcnt(6)
    v_mfma_f32_16x16x32_bf16 v[88:91], a[64:67], v[36:39], v[88:91]
    v_mfma_f32_16x16x32_bf16 v[92:95], a[68:71], v[36:39], v[92:95]
    ds_read_b128 v[32:35], v18 offset:768
    s_waitcnt lgkmcnt(6)
    v_mfma_f32_16x16x32_bf16 v[80:83], a[72:75], v[40:43], v[80:83]
    global_load_lds_dwordx4 v11, s[38:39] offset:1024
    v_mfma_f32_16x16x32_bf16 v[84:87], a[76:79], v[40:43], v[84:87]
    ds_read_b128 v[36:39], v18 offset:17152
    s_waitcnt lgkmcnt(6)
    v_mfma_f32_16x16x32_bf16 v[88:91], a[72:75], v[44:47], v[88:91]
    v_mfma_f32_16x16x32_bf16 v[92:95], a[76:79], v[44:47], v[92:95]
    ds_read_b128 v[40:43], v19 offset:768
    s_waitcnt lgkmcnt(6)
    v_mfma_f32_16x16x32_bf16 v[80:83], a[80:83], v[48:51], v[80:83]
    global_load_lds_dwordx4 v12, s[38:39] offset:2048
    v_mfma_f32_16x16x32_bf16 v[84:87], a[84:87], v[48:51], v[84:87]
    ds_read_b128 v[44:47], v19 offset:17152
    s_waitcnt lgkmcnt(6)
    v_mfma_f32_16x16x32_bf16 v[88:91], a[80:83], v[52:55], v[88:91]
    v_mfma_f32_16x16x32_bf16 v[92:95], a[84:87], v[52:55], v[92:95]
    ds_read_b128 v[48:51], v20 offset:768
    s_waitcnt lgkmcnt(6)
    v_mfma_f32_16x16x32_bf16 v[80:83], a[88:91], v[56:59], v[80:83]
    global_load_lds_dwordx4 v13, s[38:39] offset:3072
    v_mfma_f32_16x16x32_bf16 v[84:87], a[92:95], v[56:59], v[84:87]
    ds_read_b128 v[52:55], v20 offset:17152
    s_waitcnt lgkmcnt(6)
    v_mfma_f32_16x16x32_bf16 v[88:91], a[88:91], v[60:63], v[88:91]
    v_mfma_f32_16x16x32_bf16 v[92:95], a[92:95], v[60:63], v[92:95]
    ds_read_b128 v[56:59], v21 offset:768
    s_waitcnt lgkmcnt(6)
    v_mfma_f32_16x16x32_bf16 v[80:83], a[96:99], v[32:35], v[80:83]
    s_add_u32 s51, m0, 4096
    s_mov_b32 m0, s51
    s_nop 0
    global_load_lds_dwordx4 v14, s[40:41] offset:0
    v_mfma_f32_16x16x32_bf16 v[84:87], a[100:103], v[32:35], v[84:87]
    ds_read_b128 v[60:63], v21 offset:17152
    s_waitcnt lgkmcnt(6)
    v_mfma_f32_16x16x32_bf16 v[88:91], a[96:99], v[36:39], v[88:91]
    v_mfma_f32_16x16x32_bf16 v[92:95], a[100:103], v[36:39], v[92:95]
    s_add_u32 s34, s34, 32768
    s_cmp_eq_u32 s34, 131072
    s_cselect_b32 s52, -3, 1
    s_cselect_b32 s34, 0, s34
    s_lshl_b32 s52, s52, 15
    v_add_u32 v18, s52, v18
    v_add_u32 v19, s52, v19
    v_add_u32 v20, s52, v20
    v_add_u32 v21, s52, v21
    ds_read_b128 v[32:35], v18 offset:0
    s_waitcnt lgkmcnt(6)
    v_mfma_f32_16x16x32_bf16 v[80:83], a[104:107], v[40:43], v[80:83]
    global_load_lds_dwordx4 v15, s[40:41] offset:1024
    v_mfma_f32_16x16x32_bf16 v[84:87], a[108:111], v[40:43], v[84:87]
    ds_read_b128 v[36:39], v18 offset:16384
    s_waitcnt lgkmcnt(6)
    v_mfma_f32_16x16x32_bf16 v[88:91], a[104:107], v[44:47], v[88:91]
    v_mfma_f32_16x16x32_bf16 v[92:95], a[108:111], v[44:47], v[92:95]
    ds_read_b128 v[40:43], v19 offset:0
    s_waitcnt lgkmcnt(6)
    v_mfma_f32_16x16x32_bf16 v[80:83], a[112:115], v[48:51], v[80:83]
    global_load_lds_dwordx4 v16, s[40:41] offset:2048
    v_mfma_f32_16x16x32_bf16 v[84:87], a[116:119], v[48:51], v[84:87]
    ds_read_b128 v[44:47], v19 offset:16384
    s_waitcnt lgkmcnt(6)
    v_mfma_f32_16x16x32_bf16 v[88:91], a[112:115], v[52:55], v[88:91]
    v_mfma_f32_16x16x32_bf16 v[92:95], a[116:119], v[52:55], v[92:95]
    ds_read_b128 v[48:51], v20 offset:0
    s_waitcnt lgkmcnt(6)
    v_mfma_f32_16x16x32_bf16 v[80:83], a[120:123], v[56:59], v[80:83]
    global_load_lds_dwordx4 v17, s[40:41] offset:3072
    v_mfma_f32_16x16x32_bf16 v[84:87], a[124:127], v[56:59], v[84:87]
    ds_read_b128 v[52:55], v20 offset:16384
    s_waitcnt lgkmcnt(6)
    v_mfma_f32_16x16x32_bf16 v[88:91], a[120:123], v[60:63], v[88:91]
    v_mfma_f32_16x16x32_bf16 v[92:95], a[124:127], v[60:63], v[92:95]
    s_add_u32 s52, s33, 4
    s_cmp_lt_u32 s52, s35
    s_cselect_b32 s52, s43, 0
    s_add_u32 s38, s38, s52
    s_addc_u32 s39, s39, 0
    s_add_u32 s42, s42, 32768
    s_cmp_eq_u32 s42, 131072
    s_cselect_b32 s42, 0, s42
    s_add_u32 s33, s33, 1
    s_cmp_lt_u32 s33, s35
    s_cbranch_scc1 W1_top0
    s_nop 7
    v_cvt_pk_bf16_f32 v96, v80, v81
    v_cvt_pk_bf16_f32 v97, v82, v83
    v_cvt_pk_bf16_f32 v98, v84, v85
    v_cvt_pk_bf16_f32 v99, v86, v87
    v_cvt_pk_bf16_f32 v100, v88, v89
    v_cvt_pk_bf16_f32 v101, v90, v91
    v_cvt_pk_bf16_f32 v102, v92, v93
    v_cvt_pk_bf16_f32 v103, v94, v95
    global_store_dwordx4 v4, v[96:99], s[36:37] sc1
    global_store_dwordx4 v9, v[100:103], s[36:37] sc1
    s_branch W1_end
W1_top1:
    ds_read_b128 v[56:59], v21 offset:0
    s_waitcnt lgkmcnt(6)
    v_mfma_f32_16x16x32_bf16 v[64:67], v[32:35], a[0:3], 0
    v_mfma_f32_16x16x32_bf16 v[68:71], v[32:35], a[4:7], 0
    ds_read_b128 v[60:63], v21 offset:16384
    s_waitcnt lgkmcnt(6)
    v_mfma_f32_16x16x32_bf16 v[72:75], v[36:39], a[0:3], 0
    v_mfma_f32_16x16x32_bf16 v[76:79], v[36:39], a[4:7], 0
    ds_read_b128 v[32:35], v18 offset:256
    s_waitcnt lgkmcnt(6)
    v_mfma_f32_16x16x32_bf16 v[64:67], v[40:43], a[8:11], v[64:67]
    v_mfma_f32_16x16x32_bf16 v[68:71], v[40:43], a[12:15], v[68:71]
    ds_read_b128 v[36:39], v18 offset:16640
    s_waitcnt lgkmcnt(6)
    v_mfma_f32_16x16x32_bf16 v[72:75], v[44:47], a[8:11], v[72:75]
    v_mfma_f32_16x16x32_bf16 v[76:79], v[44:47], a[12:15], v[76:79]
    ds_read_b128 v[40:43], v19 offset:256
    s_waitcnt lgkmcnt(6)
    v_mfma_f32_16x16x32_bf16 v[64:67], v[48:51], a[16:19], v[64:67]
    v_cvt_pk_bf16_f32 v96, v80, v81
    v_cvt_pk_bf16_f32 v97, v82, v83
    v_mfma_f32_16x16x32_bf16 v[68:71], v[48:51], a[20:23], v[68:71]
    ds_read_b128 v[44:47], v19 offset:16640
    s_waitcnt lgkmcnt(6)
    v_mfma_f32_16x16x32_bf16 v[72:75], v[52:55], a[16:19], v[72:75]
    v_mfma_f32_16x16x32_bf16 v[76:79], v[52:55], a[20:23], v[76:79]
    ds_read_b128 v[48:51], v20 offset:256
    s_waitcnt lgkmcnt(6)
    v_mfma_f32_16x16x32_bf16 v[64:67], v[56:59], a[24:27], v[64:67]
    v_cvt_pk_bf16_f32 v98, v88, v89
    v_cvt_pk_bf16_f32 v99, v90, v91
    v_mfma_f32_16x16x32_bf16 v[68:71], v[56:59], a[28:31], v[68:71]
    ds_read_b128 v[52:55], v20 offset:16640
    s_waitcnt lgkmcnt(6)
    v_mfma_f32_16x16x32_bf16 v[72:75], v[60:63], a[24:27], v[72:75]
    v_mfma_f32_16x16x32_bf16 v[76:79], v[60:63], a[28:31], v[76:79]
    ds_read_b128 v[56:59], v21 offset:256
    s_waitcnt lgkmcnt(6)
    v_mfma_f32_16x16x32_bf16 v[64:67], v[32:35], a[32:35], v[64:67]
    v_cvt_pk_bf16_f32 v100, v84, v85
    v_cvt_pk_bf16_f32 v101, v86, v87
    v_mfma_f32_16x16x32_bf16 v[68:71], v[32:35], a[36:39], v[68:71]
    ds_read_b128 v[60:63], v21 offset:16640
    s_waitcnt lgkmcnt(6)
    v_mfma_f32_16x16x32_bf16 v[72:75], v[36:39], a[32:35], v[72:75]
    v_mfma_f32_16x16x32_bf16 v[76:79], v[36:39], a[36:39], v[76:79]
    ds_read_b128 v[32:35], v18 offset:512
    s_waitcnt lgkmcnt(6)
    v_mfma_f32_16x16x32_bf16 v[64:67], v[40:43], a[40:43], v[64:67]
    v_cvt_pk_bf16_f32 v102, v92, v93
    v_cvt_pk_bf16_f32 v103, v94, v95
    v_mfma_f32_16x16x32_bf16 v[68:71], v[40:43], a[44:47], v[68:71]
    ds_read_b128 v[36:39], v18 offset:16896
    s_waitcnt lgkmcnt(6)
    v_mfma_f32_16x16x32_bf16 v[72:75], v[44:47], a[40:43], v[72:75]
    v_mfma_f32_16x16x32_bf16 v[76:79], v[44:47], a[44:47], v[76:79]
    ds_read_b128 v[40:43], v19 offset:512
    s_waitcnt lgkmcnt(6)
    v_mfma_f32_16x16x32_bf16 v[64:67], v[48:51], a[48:51], v[64:67]
    global_store_dwordx4 v4, v[96:99], s[36:37] sc1
    v_mfma_f32_16x16x32_bf16 v[68:71], v[48:51], a[52:55], v[68:71]
    ds_read_b128 v[44:47], v19 offset:16896
    s_waitcnt lgkmcnt(6)
    v_mfma_f32_16x16x32_bf16 v[72:75], v[52:55], a[48:51], v[72:75]
    v_mfma_f32_16x16x32_bf16 v[76:79], v[52:55], a[52:55], v[76:79]
    ds_read_b128 v[48:51], v20 offset:512
    s_waitcnt lgkmcnt(6)
    v_mfma_f32_16x16x32_bf16 v[64:67], v[56:59], a[56:59], v[64:67]
    global_store_dwordx4 v9, v[100:103], s[36:37] sc1
    s_add_u32 s36, s36, s31
    s_addc_u32 s37, s37, 0
    s_cmp_eq_u32 s33, 0
    s_cselect_b64 s[36:37], s[44:45], s[36:37]
    v_mfma_f32_16x16x32_bf16 v[68:71], v[56:59], a[60:63], v[68:71]
    ds_read_b128 v[52:55], v20 offset:16896
    s_waitcnt lgkmcnt(6)
    v_mfma_f32_16x16x32_bf16 v[72:75], v[60:63], a[56:59], v[72:75]
    v_mfma_f32_16x16x32_bf16 v[76:79], v[60:63], a[60:63], v[76:79]
    s_waitcnt vmcnt(12)
    s_barrier
    s_sub_u32 s52, s33, 2
    s_max_i32 s52, s52, 0
    s_min_u32 s52, s52, 64
    v_mov_b32 v27, s52
    s_mov_b64 exec, s[86:87]
    global_store_dword v26, v27, s[2:3] sc1
    s_mov_b64 exec, -1
    s_lshl_b32 s51, s22, 13
    s_add_u32 s51, s51, s42
    s_mov_b32 m0, s51
    s_add_u32 s40, s38, 4096
    s_addc_u32 s41, s39, 0
    ds_read_b128 v[56:59], v21 offset:512
    s_waitcnt lgkmcnt(6)
    v_mfma_f32_16x16x32_bf16 v[64:67], v[32:35], a[64:67], v[64:67]
    global_load_lds_dwordx4 v10, s[38:39] offset:0
    v_mfma_f32_16x16x32_bf16 v[68:71], v[32:35], a[68:71], v[68:71]
    ds_read_b128 v[60:63], v21 offset:16896
    s_waitcnt lgkmcnt(6)
    v_mfma_f32_16x16x32_bf16 v[72:75], v[36:39], a[64:67], v[72:75]
    v_mfma_f32_16x16x32_bf16 v[76:79], v[36:39], a[68:71], v[76:79]
    ds_read_b128 v[32:35], v18 offset:768
    s_waitcnt lgkmcnt(6)
    v_mfma_f32_16x16x32_bf16 v[64:67], v[40:43], a[72:75], v[64:67]
    global_load_lds_dwordx4 v11, s[38:39] offset:1024
    v_mfma_f32_16x16x32_bf16 v[68:71], v[40:43], a[76:79], v[68:71]
    ds_read_b128 v[36:39], v18 offset:17152
    s_waitcnt lgkmcnt(6)
    v_mfma_f32_16x16x32_bf16 v[72:75], v[44:47], a[72:75], v[72:75]
    v_mfma_f32_16x16x32_bf16 v[76:79], v[44:47], a[76:79], v[76:79]
    ds_read_b128 v[40:43], v19 offset:768
    s_waitcnt lgkmcnt(6)
    v_mfma_f32_16x16x32_bf16 v[64:67], v[48:51], a[80:83], v[64:67]
    global_load_lds_dwordx4 v12, s[38:39] offset:2048
    v_mfma_f32_16x16x32_bf16 v[68:71], v[48:51], a[84:87], v[68:71]
    ds_read_b128 v[44:47], v19 offset:17152
    s_waitcnt lgkmcnt(6)
    v_mfma_f32_16x16x32_bf16 v[72:75], v[52:55], a[80:83], v[72:75]
    v_mfma_f32_16x16x32_bf16 v[76:79], v[52:55], a[84:87], v[76:79]
    ds_read_b128 v[48:51], v20 offset:768
    s_waitcnt lgkmcnt(6)
    v_mfma_f32_16x16x32_bf16 v[64:67], v[56:59], a[88:91], v[64:67]
    global_load_lds_dwordx4 v13, s[38:39] offset:3072
    v_mfma_f32_16x16x32_bf16 v[68:71], v[56:59], a[92:95], v[68:71]
    ds_read_b128 v[52:55], v20 offset:17152
    s_waitcnt lgkmcnt(6)
    v_mfma_f32_16x16x32_bf16 v[72:75], v[60:63], a[88:91], v[72:75]
    v_mfma_f32_16x16x32_bf16 v[76:79], v[60:63], a[92:95], v[76:79]
    ds_read_b128 v[56:59], v21 offset:768
    s_waitcnt lgkmcnt(6)
    v_mfma_f32_16x16x32_bf16 v[64:67], v[32:35], a[96:99], v[64:67]
    s_add_u32 s51, m0, 4096
    s_mov_b32 m0, s51
    s_nop 0
    global_load_lds_dwordx4 v14, s[40:41] offset:0
    v_mfma_f32_16x16x32_bf16 v[68:71], v[32:35], a[100:103], v[68:71]
    ds_read_b128 v[60:63], v21 offset:17152
    s_waitcnt lgkmcnt(6)
    v_mfma_f32_16x16x32_bf16 v[72:75], v[36:39], a[96:99], v[72:75]
    v_mfma_f32_16x16x32_bf16 v[76:79], v[36:39], a[100:103], v[76:79]
    s_add_u32 s34, s34, 32768
    s_cmp_eq_u32 s34, 131072
    s_cselect_b32 s52, -3, 1
    s_cselect_b32 s34, 0, s34
    s_lshl_b32 s52, s52, 15
    v_add_u32 v18, s52, v18
    v_add_u32 v19, s52, v19
    v_add_u32 v20, s52, v20
    v_add_u32 v21, s52, v21
    ds_read_b128 v[32:35], v18 offset:0
    s_waitcnt lgkmcnt(6)
    v_mfma_f32_16x16x32_bf16 v[64:67], v[40:43], a[104:107], v[64:67]
    global_load_lds_dwordx4 v15, s[40:41] offset:1024
    v_mfma_f32_16x16x32_bf16 v[68:71], v[40:43], a[108:111], v[68:71]
    ds_read_b128 v[36:39], v18 offset:16384
    s_waitcnt lgkmcnt(6)
    v_mfma_f32_16x16x32_bf16 v[72:75], v[44:47], a[104:107], v[72:75]
    v_mfma_f32_16x16x32_bf16 v[76:79], v[44:47], a[108:111], v[76:79]
    ds_read_b128 v[40:43], v19 offset:0
    s_waitcnt lgkmcnt(6)
    v_mfma_f32_16x16x32_bf16 v[64:67], v[48:51], a[112:115], v[64:67]
    global_load_lds_dwordx4 v16, s[40:41] offset:2048
    v_mfma_f32_16x16x32_bf16 v[68:71], v[48:51], a[116:119], v[68:71]
    ds_read_b128 v[44:47], v19 offset:16384
    s_waitcnt lgkmcnt(6)
    v_mfma_f32_16x16x32_bf16 v[72:75], v[52:55], a[112:115], v[72:75]
    v_mfma_f32_16x16x32_bf16 v[76:79], v[52:55], a[116:119], v[76:79]
    ds_read_b128 v[48:51], v20 offset:0
    s_waitcnt lgkmcnt(6)
    v_mfma_f32_16x16x32_bf16 v[64:67], v[56:59], a[120:123], v[64:67]
    global_load_lds_dwordx4 v17, s[40:41] offset:3072
    v_mfma_f32_16x16x32_bf16 v[68:71], v[56:59], a[124:127], v[68:71]
    ds_read_b128 v[52:55], v20 offset:16384
    s_waitcnt lgkmcnt(6)
    v_mfma_f32_16x16x32_bf16 v[72:75], v[60:63], a[120:123], v[72:75]
    v_mfma_f32_16x16x32_bf16 v[76:79], v[60:63], a[124:127], v[76:79]
    s_add_u32 s52, s33, 4
    s_cmp_lt_u32 s52, s35
    s_cselect_b32 s52, s43, 0
    s_add_u32 s38, s38, s52
    s_addc_u32 s39, s39, 0
    s_add_u32 s42, s42, 32768
    s_cmp_eq_u32 s42, 131072
    s_cselect_b32 s42, 0, s42
    s_add_u32 s33, s33, 1
    ds_read_b128 v[56:59], v21 offset:0
    s_waitcnt lgkmcnt(6)
    v_mfma_f32_16x16x32_bf16 v[80:83], v[32:35], a[0:3], 0
    v_mfma_f32_16x16x32_bf16 v[84:87], v[32:35], a[4:7], 0
    ds_read_b128 v[60:63], v21 offset:16384
    s_waitcnt lgkmcnt(6)
    v_mfma_f32_16x16x32_bf16 v[88:91], v[36:39], a[0:3], 0
    v_mfma_f32_16x16x32_bf16 v[92:95], v[36:39], a[4:7], 0
    ds_read_b128 v[32:35], v18 offset:256
    s_waitcnt lgkmcnt(6)
    v_mfma_f32_16x16x32_bf16 v[80:83], v[40:43], a[8:11], v[80:83]
    v_mfma_f32_16x16x32_bf16 v[84:87], v[40:43], a[12:15], v[84:87]
    ds_read_b128 v[36:39], v18 offset:16640
    s_waitcnt lgkmcnt(6)
    v_mfma_f32_16x16x32_bf16 v[88:91], v[44:47], a[8:11], v[88:91]
    v_mfma_f32_16x16x32_bf16 v[92:95], v[44:47], a[12:15], v[92:95]
    ds_read_b128 v[40:43], v19 offset:256
    s_waitcnt lgkmcnt(6)
    v_mfma_f32_16x16x32_bf16 v[80:83], v[48:51], a[16:19], v[80:83]
    v_cvt_pk_bf16_f32 v96, v64, v65
    v_cvt_pk_bf16_f32 v97, v66, v67
    v_mfma_f32_16x16x32_bf16 v[84:87], v[48:51], a[20:23], v[84:87]
    ds_read_b128 v[44:47], v19 offset:16640
    s_waitcnt lgkmcnt(6)
    v_mfma_f32_16x16x32_bf16 v[88:91], v[52:55], a[16:19], v[88:91]
    v_mfma_f32_16x16x32_bf16 v[92:95], v[52:55], a[20:23], v[92:95]
    ds_read_b128 v[48:51], v20 offset:256
    s_waitcnt lgkmcnt(6)
    v_mfma_f32_16x16x32_bf16 v[80:83], v[56:59], a[24:27], v[80:83]
    v_cvt_pk_bf16_f32 v98, v72, v73
    v_cvt_pk_bf16_f32 v99, v74, v75
    v_mfma_f32_16x16x32_bf16 v[84:87], v[56:59], a[28:31], v[84:87]
    ds_read_b128 v[52:55], v20 offset:16640
    s_waitcnt lgkmcnt(6)
    v_mfma_f32_16x16x32_bf16 v[88:91], v[60:63], a[24:27], v[88:91]
    v_mfma_f32_16x16x32_bf16 v[92:95], v[60:63], a[28:31], v[92:95]
    ds_read_b128 v[56:59], v21 offset:256
    s_waitcnt lgkmcnt(6)
    v_mfma_f32_16x16x32_bf16 v[80:83], v[32:35], a[32:35], v[80:83]
    v_cvt_pk_bf16_f32 v100, v68, v69
    v_cvt_pk_bf16_f32 v101, v70, v71
    v_mfma_f32_16x16x32_bf16 v[84:87], v[32:35], a[36:39], v[84:87]
    ds_read_b128 v[60:63], v21 offset:16640
    s_waitcnt lgkmcnt(6)
    v_mfma_f32_16x16x32_bf16 v[88:91], v[36:39], a[32:35], v[88:91]
    v_mfma_f32_16x16x32_bf16 v[92:95], v[36:39], a[36:39], v[92:95]
    ds_read_b128 v[32:35], v18 offset:512
    s_waitcnt lgkmcnt(6)
    v_mfma_f32_16x16x32_bf16 v[80:83], v[40:43], a[40:43], v[80:83]
    v_cvt_pk_bf16_f32 v102, v76, v77
    v_cvt_pk_bf16_f32 v103, v78, v79
    v_mfma_f32_16x16x32_bf16 v[84:87], v[40:43], a[44:47], v[84:87]
    ds_read_b128 v[36:39], v18 offset:16896
    s_waitcnt lgkmcnt(6)
    v_mfma_f32_16x16x32_bf16 v[88:91], v[44:47], a[40:43], v[88:91]
    v_mfma_f32_16x16x32_bf16 v[92:95], v[44:47], a[44:47], v[92:95]
    ds_read_b128 v[40:43], v19 offset:512
    s_waitcnt lgkmcnt(6)
    v_mfma_f32_16x16x32_bf16 v[80:83], v[48:51], a[48:51], v[80:83]
    global_store_dwordx4 v4, v[96:99], s[36:37] sc1
    v_mfma_f32_16x16x32_bf16 v[84:87], v[48:51], a[52:55], v[84:87]
    ds_read_b128 v[44:47], v19 offset:16896
    s_waitcnt lgkmcnt(6)
    v_mfma_f32_16x16x32_bf16 v[88:91], v[52:55], a[48:51], v[88:91]
    v_mfma_f32_16x16x32_bf16 v[92:95], v[52:55], a[52:55], v[92:95]
    ds_read_b128 v[48:51], v20 offset:512
    s_waitcnt lgkmcnt(6)
    v_mfma_f32_16x16x32_bf16 v[80:83], v[56:59], a[56:59], v[80:83]
    global_store_dwordx4 v9, v[100:103], s[36:37] sc1
    s_add_u32 s36, s36, s31
    s_addc_u32 s37, s37, 0
    s_cmp_eq_u32 s33, 0
    s_cselect_b64 s[36:37], s[44:45], s[36:37]
    v_mfma_f32_16x16x32_bf16 v[84:87], v[56:59], a[60:63], v[84:87]
    ds_read_b128 v[52:55], v20 offset:16896
    s_waitcnt lgkmcnt(6)
    v_mfma_f32_16x16x32_bf16 v[88:91], v[60:63], a[56:59], v[88:91]
    v_mfma_f32_16x16x32_bf16 v[92:95], v[60:63], a[60:63], v[92:95]
    s_waitcnt vmcnt(12)
    s_barrier
    s_sub_u32 s52, s33, 2
    s_max_i32 s52, s52, 0
    s_min_u32 s52, s52, 64
    v_mov_b32 v27, s52
    s_mov_b64 exec, s[86:87]
    global_store_dword v26, v27, s[2:3] sc1
    s_mov_b64 exec, -1
    s_lshl_b32 s51, s22, 13
    s_add_u32 s51, s51, s42
    s_mov_b32 m0, s51
    s_add_u32 s40, s38, 4096
    s_addc_u32 s41, s39, 0
    ds_read_b128 v[56:59], v21 offset:512
    s_waitcnt lgkmcnt(6)
    v_mfma_f32_16x16x32_bf16 v[80:83], v[32:35], a[64:67], v[80:83]
    global_load_lds_dwordx4 v10, s[38:39] offset:0
    v_mfma_f32_16x16x32_bf16 v[84:87], v[32:35], a[68:71], v[84:87]
    ds_read_b128 v[60:63], v21 offset:16896
    s_waitcnt lgkmcnt(6)
    v_mfma_f32_16x16x32_bf16 v[88:91], v[36:39], a[64:67], v[88:91]
    v_mfma_f32_16x16x32_bf16 v[92:95], v[36:39], a[68:71], v[92:95]
    ds_read_b128 v[32:35], v18 offset:768
    s_waitcnt lgkmcnt(6)
    v_mfma_f32_16x16x32_bf16 v[80:83], v[40:43], a[72:75], v[80:83]
    global_load_lds_dwordx4 v11, s[38:39] offset:1024
    v_mfma_f32_16x16x32_bf16 v[84:87], v[40:43], a[76:79], v[84:87]
    ds_read_b128 v[36:39], v18 offset:17152
    s_waitcnt lgkmcnt(6)
    v_mfma_f32_16x16x32_bf16 v[88:91], v[44:47], a[72:75], v[88:91]
    v_mfma_f32_16x16x32_bf16 v[92:95], v[44:47], a[76:79], v[92:95]
    ds_read_b128 v[40:43], v19 offset:768
    s_waitcnt lgkmcnt(6)
    v_mfma_f32_16x16x32_bf16 v[80:83], v[48:51], a[80:83], v[80:83]
    global_load_lds_dwordx4 v12, s[38:39] offset:2048
    v_mfma_f32_16x16x32_bf16 v[84:87], v[48:51], a[84:87], v[84:87]
    ds_read_b128 v[44:47], v19 offset:17152
    s_waitcnt lgkmcnt(6)
    v_mfma_f32_16x16x32_bf16 v[88:91], v[52:55], a[80:83], v[88:91]
    v_mfma_f32_16x16x32_bf16 v[92:95], v[52:55], a[84:87], v[92:95]
    ds_read_b128 v[48:51], v20 offset:768
    s_waitcnt lgkmcnt(6)
    v_mfma_f32_16x16x32_bf16 v[80:83], v[56:59], a[88:91], v[80:83]
    global_load_lds_dwordx4 v13, s[38:39] offset:3072
    v_mfma_f32_16x16x32_bf16 v[84:87], v[56:59], a[92:95], v[84:87]
    ds_read_b128 v[52:55], v20 offset:17152
    s_waitcnt lgkmcnt(6)
    v_mfma_f32_16x16x32_bf16 v[88:91], v[60:63], a[88:91], v[88:91]
    v_mfma_f32_16x16x32_bf16 v[92:95], v[60:63], a[92:95], v[92:95]
    ds_read_b128 v[56:59], v21 offset:768
    s_waitcnt lgkmcnt(6)
    v_mfma_f32_16x16x32_bf16 v[80:83], v[32:35], a[96:99], v[80:83]
    s_add_u32 s51, m0, 4096
    s_mov_b32 m0, s51
    s_nop 0
    global_load_lds_dwordx4 v14, s[40:41] offset:0
    v_mfma_f32_16x16x32_bf16 v[84:87], v[32:35], a[100:103], v[84:87]
    ds_read_b128 v[60:63], v21 offset:17152
    s_waitcnt lgkmcnt(6)
    v_mfma_f32_16x16x32_bf16 v[88:91], v[36:39], a[96:99], v[88:91]
    v_mfma_f32_16x16x32_bf16 v[92:95], v[36:39], a[100:103], v[92:95]
    s_add_u32 s34, s34, 32768
    s_cmp_eq_u32 s34, 131072
    s_cselect_b32 s52, -3, 1
    s_cselect_b32 s34, 0, s34
    s_lshl_b32 s52, s52, 15
    v_add_u32 v18, s52, v18
    v_add_u32 v19, s52, v19
    v_add_u32 v20, s52, v20
    v_add_u32 v21, s52, v21
    ds_read_b128 v[32:35], v18 offset:0
    s_waitcnt lgkmcnt(6)
    v_mfma_f32_16x16x32_bf16 v[80:83], v[40:43], a[104:107], v[80:83]
    global_load_lds_dwordx4 v15, s[40:41] offset:1024
    v_mfma_f32_16x16x32_bf16 v[84:87], v[40:43], a[108:111], v[84:87]
    ds_read_b128 v[36:39], v18 offset:16384
    s_waitcnt lgkmcnt(6)
    v_mfma_f32_16x16x32_bf16 v[88:91], v[44:47], a[104:107], v[88:91]
    v_mfma_f32_16x16x32_bf16 v[92:95], v[44:47], a[108:111], v[92:95]
    ds_read_b128 v[40:43], v19 offset:0
    s_waitcnt lgkmcnt(6)
    v_mfma_f32_16x16x32_bf16 v[80:83], v[48:51], a[112:115], v[80:83]
    global_load_lds_dwordx4 v16, s[40:41] offset:2048
    v_mfma_f32_16x16x32_bf16 v[84:87], v[48:51], a[116:119], v[84:87]
    ds_read_b128 v[44:47], v19 offset:16384
    s_waitcnt lgkmcnt(6)
    v_mfma_f32_16x16x32_bf16 v[88:91], v[52:55], a[112:115], v[88:91]
    v_mfma_f32_16x16x32_bf16 v[92:95], v[52:55], a[116:119], v[92:95]
    ds_read_b128 v[48:51], v20 offset:0
    s_waitcnt lgkmcnt(6)
    v_mfma_f32_16x16x32_bf16 v[80:83], v[56:59], a[120:123], v[80:83]
    global_load_lds_dwordx4 v17, s[40:41] offset:3072
    v_mfma_f32_16x16x32_bf16 v[84:87], v[56:59], a[124:127], v[84:87]
    ds_read_b128 v[52:55], v20 offset:16384
    s_waitcnt lgkmcnt(6)
    v_mfma_f32_16x16x32_bf16 v[88:91], v[60:63], a[120:123], v[88:91]
    v_mfma_f32_16x16x32_bf16 v[92:95], v[60:63], a[124:127], v[92:95]
    s_add_u32 s52, s33, 4
    s_cmp_lt_u32 s52, s35
    s_cselect_b32 s52, s43, 0
    s_add_u32 s38, s38, s52
    s_addc_u32 s39, s39, 0
    s_add_u32 s42, s42, 32768
    s_cmp_eq_u32 s42, 131072
    s_cselect_b32 s42, 0, s42
    s_add_u32 s33, s33, 1
    s_cmp_lt_u32 s33, s35
    s_cbranch_scc1 W1_top1
    s_nop 7
    v_cvt_pk_bf16_f32 v96, v80, v81
    v_cvt_pk_bf16_f32 v97, v82, v83
    v_cvt_pk_bf16_f32 v98, v88, v89
    v_cvt_pk_bf16_f32 v99, v90, v91
    v_cvt_pk_bf16_f32 v100, v84, v85
    v_cvt_pk_bf16_f32 v101, v86, v87
    v_cvt_pk_bf16_f32 v102, v92, v93
    v_cvt_pk_bf16_f32 v103, v94, v95
    global_store_dwordx4 v4, v[96:99], s[36:37] sc1
    global_store_dwordx4 v9, v[100:103], s[36:37] sc1
    s_branch W1_end
W1_top2:
    ds_read_b128 v[56:59], v21 offset:0
    s_waitcnt lgkmcnt(6)
    v_mfma_f32_16x16x32_bf16 v[64:67], a[0:3], v[32:35], 0
    v_mfma_f32_16x16x32_bf16 v[68:71], a[4:7], v[32:35], 0
    ds_read_b128 v[60:63], v21 offset:16384
    s_waitcnt lgkmcnt(6)
    v_mfma_f32_16x16x32_bf16 v[72:75], a[0:3], v[36:39], 0
    v_mfma_f32_16x16x32_bf16 v[76:79], a[4:7], v[36:39], 0
    ds_read_b128 v[32:35], v18 offset:256
    s_waitcnt lgkmcnt(6)
    v_mfma_f32_16x16x32_bf16 v[64:67], a[8:11], v[40:43], v[64:67]
    v_mfma_f32_16x16x32_bf16 v[68:71], a[12:15], v[40:43], v[68:71]
    ds_read_b128 v[36:39], v18 offset:16640
    s_waitcnt lgkmcnt(6)
    v_mfma_f32_16x16x32_bf16 v[72:75], a[8:11], v[44:47], v[72:75]
    v_mfma_f32_16x16x32_bf16 v[76:79], a[12:15], v[44:47], v[76:79]
    ds_read_b128 v[40:43], v19 offset:256
    s_waitcnt lgkmcnt(6)
    v_mfma_f32_16x16x32_bf16 v[64:67], a[16:19], v[48:51], v[64:67]
    v_cvt_pk_bf16_f32 v96, v80, v81
    v_cvt_pk_bf16_f32 v97, v82, v83
    v_mfma_f32_16x16x32_bf16 v[68:71], a[20:23], v[48:51], v[68:71]
    ds_read_b128 v[44:47], v19 offset:16640
    s_waitcnt lgkmcnt(6)
    v_mfma_f32_16x16x32_bf16 v[72:75], a[16:19], v[52:55], v[72:75]
    v_mfma_f32_16x16x32_bf16 v[76:79], a[20:23], v[52:55], v[76:79]
    ds_read_b128 v[48:51], v20 offset:256
    s_waitcnt lgkmcnt(6)
    v_mfma_f32_16x16x32_bf16 v[64:67], a[24:27], v[56:59], v[64:67]
    v_cvt_pk_bf16_f32 v98, v84, v85
    v_cvt_pk_bf16_f32 v99, v86, v87
    v_mfma_f32_16x16x32_bf16 v[68:71], a[28:31], v[56:59], v[68:71]
    ds_read_b128 v[52:55], v20 offset:16640
    s_waitcnt lgkmcnt(6)
    v_mfma_f32_16x16x32_bf16 v[72:75], a[24:27], v[60:63], v[72:75]
    v_mfma_f32_16x16x32_bf16 v[76:79], a[28:31], v[60:63], v[76:79]
    ds_read_b128 v[56:59], v21 offset:256
    s_waitcnt lgkmcnt(6)
    v_mfma_f32_16x16x32_bf16 v[64:67], a[32:35], v[32:35], v[64:67]
    v_cvt_pk_bf16_f32 v100, v88, v89
    v_cvt_pk_bf16_f32 v101, v90, v91
    v_mfma_f32_16x16x32_bf16 v[68:71], a[36:39], v[32:35], v[68:71]
    ds_read_b128 v[60:63], v21 offset:16640
    s_waitcnt lgkmcnt(6)
    v_mfma_f32_16x16x32_bf16 v[72:75], a[32:35], v[36:39], v[72:75]
    v_mfma_f32_16x16x32_bf16 v[76:79], a[36:39], v[36:39], v[76:79]
    ds_read_b128 v[32:35], v18 offset:512
    s_waitcnt lgkmcnt(6)
    v_mfma_f32_16x16x32_bf16 v[64:67], a[40:43], v[40:43], v[64:67]
    v_cvt_pk_bf16_f32 v102, v92, v93
    v_cvt_pk_bf16_f32 v103, v94, v95
    v_mfma_f32_16x16x32_bf16 v[68:71], a[44:47], v[40:43], v[68:71]
    ds_read_b128 v[36:39], v18 offset:16896
    s_waitcnt lgkmcnt(6)
    v_mfma_f32_16x16x32_bf16 v[72:75], a[40:43], v[44:47], v[72:75]
    v_mfma_f32_16x16x32_bf16 v[76:79], a[44:47], v[44:47], v[76:79]
    ds_read_b128 v[40:43], v19 offset:512
    s_waitcnt lgkmcnt(6)
    v_mfma_f32_16x16x32_bf16 v[64:67], a[48:51], v[48:51], v[64:67]
    global_store_dwordx4 v4, v[96:99], s[36:37]
    v_mfma_f32_16x16x32_bf16 v[68:71], a[52:55], v[48:51], v[68:71]
    ds_read_b128 v[44:47], v19 offset:16896
    s_waitcnt lgkmcnt(6)
    v_mfma_f32_16x16x32_bf16 v[72:75], a[48:51], v[52:55], v[72:75]
    v_mfma_f32_16x16x32_bf16 v[76:79], a[52:55], v[52:55], v[76:79]
    ds_read_b128 v[48:51], v20 offset:512
    s_waitcnt lgkmcnt(6)
    v_mfma_f32_16x16x32_bf16 v[64:67], a[56:59], v[56:59], v[64:67]
    global_store_dwordx4 v9, v[100:103], s[36:37]
    s_add_u32 s36, s36, s31
    s_addc_u32 s37, s37, 0
    s_cmp_eq_u32 s33, 0
    s_cselect_b64 s[36:37], s[44:45], s[36:37]
    v_mfma_f32_16x16x32_bf16 v[68:71], a[60:63], v[56:59], v[68:71]
    ds_read_b128 v[52:55], v20 offset:16896
    s_waitcnt lgkmcnt(6)
    v_mfma_f32_16x16x32_bf16 v[72:75], a[56:59], v[60:63], v[72:75]
    v_mfma_f32_16x16x32_bf16 v[76:79], a[60:63], v[60:63], v[76:79]
    s_waitcnt vmcnt(12)
    s_barrier
    s_sub_u32 s52, s33, 2
    s_max_i32 s52, s52, 0
    s_min_u32 s52, s52, 64
    v_mov_b32 v27, s52
    s_mov_b64 exec, s[86:87]
    global_store_dword v26, v27, s[2:3] sc1
    s_mov_b64 exec, -1
    s_lshl_b32 s51, s22, 13
    s_add_u32 s51, s51, s42
    s_mov_b32 m0, s51
    s_add_u32 s40, s38, 4096
    s_addc_u32 s41, s39, 0
    ds_read_b128 v[56:59], v21 offset:512
    s_waitcnt lgkmcnt(6)
    v_mfma_f32_16x16x32_bf16 v[64:67], a[64:67], v[32:35], v[64:67]
    global_load_lds_dwordx4 v10, s[38:39] offset:0
    v_mfma_f32_16x16x32_bf16 v[68:71], a[68:71], v[32:35], v[68:71]
    ds_read_b128 v[60:63], v21 offset:16896
    s_waitcnt lgkmcnt(6)
    v_mfma_f32_16x16x32_bf16 v[72:75], a[64:67], v[36:39], v[72:75]
    v_mfma_f32_16x16x32_bf16 v[76:79], a[68:71], v[36:39], v[76:79]
    ds_read_b128 v[32:35], v18 offset:768
    s_waitcnt lgkmcnt(6)
    v_mfma_f32_16x16x32_bf16 v[64:67], a[72:75], v[40:43], v[64:67]
    global_load_lds_dwordx4 v11, s[38:39] offset:1024
    v_mfma_f32_16x16x32_bf16 v[68:71], a[76:79], v[40:43], v[68:71]
    ds_read_b128 v[36:39], v18 offset:17152
    s_waitcnt lgkmcnt(6)
    v_mfma_f32_16x16x32_bf16 v[72:75], a[72:75], v[44:47], v[72:75]
    v_mfma_f32_16x16x32_bf16 v[76:79], a[76:79], v[44:47], v[76:79]
    ds_read_b128 v[40:43], v19 offset:768
    s_waitcnt lgkmcnt(6)
    v_mfma_f32_16x16x32_bf16 v[64:67], a[80:83], v[48:51], v[64:67]
    global_load_lds_dwordx4 v12, s[38:39] offset:2048
    v_mfma_f32_16x16x32_bf16 v[68:71], a[84:87], v[48:51], v[68:71]
    ds_read_b128 v[44:47], v19 offset:17152
    s_waitcnt lgkmcnt(6)
    v_mfma_f32_16x16x32_bf16 v[72:75], a[80:83], v[52:55], v[72:75]
    v_mfma_f32_16x16x32_bf16 v[76:79], a[84:87], v[52:55], v[76:79]
    ds_read_b128 v[48:51], v20 offset:768
    s_waitcnt lgkmcnt(6)
    v_mfma_f32_16x16x32_bf16 v[64:67], a[88:91], v[56:59], v[64:67]
    global_load_lds_dwordx4 v13, s[38:39] offset:3072
    v_mfma_f32_16x16x32_bf16 v[68:71], a[92:95], v[56:59], v[68:71]
    ds_read_b128 v[52:55], v20 offset:17152
    s_waitcnt lgkmcnt(6)
    v_mfma_f32_16x16x32_bf16 v[72:75], a[88:91], v[60:63], v[72:75]
    v_mfma_f32_16x16x32_bf16 v[76:79], a[92:95], v[60:63], v[76:79]
    ds_read_b128 v[56:59], v21 offset:768
    s_waitcnt lgkmcnt(6)
    v_mfma_f32_16x16x32_bf16 v[64:67], a[96:99], v[32:35], v[64:67]
    s_add_u32 s51, m0, 4096
    s_mov_b32 m0, s51
    s_nop 0
    global_load_lds_dwordx4 v14, s[40:41] offset:0
    v_mfma_f32_16x16x32_bf16 v[68:71], a[100:103], v[32:35], v[68:71]
    ds_read_b128 v[60:63], v21 offset:17152
    s_waitcnt lgkmcnt(6)
    v_mfma_f32_16x16x32_bf16 v[72:75], a[96:99], v[36:39], v[72:75]
    v_mfma_f32_16x16x32_bf16 v[76:79], a[100:103], v[36:39], v[76:79]
    s_add_u32 s34, s34, 32768
    s_cmp_eq_u32 s34, 131072
    s_cselect_b32 s52, -3, 1
    s_cselect_b32 s34, 0, s34
    s_lshl_b32 s52, s52, 15
    v_add_u32 v18, s52, v18
    v_add_u32 v19, s52, v19
    v_add_u32 v20, s52, v20
    v_add_u32 v21, s52, v21
    ds_read_b128 v[32:35], v18 offset:0
    s_waitcnt lgkmcnt(6)
    v_mfma_f32_16x16x32_bf16 v[64:67], a[104:107], v[40:43], v[64:67]
    global_load_lds_dwordx4 v15, s[40:41] offset:1024
    v_mfma_f32_16x16x32_bf16 v[68:71], a[108:111], v[40:43], v[68:71]
    ds_read_b128 v[36:39], v18 offset:16384
    s_waitcnt lgkmcnt(6)
    v_mfma_f32_16x16x32_bf16 v[72:75], a[104:107], v[44:47], v[72:75]
    v_mfma_f32_16x16x32_bf16 v[76:79], a[108:111], v[44:47], v[76:79]
    ds_read_b128 v[40:43], v19 offset:0
    s_waitcnt lgkmcnt(6)
    v_mfma_f32_16x16x32_bf16 v[64:67], a[112:115], v[48:51], v[64:67]
    global_load_lds_dwordx4 v16, s[40:41] offset:2048
    v_mfma_f32_16x16x32_bf16 v[68:71], a[116:119], v[48:51], v[68:71]
    ds_read_b128 v[44:47], v19 offset:16384
    s_waitcnt lgkmcnt(6)
    v_mfma_f32_16x16x32_bf16 v[72:75], a[112:115], v[52:55], v[72:75]
    v_mfma_f32_16x16x32_bf16 v[76:79], a[116:119], v[52:55], v[76:79]
    ds_read_b128 v[48:51], v20 offset:0
    s_waitcnt lgkmcnt(6)
    v_mfma_f32_16x16x32_bf16 v[64:67], a[120:123], v[56:59], v[64:67]
    global_load_lds_dwordx4 v17, s[40:41] offset:3072
    v_mfma_f32_16x16x32_bf16 v[68:71], a[124:127], v[56:59], v[68:71]
    ds_read_b128 v[52:55], v20 offset:16384
    s_waitcnt lgkmcnt(6)
    v_mfma_f32_16x16x32_bf16 v[72:75], a[120:123], v[60:63], v[72:75]
    v_mfma_f32_16x16x32_bf16 v[76:79], a[124:127], v[60:63], v[76:79]
    s_add_u32 s52, s33, 4
    s_cmp_lt_u32 s52, s35
    s_cselect_b32 s52, s43, 0
    s_add_u32 s38, s38, s52
    s_addc_u32 s39, s39, 0
    s_add_u32 s42, s42, 32768
    s_cmp_eq_u32 s42, 131072
    s_cselect_b32 s42, 0, s42
    s_add_u32 s33, s33, 1
    ds_read_b128 v[56:59], v21 offset:0
    s_waitcnt lgkmcnt(6)
    v_mfma_f32_16x16x32_bf16 v[80:83], a[0:3], v[32:35], 0
    v_mfma_f32_16x16x32_bf16 v[84:87], a[4:7], v[32:35], 0
    ds_read_b128 v[60:63], v21 offset:16384
    s_waitcnt lgkmcnt(6)
    v_mfma_f32_16x16x32_bf16 v[88:91], a[0:3], v[36:39], 0
    v_mfma_f32_16x16x32_bf16 v[92:95], a[4:7], v[36:39], 0
    ds_read_b128 v[32:35], v18 offset:256
    s_waitcnt lgkmcnt(6)
    v_mfma_f32_16x16x32_bf16 v[80:83], a[8:11], v[40:43], v[80:83]
    v_mfma_f32_16x16x32_bf16 v[84:87], a[12:15], v[40:43], v[84:87]
    ds_read_b128 v[36:39], v18 offset:16640
    s_waitcnt lgkmcnt(6)
    v_mfma_f32_16x16x32_bf16 v[88:91], a[8:11], v[44:47], v[88:91]
    v_mfma_f32_16x16x32_bf16 v[92:95], a[12:15], v[44:47], v[92:95]
    ds_read_b128 v[40:43], v19 offset:256
    s_waitcnt lgkmcnt(6)
    v_mfma_f32_16x16x32_bf16 v[80:83], a[16:19], v[48:51], v[80:83]
    v_cvt_pk_bf16_f32 v96, v64, v65
    v_cvt_pk_bf16_f32 v97, v66, v67
    v_mfma_f32_16x16x32_bf16 v[84:87], a[20:23], v[48:51], v[84:87]
    ds_read_b128 v[44:47], v19 offset:16640
    s_waitcnt lgkmcnt(6)
    v_mfma_f32_16x16x32_bf16 v[88:91], a[16:19], v[52:55], v[88:91]
    v_mfma_f32_16x16x32_bf16 v[92:95], a[20:23], v[52:55], v[92:95]
    ds_read_b128 v[48:51], v20 offset:256
    s_waitcnt lgkmcnt(6)
    v_mfma_f32_16x16x32_bf16 v[80:83], a[24:27], v[56:59], v[80:83]
    v_cvt_pk_bf16_f32 v98, v68, v69
    v_cvt_pk_bf16_f32 v99, v70, v71
    v_mfma_f32_16x16x32_bf16 v[84:87], a[28:31], v[56:59], v[84:87]
    ds_read_b128 v[52:55], v20 offset:16640
    s_waitcnt lgkmcnt(6)
    v_mfma_f32_16x16x32_bf16 v[88:91], a[24:27], v[60:63], v[88:91]
    v_mfma_f32_16x16x32_bf16 v[92:95], a[28:31], v[60:63], v[92:95]
    ds_read_b128 v[56:59], v21 offset:256
    s_waitcnt lgkmcnt(6)
    v_mfma_f32_16x16x32_bf16 v[80:83], a[32:35], v[32:35], v[80:83]
    v_cvt_pk_bf16_f32 v100, v72, v73
    v_cvt_pk_bf16_f32 v101, v74, v75
    v_mfma_f32_16x16x32_bf16 v[84:87], a[36:39], v[32:35], v[84:87]
    ds_read_b128 v[60:63], v21 offset:16640
    s_waitcnt lgkmcnt(6)
    v_mfma_f32_16x16x32_bf16 v[88:91], a[32:35], v[36:39], v[88:91]
    v_mfma_f32_16x16x32_bf16 v[92:95], a[36:39], v[36:39], v[92:95]
    ds_read_b128 v[32:35], v18 offset:512
    s_waitcnt lgkmcnt(6)
    v_mfma_f32_16x16x32_bf16 v[80:83], a[40:43], v[40:43], v[80:83]
    v_cvt_pk_bf16_f32 v102, v76, v77
    v_cvt_pk_bf16_f32 v103, v78, v79
    v_mfma_f32_16x16x32_bf16 v[84:87], a[44:47], v[40:43], v[84:87]
    ds_read_b128 v[36:39], v18 offset:16896
    s_waitcnt lgkmcnt(6)
    v_mfma_f32_16x16x32_bf16 v[88:91], a[40:43], v[44:47], v[88:91]
    v_mfma_f32_16x16x32_bf16 v[92:95], a[44:47], v[44:47], v[92:95]
    ds_read_b128 v[40:43], v19 offset:512
    s_waitcnt lgkmcnt(6)
    v_mfma_f32_16x16x32_bf16 v[80:83], a[48:51], v[48:51], v[80:83]
    global_store_dwordx4 v4, v[96:99], s[36:37]
    v_mfma_f32_16x16x32_bf16 v[84:87], a[52:55], v[48:51], v[84:87]
    ds_read_b128 v[44:47], v19 offset:16896
    s_waitcnt lgkmcnt(6)
    v_mfma_f32_16x16x32_bf16 v[88:91], a[48:51], v[52:55], v[88:91]
    v_mfma_f32_16x16x32_bf16 v[92:95], a[52:55], v[52:55], v[92:95]
    ds_read_b128 v[48:51], v20 offset:512
    s_waitcnt lgkmcnt(6)
    v_mfma_f32_16x16x32_bf16 v[80:83], a[56:59], v[56:59], v[80:83]
    global_store_dwordx4 v9, v[100:103], s[36:37]
    s_add_u32 s36, s36, s31
    s_addc_u32 s37, s37, 0
    s_cmp_eq_u32 s33, 0
    s_cselect_b64 s[36:37], s[44:45], s[36:37]
    v_mfma_f32_16x16x32_bf16 v[84:87], a[60:63], v[56:59], v[84:87]
    ds_read_b128 v[52:55], v20 offset:16896
    s_waitcnt lgkmcnt(6)
    v_mfma_f32_16x16x32_bf16 v[88:91], a[56:59], v[60:63], v[88:91]
    v_mfma_f32_16x16x32_bf16 v[92:95], a[60:63], v[60:63], v[92:95]
    s_waitcnt vmcnt(12)
    s_barrier
    s_sub_u32 s52, s33, 2
    s_max_i32 s52, s52, 0
    s_min_u32 s52, s52, 64
    v_mov_b32 v27, s52
    s_mov_b64 exec, s[86:87]
    global_store_dword v26, v27, s[2:3] sc1
    s_mov_b64 exec, -1
    s_lshl_b32 s51, s22, 13
    s_add_u32 s51, s51, s42
    s_mov_b32 m0, s51
    s_add_u32 s40, s38, 4096
    s_addc_u32 s41, s39, 0
    ds_read_b128 v[56:59], v21 offset:512
    s_waitcnt lgkmcnt(6)
    v_mfma_f32_16x16x32_bf16 v[80:83], a[64:67], v[32:35], v[80:83]
    global_load_lds_dwordx4 v10, s[38:39] offset:0
    v_mfma_f32_16x16x32_bf16 v[84:87], a[68:71], v[32:35], v[84:87]
    ds_read_b128 v[60:63], v21 offset:16896
    s_waitcnt lgkmcnt(6)
    v_mfma_f32_16x16x32_bf16 v[88:91], a[64:67], v[36:39], v[88:91]
    v_mfma_f32_16x16x32_bf16 v[92:95], a[68:71], v[36:39], v[92:95]
    ds_read_b128 v[32:35], v18 offset:768
    s_waitcnt lgkmcnt(6)
    v_mfma_f32_16x16x32_bf16 v[80:83], a[72:75], v[40:43], v[80:83]
    global_load_lds_dwordx4 v11, s[38:39] offset:1024
    v_mfma_f32_16x16x32_bf16 v[84:87], a[76:79], v[40:43], v[84:87]
    ds_read_b128 v[36:39], v18 offset:17152
    s_waitcnt lgkmcnt(6)
    v_mfma_f32_16x16x32_bf16 v[88:91], a[72:75], v[44:47], v[88:91]
    v_mfma_f32_16x16x32_bf16 v[92:95], a[76:79], v[44:47], v[92:95]
    ds_read_b128 v[40:43], v19 offset:768
    s_waitcnt lgkmcnt(6)
    v_mfma_f32_16x16x32_bf16 v[80:83], a[80:83], v[48:51], v[80:83]
    global_load_lds_dwordx4 v12, s[38:39] offset:2048
    v_mfma_f32_16x16x32_bf16 v[84:87], a[84:87], v[48:51], v[84:87]
    ds_read_b128 v[44:47], v19 offset:17152
    s_waitcnt lgkmcnt(6)
    v_mfma_f32_16x16x32_bf16 v[88:91], a[80:83], v[52:55], v[88:91]
    v_mfma_f32_16x16x32_bf16 v[92:95], a[84:87], v[52:55], v[92:95]
    ds_read_b128 v[48:51], v20 offset:768
    s_waitcnt lgkmcnt(6)
    v_mfma_f32_16x16x32_bf16 v[80:83], a[88:91], v[56:59], v[80:83]
    global_load_lds_dwordx4 v13, s[38:39] offset:3072
    v_mfma_f32_16x16x32_bf16 v[84:87], a[92:95], v[56:59], v[84:87]
    ds_read_b128 v[52:55], v20 offset:17152
    s_waitcnt lgkmcnt(6)
    v_mfma_f32_16x16x32_bf16 v[88:91], a[88:91], v[60:63], v[88:91]
    v_mfma_f32_16x16x32_bf16 v[92:95], a[92:95], v[60:63], v[92:95]
    ds_read_b128 v[56:59], v21 offset:768
    s_waitcnt lgkmcnt(6)
    v_mfma_f32_16x16x32_bf16 v[80:83], a[96:99], v[32:35], v[80:83]
    s_add_u32 s51, m0, 4096
    s_mov_b32 m0, s51
    s_nop 0
    global_load_lds_dwordx4 v14, s[40:41] offset:0
    v_mfma_f32_16x16x32_bf16 v[84:87], a[100:103], v[32:35], v[84:87]
    ds_read_b128 v[60:63], v21 offset:17152
    s_waitcnt lgkmcnt(6)
    v_mfma_f32_16x16x32_bf16 v[88:91], a[96:99], v[36:39], v[88:91]
    v_mfma_f32_16x16x32_bf16 v[92:95], a[100:103], v[36:39], v[92:95]
    s_add_u32 s34, s34, 32768
    s_cmp_eq_u32 s34, 131072
    s_cselect_b32 s52, -3, 1
    s_cselect_b32 s34, 0, s34
    s_lshl_b32 s52, s52, 15
    v_add_u32 v18, s52, v18
    v_add_u32 v19, s52, v19
    v_add_u32 v20, s52, v20
    v_add_u32 v21, s52, v21
    ds_read_b128 v[32:35], v18 offset:0
    s_waitcnt lgkmcnt(6)
    v_mfma_f32_16x16x32_bf16 v[80:83], a[104:107], v[40:43], v[80:83]
    global_load_lds_dwordx4 v15, s[40:41] offset:1024
    v_mfma_f32_16x16x32_bf16 v[84:87], a[108:111], v[40:43], v[84:87]
    ds_read_b128 v[36:39], v18 offset:16384
    s_waitcnt lgkmcnt(6)
    v_mfma_f32_16x16x32_bf16 v[88:91], a[104:107], v[44:47], v[88:91]
    v_mfma_f32_16x16x32_bf16 v[92:95], a[108:111], v[44:47], v[92:95]
    ds_read_b128 v[40:43], v19 offset:0
    s_waitcnt lgkmcnt(6)
    v_mfma_f32_16x16x32_bf16 v[80:83], a[112:115], v[48:51], v[80:83]
    global_load_lds_dwordx4 v16, s[40:41] offset:2048
    v_mfma_f32_16x16x32_bf16 v[84:87], a[116:119], v[48:51], v[84:87]
    ds_read_b128 v[44:47], v19 offset:16384
    s_waitcnt lgkmcnt(6)
    v_mfma_f32_16x16x32_bf16 v[88:91], a[112:115], v[52:55], v[88:91]
    v_mfma_f32_16x16x32_bf16 v[92:95], a[116:119], v[52:55], v[92:95]
    ds_read_b128 v[48:51], v20 offset:0
    s_waitcnt lgkmcnt(6)
    v_mfma_f32_16x16x32_bf16 v[80:83], a[120:123], v[56:59], v[80:83]
    global_load_lds_dwordx4 v17, s[40:41] offset:3072
    v_mfma_f32_16x16x32_bf16 v[84:87], a[124:127], v[56:59], v[84:87]
    ds_read_b128 v[52:55], v20 offset:16384
    s_waitcnt lgkmcnt(6)
    v_mfma_f32_16x16x32_bf16 v[88:91], a[120:123], v[60:63], v[88:91]
    v_mfma_f32_16x16x32_bf16 v[92:95], a[124:127], v[60:63], v[92:95]
    s_add_u32 s52, s33, 4
    s_cmp_lt_u32 s52, s35
    s_cselect_b32 s52, s43, 0
    s_add_u32 s38, s38, s52
    s_addc_u32 s39, s39, 0
    s_add_u32 s42, s42, 32768
    s_cmp_eq_u32 s42, 131072
    s_cselect_b32 s42, 0, s42
    s_add_u32 s33, s33, 1
    s_cmp_lt_u32 s33, s35
    s_cbranch_scc1 W1_top2
    s_nop 7
    v_cvt_pk_bf16_f32 v96, v80, v81
    v_cvt_pk_bf16_f32 v97, v82, v83
    v_cvt_pk_bf16_f32 v98, v84, v85
    v_cvt_pk_bf16_f32 v99, v86, v87
    v_cvt_pk_bf16_f32 v100, v88, v89
    v_cvt_pk_bf16_f32 v101, v90, v91
    v_cvt_pk_bf16_f32 v102, v92, v93
    v_cvt_pk_bf16_f32 v103, v94, v95
    global_store_dwordx4 v4, v[96:99], s[36:37]
    global_store_dwordx4 v9, v[100:103], s[36:37]
    s_branch W1_end
W1_end:
    s_waitcnt vmcnt(0) lgkmcnt(0)
    s_barrier
    s_cmp_lt_u32 s26, 64
    s_cbranch_scc1 PH1_REL
    s_cmp_lg_u32 s22, 0
    s_cbranch_scc1 PH1_REL
    buffer_wbl2 sc1
    s_waitcnt vmcnt(0)
PH1_REL:
    v_mov_b32 v27, 64
    s_mov_b64 exec, s[86:87]
    global_store_dword v26, v27, s[2:3] sc1
    s_mov_b64 exec, -1
    s_branch PH1_DONE
PH1_GATE:
    s_sub_u32 s26, s26, 152
    s_lshl_b32 s26, s26, 4
    s_lshl_b32 s51, s22, 2
    s_add_u32 s26, s26, s51
    s_add_u32 s43, s26, 4
PH1_GL:
    v_mbcnt_lo_u32_b32 v1, -1, 0
    v_mbcnt_hi_u32_b32 v1, -1, v1
    v_and_b32 v2, 15, v1
    v_lshrrev_b32 v3, 4, v1
    v_lshlrev_b32 v4, 8, v3
    v_lshl_add_u32 v5, v2, 10, v4
    s_lshl_b32 s51, s26, 14
    s_add_u32 s28, s74, s51
    s_addc_u32 s29, s75, 0
    global_load_dwordx4 v[8:11], v5, s[28:29] offset:0
    global_load_dwordx4 v[12:15], v5, s[28:29] offset:16
    global_load_dwordx4 v[16:19], v5, s[28:29] offset:32
    global_load_dwordx4 v[20:23], v5, s[28:29] offset:48
    global_load_dwordx4 v[24:27], v5, s[28:29] offset:64
    global_load_dwordx4 v[28:31], v5, s[28:29] offset:80
    global_load_dwordx4 v[32:35], v5, s[28:29] offset:96
    global_load_dwordx4 v[36:39], v5, s[28:29] offset:112
    global_load_dwordx4 v[40:43], v5, s[28:29] offset:128
    global_load_dwordx4 v[44:47], v5, s[28:29] offset:144
    global_load_dwordx4 v[48:51], v5, s[28:29] offset:160
    global_load_dwordx4 v[52:55], v5, s[28:29] offset:176
    global_load_dwordx4 v[56:59], v5, s[28:29] offset:192
    global_load_dwordx4 v[60:63], v5, s[28:29] offset:208
    global_load_dwordx4 v[64:67], v5, s[28:29] offset:224
    global_load_dwordx4 v[68:71], v5, s[28:29] offset:240
    global_load_dwordx4 v[72:75], v4, s[80:81] offset:0
    global_load_dwordx4 v[76:79], v4, s[80:81] offset:16
    global_load_dwordx4 v[80:83], v4, s[80:81] offset:32
    global_load_dwordx4 v[84:87], v4, s[80:81] offset:48
    global_load_dwordx4 v[88:91], v4, s[80:81] offset:64
    global_load_dwordx4 v[92:95], v4, s[80:81] offset:80
    global_load_dwordx4 v[96:99], v4, s[80:81] offset:96
    global_load_dwordx4 v[100:103], v4, s[80:81] offset:112
    global_load_dwordx4 v[104:107], v4, s[80:81] offset:128
    global_load_dwordx4 v[108:111], v4, s[80:81] offset:144
    global_load_dwordx4 v[112:115], v4, s[80:81] offset:160
    global_load_dwordx4 v[116:119], v4, s[80:81] offset:176
    global_load_dwordx4 v[120:123], v4, s[80:81] offset:192
    global_load_dwordx4 v[124:127], v4, s[80:81] offset:208
    global_load_dwordx4 v[128:131], v4, s[80:81] offset:224
    global_load_dwordx4 v[132:135], v4, s[80:81] offset:240
    v_mov_b32 v6, 0
    v_mov_b32 v7, 0
    s_waitcnt vmcnt(0)
    v_dot2c_f32_bf16 v6, v8, v72
    v_dot2c_f32_bf16 v7, v9, v73
    v_dot2c_f32_bf16 v6, v10, v74
    v_dot2c_f32_bf16 v7, v11, v75
    v_dot2c_f32_bf16 v6, v12, v76
    v_dot2c_f32_bf16 v7, v13, v77
    v_dot2c_f32_bf16 v6, v14, v78
    v_dot2c_f32_bf16 v7, v15, v79
    v_dot2c_f32_bf16 v6, v16, v80
    v_dot2c_f32_bf16 v7, v17, v81
    v_dot2c_f32_bf16 v6, v18, v82
    v_dot2c_f32_bf16 v7, v19, v83
    v_dot2c_f32_bf16 v6, v20, v84
    v_dot2c_f32_bf16 v7, v21, v85
    v_dot2c_f32_bf16 v6, v22, v86
    v_dot2c_f32_bf16 v7, v23, v87
    v_dot2c_f32_bf16 v6, v24, v88
    v_dot2c_f32_bf16 v7, v25, v89
    v_dot2c_f32_bf16 v6, v26, v90
    v_dot2c_f32_bf16 v7, v27, v91
    v_dot2c_f32_bf16 v6, v28, v92
    v_dot2c_f32_bf16 v7, v29, v93
    v_dot2c_f32_bf16 v6, v30, v94
    v_dot2c_f32_bf16 v7, v31, v95
    v_dot2c_f32_bf16 v6, v32, v96
    v_dot2c_f32_bf16 v7, v33, v97
    v_dot2c_f32_bf16 v6, v34, v98
    v_dot2c_f32_bf16 v7, v35, v99
    v_dot2c_f32_bf16 v6, v36, v100
    v_dot2c_f32_bf16 v7, v37, v101
    v_dot2c_f32_bf16 v6, v38, v102
    v_dot2c_f32_bf16 v7, v39, v103
    v_dot2c_f32_bf16 v6, v40, v104
    v_dot2c_f32_bf16 v7, v41, v105
    v_dot2c_f32_bf16 v6, v42, v106
    v_dot2c_f32_bf16 v7, v43, v107
    v_dot2c_f32_bf16 v6, v44, v108
    v_dot2c_f32_bf16 v7, v45, v109
    v_dot2c_f32_bf16 v6, v46, v110
    v_dot2c_f32_bf16 v7, v47, v111
    v_dot2c_f32_bf16 v6, v48, v112
    v_dot2c_f32_bf16 v7, v49, v113
    v_dot2c_f32_bf16 v6, v50, v114
    v_dot2c_f32_bf16 v7, v51, v115
    v_dot2c_f32_bf16 v6, v52, v116
    v_dot2c_f32_bf16 v7, v53, v117
    v_dot2c_f32_bf16 v6, v54, v118
    v_dot2c_f32_bf16 v7, v55, v119
    v_dot2c_f32_bf16 v6, v56, v120
    v_dot2c_f32_bf16 v7, v57, v121
    v_dot2c_f32_bf16 v6, v58, v122
    v_dot2c_f32_bf16 v7, v59, v123
    v_dot2c_f32_bf16 v6, v60, v124
    v_dot2c_f32_bf16 v7, v61, v125
    v_dot2c_f32_bf16 v6, v62, v126
    v_dot2c_f32_bf16 v7, v63, v127
    v_dot2c_f32_bf16 v6, v64, v128
    v_dot2c_f32_bf16 v7, v65, v129
    v_dot2c_f32_bf16 v6, v66, v130
    v_dot2c_f32_bf16 v7, v67, v131
    v_dot2c_f32_bf16 v6, v68, v132
    v_dot2c_f32_bf16 v7, v69, v133
    v_dot2c_f32_bf16 v6, v70, v134
    v_dot2c_f32_bf16 v7, v71, v135
    s_nop 2
    v_add_f32 v6, v6, v7
    v_mov_b32 v7, v6
    s_nop 1
    v_permlane16_swap_b32 v6, v7
    v_add_f32 v6, v6, v7
    v_mov_b32 v7, v6
    s_nop 1
    v_permlane32_swap_b32 v6, v7
    v_add_f32 v6, v6, v7
    v_mul_f32 v6, 0xbfb8aa3b, v6
    v_exp_f32 v6, v6
    s_nop 0
    v_add_f32 v6, 1.0, v6
    v_rcp_f32 v6, v6
    s_lshl_b32 s51, s26, 6
    s_add_u32 s51, s51, 87097344
    s_add_u32 s28, s16, s51
    s_addc_u32 s29, s17, 0
    v_lshlrev_b32 v2, 2, v2
    s_mov_b64 exec, 0xffff
    global_store_dword v2, v6, s[28:29] sc1
    s_mov_b64 exec, -1
    s_add_u32 s26, s26, 1
    s_cmp_lt_u32 s26, s43
    s_cbranch_scc1 PH1_GL
    s_sub_u32 s26, s26, 1
    s_lshr_b32 s26, s26, 2
    v_mbcnt_lo_u32_b32 v1, -1, 0
    v_mbcnt_hi_u32_b32 v1, -1, v1
    v_lshlrev_b32 v1, 4, v1
    v_mov_b32 v8, -1
    v_mov_b32 v9, -1
    v_mov_b32 v10, -1
    v_mov_b32 v11, -1
    s_lshl_b32 s51, s26, 12
    s_add_u32 s51, s51, 78446592
    s_add_u32 s28, s16, s51
    s_addc_u32 s29, s17, 0
    global_store_dwordx4 v1, v[8:11], s[28:29] offset:0 sc1
    global_store_dwordx4 v1, v[8:11], s[28:29] offset:1024 sc1
    global_store_dwordx4 v1, v[8:11], s[28:29] offset:2048 sc1
    global_store_dwordx4 v1, v[8:11], s[28:29] offset:3072 sc1
    s_lshl_b32 s51, s26, 12
    s_add_u32 s51, s51, 78594048
    s_add_u32 s28, s16, s51
    s_addc_u32 s29, s17, 0
    global_store_dwordx4 v1, v[8:11], s[28:29] offset:0 sc1
    global_store_dwordx4 v1, v[8:11], s[28:29] offset:1024 sc1
    global_store_dwordx4 v1, v[8:11], s[28:29] offset:2048 sc1
    global_store_dwordx4 v1, v[8:11], s[28:29] offset:3072 sc1
    s_lshl_b32 s51, s26, 12
    s_add_u32 s51, s51, 78741504
    s_add_u32 s28, s16, s51
    s_addc_u32 s29, s17, 0
    global_store_dwordx4 v1, v[8:11], s[28:29] offset:0 sc1
    global_store_dwordx4 v1, v[8:11], s[28:29] offset:1024 sc1
    global_store_dwordx4 v1, v[8:11], s[28:29] offset:2048 sc1
    global_store_dwordx4 v1, v[8:11], s[28:29] offset:3072 sc1
    s_lshl_b32 s51, s26, 12
    s_add_u32 s51, s51, 78888960
    s_add_u32 s28, s16, s51
    s_addc_u32 s29, s17, 0
    global_store_dwordx4 v1, v[8:11], s[28:29] offset:0 sc1
    global_store_dwordx4 v1, v[8:11], s[28:29] offset:1024 sc1
    global_store_dwordx4 v1, v[8:11], s[28:29] offset:2048 sc1
    global_store_dwordx4 v1, v[8:11], s[28:29] offset:3072 sc1
    s_lshl_b32 s51, s26, 12
    s_add_u32 s51, s51, 79036416
    s_add_u32 s28, s16, s51
    s_addc_u32 s29, s17, 0
    global_store_dwordx4 v1, v[8:11], s[28:29] offset:0 sc1
    global_store_dwordx4 v1, v[8:11], s[28:29] offset:1024 sc1
    global_store_dwordx4 v1, v[8:11], s[28:29] offset:2048 sc1
    global_store_dwordx4 v1, v[8:11], s[28:29] offset:3072 sc1
    s_lshl_b32 s51, s26, 12
    s_add_u32 s51, s51, 79183872
    s_add_u32 s28, s16, s51
    s_addc_u32 s29, s17, 0
    global_store_dwordx4 v1, v[8:11], s[28:29] offset:0 sc1
    global_store_dwordx4 v1, v[8:11], s[28:29] offset:1024 sc1
    global_store_dwordx4 v1, v[8:11], s[28:29] offset:2048 sc1
    global_store_dwordx4 v1, v[8:11], s[28:29] offset:3072 sc1
    s_lshl_b32 s51, s26, 12
    s_add_u32 s51, s51, 79331328
    s_add_u32 s28, s16, s51
    s_addc_u32 s29, s17, 0
    global_store_dwordx4 v1, v[8:11], s[28:29] offset:0 sc1
    global_store_dwordx4 v1, v[8:11], s[28:29] offset:1024 sc1
    global_store_dwordx4 v1, v[8:11], s[28:29] offset:2048 sc1
    global_store_dwordx4 v1, v[8:11], s[28:29] offset:3072 sc1
    s_lshl_b32 s51, s26, 12
    s_add_u32 s51, s51, 79478784
    s_add_u32 s28, s16, s51
    s_addc_u32 s29, s17, 0
    global_store_dwordx4 v1, v[8:11], s[28:29] offset:0 sc1
    global_store_dwordx4 v1, v[8:11], s[28:29] offset:1024 sc1
    global_store_dwordx4 v1, v[8:11], s[28:29] offset:2048 sc1
    global_store_dwordx4 v1, v[8:11], s[28:29] offset:3072 sc1
    s_lshl_b32 s51, s26, 12
    s_add_u32 s51, s51, 79626240
    s_add_u32 s28, s16, s51
    s_addc_u32 s29, s17, 0
    global_store_dwordx4 v1, v[8:11], s[28:29] offset:0 sc1
    global_store_dwordx4 v1, v[8:11], s[28:29] offset:1024 sc1
    global_store_dwordx4 v1, v[8:11], s[28:29] offset:2048 sc1
    global_store_dwordx4 v1, v[8:11], s[28:29] offset:3072 sc1
    s_lshl_b32 s51, s26, 12
    s_add_u32 s51, s51, 79773696
    s_add_u32 s28, s16, s51
    s_addc_u32 s29, s17, 0
    global_store_dwordx4 v1, v[8:11], s[28:29] offset:0 sc1
    global_store_dwordx4 v1, v[8:11], s[28:29] offset:1024 sc1
    global_store_dwordx4 v1, v[8:11], s[28:29] offset:2048 sc1
    global_store_dwordx4 v1, v[8:11], s[28:29] offset:3072 sc1
    s_lshl_b32 s51, s26, 12
    s_add_u32 s51, s51, 79921152
    s_add_u32 s28, s16, s51
    s_addc_u32 s29, s17, 0
    global_store_dwordx4 v1, v[8:11], s[28:29] offset:0 sc1
    global_store_dwordx4 v1, v[8:11], s[28:29] offset:1024 sc1
    global_store_dwordx4 v1, v[8:11], s[28:29] offset:2048 sc1
    global_store_dwordx4 v1, v[8:11], s[28:29] offset:3072 sc1
    s_lshl_b32 s51, s26, 12
    s_add_u32 s51, s51, 80068608
    s_add_u32 s28, s16, s51
    s_addc_u32 s29, s17, 0
    global_store_dwordx4 v1, v[8:11], s[28:29] offset:0 sc1
    global_store_dwordx4 v1, v[8:11], s[28:29] offset:1024 sc1
    global_store_dwordx4 v1, v[8:11], s[28:29] offset:2048 sc1
    global_store_dwordx4 v1, v[8:11], s[28:29] offset:3072 sc1
    s_lshl_b32 s51, s26, 12
    s_add_u32 s51, s51, 80216064
    s_add_u32 s28, s16, s51
    s_addc_u32 s29, s17, 0
    global_store_dwordx4 v1, v[8:11], s[28:29] offset:0 sc1
    global_store_dwordx4 v1, v[8:11], s[28:29] offset:1024 sc1
    global_store_dwordx4 v1, v[8:11], s[28:29] offset:2048 sc1
    global_store_dwordx4 v1, v[8:11], s[28:29] offset:3072 sc1
    s_lshl_b32 s51, s26, 12
    s_add_u32 s51, s51, 80363520
    s_add_u32 s28, s16, s51
    s_addc_u32 s29, s17, 0
    global_store_dwordx4 v1, v[8:11], s[28:29] offset:0 sc1
    global_store_dwordx4 v1, v[8:11], s[28:29] offset:1024 sc1
    global_store_dwordx4 v1, v[8:11], s[28:29] offset:2048 sc1
    global_store_dwordx4 v1, v[8:11], s[28:29] offset:3072 sc1
    s_lshl_b32 s51, s26, 12
    s_add_u32 s51, s51, 80510976
    s_add_u32 s28, s16, s51
    s_addc_u32 s29, s17, 0
    global_store_dwordx4 v1, v[8:11], s[28:29] offset:0 sc1
    global_store_dwordx4 v1, v[8:11], s[28:29] offset:1024 sc1
    global_store_dwordx4 v1, v[8:11], s[28:29] offset:2048 sc1
    global_store_dwordx4 v1, v[8:11], s[28:29] offset:3072 sc1
    s_lshl_b32 s51, s26, 12
    s_add_u32 s51, s51, 80658432
    s_add_u32 s28, s16, s51
    s_addc_u32 s29, s17, 0
    global_store_dwordx4 v1, v[8:11], s[28:29] offset:0 sc1
    global_store_dwordx4 v1, v[8:11], s[28:29] offset:1024 sc1
    global_store_dwordx4 v1, v[8:11], s[28:29] offset:2048 sc1
    global_store_dwordx4 v1, v[8:11], s[28:29] offset:3072 sc1
    v_mov_b32 v4, 12
    s_mov_b32 s25, 0
wt_8:
    global_load_dword v5, v4, s[14:15] sc1
    s_add_u32 s25, s25, 1
    s_cmp_gt_u32 s25, 300000
    s_cbranch_scc1 W_ABORT
    s_waitcnt vmcnt(0)
    v_readfirstlane_b32 s51, v5
    s_nop 1
    s_cmp_ge_u32 s51, 1
    s_cbranch_scc1 wd_9
    s_sleep 2
    s_branch wt_8
wd_9:
    s_waitcnt vmcnt(0)
    s_barrier
    v_mov_b32 v4, 16384
    v_mov_b32 v5, 1
    s_cmp_eq_u32 s22, 0
    s_cselect_b64 exec, 1, 0
    global_atomic_add v4, v5, s[2:3]
    s_mov_b64 exec, -1
    v_mov_b32 v4, 16512
    v_mov_b32 v5, 1
    s_cmp_eq_u32 s22, 0
    s_cselect_b64 exec, 1, 0
    global_atomic_add v4, v5, s[2:3]
    s_mov_b64 exec, -1
    v_mbcnt_lo_u32_b32 v1, -1, 0
    v_mbcnt_hi_u32_b32 v1, -1, v1
    v_lshlrev_b32 v2, 4, v1
    v_lshrrev_b32 v3, 2, v1
    v_and_b32 v4, 3, v1
    s_mul_i32 s30, s22, 33792
    v_mul_u32_u24 v3, 1056, v3
    v_lshlrev_b32 v4, 3, v4
    v_add3_u32 v3, v3, v4, s30
PH1_WL:
    s_lshr_b32 s31, s26, 2
    s_lshl_b32 s31, s31, 17
    s_and_b32 s32, s26, 3
    s_lshl_b32 s32, s32, 11
    s_add_u32 s31, s31, s32
    s_sub_u32 s32, s26, 128
    s_lshl_b32 s32, s32, 15
    s_cmp_lt_u32 s26, 128
    s_cselect_b32 s31, s31, s32
    s_cselect_b32 s34, s10, s78
    s_cselect_b32 s35, s11, s79
    s_cselect_b32 s36, 1, 4
    s_cselect_b32 s37, 32, 8
    s_cselect_b32 s38, 8, 1
    s_add_u32 s34, s34, s31
    s_addc_u32 s35, s35, 0
    s_lshl_b32 s36, s36, 10
    s_lshl_b32 s37, s37, 10
    s_lshl_b32 s38, s38, 10
    s_mov_b32 m0, s30
    s_mul_i32 s39, s36, 0
    s_mul_i32 s40, s37, 0
    s_add_u32 s39, s39, s40
    s_mul_i32 s40, s38, 0
    s_add_u32 s39, s39, s40
    s_add_u32 s40, s34, s39
    s_addc_u32 s41, s35, 0
    global_load_lds_dwordx4 v2, s[40:41]
    s_add_u32 s39, m0, 1056
    s_mov_b32 m0, s39
    s_mul_i32 s39, s36, 0
    s_mul_i32 s40, s37, 0
    s_add_u32 s39, s39, s40
    s_mul_i32 s40, s38, 1
    s_add_u32 s39, s39, s40
    s_add_u32 s40, s34, s39
    s_addc_u32 s41, s35, 0
    global_load_lds_dwordx4 v2, s[40:41]
    s_add_u32 s39, m0, 1056
    s_mov_b32 m0, s39
    s_mul_i32 s39, s36, 0
    s_mul_i32 s40, s37, 0
    s_add_u32 s39, s39, s40
    s_mul_i32 s40, s38, 2
    s_add_u32 s39, s39, s40
    s_add_u32 s40, s34, s39
    s_addc_u32 s41, s35, 0
    global_load_lds_dwordx4 v2, s[40:41]
    s_add_u32 s39, m0, 1056
    s_mov_b32 m0, s39
    s_mul_i32 s39, s36, 0
    s_mul_i32 s40, s37, 0
    s_add_u32 s39, s39, s40
    s_mul_i32 s40, s38, 3
    s_add_u32 s39, s39, s40
    s_add_u32 s40, s34, s39
    s_addc_u32 s41, s35, 0
    global_load_lds_dwordx4 v2, s[40:41]
    s_add_u32 s39, m0, 1056
    s_mov_b32 m0, s39
    s_mul_i32 s39, s36, 0
    s_mul_i32 s40, s37, 1
    s_add_u32 s39, s39, s40
    s_mul_i32 s40, s38, 0
    s_add_u32 s39, s39, s40
    s_add_u32 s40, s34, s39
    s_addc_u32 s41, s35, 0
    global_load_lds_dwordx4 v2, s[40:41]
    s_add_u32 s39, m0, 1056
    s_mov_b32 m0, s39
    s_mul_i32 s39, s36, 0
    s_mul_i32 s40, s37, 1
    s_add_u32 s39, s39, s40
    s_mul_i32 s40, s38, 1
    s_add_u32 s39, s39, s40
    s_add_u32 s40, s34, s39
    s_addc_u32 s41, s35, 0
    global_load_lds_dwordx4 v2, s[40:41]
    s_add_u32 s39, m0, 1056
    s_mov_b32 m0, s39
    s_mul_i32 s39, s36, 0
    s_mul_i32 s40, s37, 1
    s_add_u32 s39, s39, s40
    s_mul_i32 s40, s38, 2
    s_add_u32 s39, s39, s40
    s_add_u32 s40, s34, s39
    s_addc_u32 s41, s35, 0
    global_load_lds_dwordx4 v2, s[40:41]
    s_add_u32 s39, m0, 1056
    s_mov_b32 m0, s39
    s_mul_i32 s39, s36, 0
    s_mul_i32 s40, s37, 1
    s_add_u32 s39, s39, s40
    s_mul_i32 s40, s38, 3
    s_add_u32 s39, s39, s40
    s_add_u32 s40, s34, s39
    s_addc_u32 s41, s35, 0
    global_load_lds_dwordx4 v2, s[40:41]
    s_add_u32 s39, m0, 1056
    s_mov_b32 m0, s39
    s_mul_i32 s39, s36, 0
    s_mul_i32 s40, s37, 2
    s_add_u32 s39, s39, s40
    s_mul_i32 s40, s38, 0
    s_add_u32 s39, s39, s40
    s_add_u32 s40, s34, s39
    s_addc_u32 s41, s35, 0
    global_load_lds_dwordx4 v2, s[40:41]
    s_add_u32 s39, m0, 1056
    s_mov_b32 m0, s39
    s_mul_i32 s39, s36, 0
    s_mul_i32 s40, s37, 2
    s_add_u32 s39, s39, s40
    s_mul_i32 s40, s38, 1
    s_add_u32 s39, s39, s40
    s_add_u32 s40, s34, s39
    s_addc_u32 s41, s35, 0
    global_load_lds_dwordx4 v2, s[40:41]
    s_add_u32 s39, m0, 1056
    s_mov_b32 m0, s39
    s_mul_i32 s39, s36, 0
    s_mul_i32 s40, s37, 2
    s_add_u32 s39, s39, s40
    s_mul_i32 s40, s38, 2
    s_add_u32 s39, s39, s40
    s_add_u32 s40, s34, s39
    s_addc_u32 s41, s35, 0
    global_load_lds_dwordx4 v2, s[40:41]
    s_add_u32 s39, m0, 1056
    s_mov_b32 m0, s39
    s_mul_i32 s39, s36, 0
    s_mul_i32 s40, s37, 2
    s_add_u32 s39, s39, s40
    s_mul_i32 s40, s38, 3
    s_add_u32 s39, s39, s40
    s_add_u32 s40, s34, s39
    s_addc_u32 s41, s35, 0
    global_load_lds_dwordx4 v2, s[40:41]
    s_add_u32 s39, m0, 1056
    s_mov_b32 m0, s39
    s_mul_i32 s39, s36, 0
    s_mul_i32 s40, s37, 3
    s_add_u32 s39, s39, s40
    s_mul_i32 s40, s38, 0
    s_add_u32 s39, s39, s40
    s_add_u32 s40, s34, s39
    s_addc_u32 s41, s35, 0
    global_load_lds_dwordx4 v2, s[40:41]
    s_add_u32 s39, m0, 1056
    s_mov_b32 m0, s39
    s_mul_i32 s39, s36, 0
    s_mul_i32 s40, s37, 3
    s_add_u32 s39, s39, s40
    s_mul_i32 s40, s38, 1
    s_add_u32 s39, s39, s40
    s_add_u32 s40, s34, s39
    s_addc_u32 s41, s35, 0
    global_load_lds_dwordx4 v2, s[40:41]
    s_add_u32 s39, m0, 1056
    s_mov_b32 m0, s39
    s_mul_i32 s39, s36, 0
    s_mul_i32 s40, s37, 3
    s_add_u32 s39, s39, s40
    s_mul_i32 s40, s38, 2
    s_add_u32 s39, s39, s40
    s_add_u32 s40, s34, s39
    s_addc_u32 s41, s35, 0
    global_load_lds_dwordx4 v2, s[40:41]
    s_add_u32 s39, m0, 1056
    s_mov_b32 m0, s39
    s_mul_i32 s39, s36, 0
    s_mul_i32 s40, s37, 3
    s_add_u32 s39, s39, s40
    s_mul_i32 s40, s38, 3
    s_add_u32 s39, s39, s40
    s_add_u32 s40, s34, s39
    s_addc_u32 s41, s35, 0
    global_load_lds_dwordx4 v2, s[40:41]
    s_add_u32 s39, m0, 1056
    s_mov_b32 m0, s39
    s_mul_i32 s39, s36, 1
    s_mul_i32 s40, s37, 0
    s_add_u32 s39, s39, s40
    s_mul_i32 s40, s38, 0
    s_add_u32 s39, s39, s40
    s_add_u32 s40, s34, s39
    s_addc_u32 s41, s35, 0
    global_load_lds_dwordx4 v2, s[40:41]
    s_add_u32 s39, m0, 1056
    s_mov_b32 m0, s39
    s_mul_i32 s39, s36, 1
    s_mul_i32 s40, s37, 0
    s_add_u32 s39, s39, s40
    s_mul_i32 s40, s38, 1
    s_add_u32 s39, s39, s40
    s_add_u32 s40, s34, s39
    s_addc_u32 s41, s35, 0
    global_load_lds_dwordx4 v2, s[40:41]
    s_add_u32 s39, m0, 1056
    s_mov_b32 m0, s39
    s_mul_i32 s39, s36, 1
    s_mul_i32 s40, s37, 0
    s_add_u32 s39, s39, s40
    s_mul_i32 s40, s38, 2
    s_add_u32 s39, s39, s40
    s_add_u32 s40, s34, s39
    s_addc_u32 s41, s35, 0
    global_load_lds_dwordx4 v2, s[40:41]
    s_add_u32 s39, m0, 1056
    s_mov_b32 m0, s39
    s_mul_i32 s39, s36, 1
    s_mul_i32 s40, s37, 0
    s_add_u32 s39, s39, s40
    s_mul_i32 s40, s38, 3
    s_add_u32 s39, s39, s40
    s_add_u32 s40, s34, s39
    s_addc_u32 s41, s35, 0
    global_load_lds_dwordx4 v2, s[40:41]
    s_add_u32 s39, m0, 1056
    s_mov_b32 m0, s39
    s_mul_i32 s39, s36, 1
    s_mul_i32 s40, s37, 1
    s_add_u32 s39, s39, s40
    s_mul_i32 s40, s38, 0
    s_add_u32 s39, s39, s40
    s_add_u32 s40, s34, s39
    s_addc_u32 s41, s35, 0
    global_load_lds_dwordx4 v2, s[40:41]
    s_add_u32 s39, m0, 1056
    s_mov_b32 m0, s39
    s_mul_i32 s39, s36, 1
    s_mul_i32 s40, s37, 1
    s_add_u32 s39, s39, s40
    s_mul_i32 s40, s38, 1
    s_add_u32 s39, s39, s40
    s_add_u32 s40, s34, s39
    s_addc_u32 s41, s35, 0
    global_load_lds_dwordx4 v2, s[40:41]
    s_add_u32 s39, m0, 1056
    s_mov_b32 m0, s39
    s_mul_i32 s39, s36, 1
    s_mul_i32 s40, s37, 1
    s_add_u32 s39, s39, s40
    s_mul_i32 s40, s38, 2
    s_add_u32 s39, s39, s40
    s_add_u32 s40, s34, s39
    s_addc_u32 s41, s35, 0
    global_load_lds_dwordx4 v2, s[40:41]
    s_add_u32 s39, m0, 1056
    s_mov_b32 m0, s39
    s_mul_i32 s39, s36, 1
    s_mul_i32 s40, s37, 1
    s_add_u32 s39, s39, s40
    s_mul_i32 s40, s38, 3
    s_add_u32 s39, s39, s40
    s_add_u32 s40, s34, s39
    s_addc_u32 s41, s35, 0
    global_load_lds_dwordx4 v2, s[40:41]
    s_add_u32 s39, m0, 1056
    s_mov_b32 m0, s39
    s_mul_i32 s39, s36, 1
    s_mul_i32 s40, s37, 2
    s_add_u32 s39, s39, s40
    s_mul_i32 s40, s38, 0
    s_add_u32 s39, s39, s40
    s_add_u32 s40, s34, s39
    s_addc_u32 s41, s35, 0
    global_load_lds_dwordx4 v2, s[40:41]
    s_add_u32 s39, m0, 1056
    s_mov_b32 m0, s39
    s_mul_i32 s39, s36, 1
    s_mul_i32 s40, s37, 2
    s_add_u32 s39, s39, s40
    s_mul_i32 s40, s38, 1
    s_add_u32 s39, s39, s40
    s_add_u32 s40, s34, s39
    s_addc_u32 s41, s35, 0
    global_load_lds_dwordx4 v2, s[40:41]
    s_add_u32 s39, m0, 1056
    s_mov_b32 m0, s39
    s_mul_i32 s39, s36, 1
    s_mul_i32 s40, s37, 2
    s_add_u32 s39, s39, s40
    s_mul_i32 s40, s38, 2
    s_add_u32 s39, s39, s40
    s_add_u32 s40, s34, s39
    s_addc_u32 s41, s35, 0
    global_load_lds_dwordx4 v2, s[40:41]
    s_add_u32 s39, m0, 1056
    s_mov_b32 m0, s39
    s_mul_i32 s39, s36, 1
    s_mul_i32 s40, s37, 2
    s_add_u32 s39, s39, s40
    s_mul_i32 s40, s38, 3
    s_add_u32 s39, s39, s40
    s_add_u32 s40, s34, s39
    s_addc_u32 s41, s35, 0
    global_load_lds_dwordx4 v2, s[40:41]
    s_add_u32 s39, m0, 1056
    s_mov_b32 m0, s39
    s_mul_i32 s39, s36, 1
    s_mul_i32 s40, s37, 3
    s_add_u32 s39, s39, s40
    s_mul_i32 s40, s38, 0
    s_add_u32 s39, s39, s40
    s_add_u32 s40, s34, s39
    s_addc_u32 s41, s35, 0
    global_load_lds_dwordx4 v2, s[40:41]
    s_add_u32 s39, m0, 1056
    s_mov_b32 m0, s39
    s_mul_i32 s39, s36, 1
    s_mul_i32 s40, s37, 3
    s_add_u32 s39, s39, s40
    s_mul_i32 s40, s38, 1
    s_add_u32 s39, s39, s40
    s_add_u32 s40, s34, s39
    s_addc_u32 s41, s35, 0
    global_load_lds_dwordx4 v2, s[40:41]
    s_add_u32 s39, m0, 1056
    s_mov_b32 m0, s39
    s_mul_i32 s39, s36, 1
    s_mul_i32 s40, s37, 3
    s_add_u32 s39, s39, s40
    s_mul_i32 s40, s38, 2
    s_add_u32 s39, s39, s40
    s_add_u32 s40, s34, s39
    s_addc_u32 s41, s35, 0
    global_load_lds_dwordx4 v2, s[40:41]
    s_add_u32 s39, m0, 1056
    s_mov_b32 m0, s39
    s_mul_i32 s39, s36, 1
    s_mul_i32 s40, s37, 3
    s_add_u32 s39, s39, s40
    s_mul_i32 s40, s38, 3
    s_add_u32 s39, s39, s40
    s_add_u32 s40, s34, s39
    s_addc_u32 s41, s35, 0
    global_load_lds_dwordx4 v2, s[40:41]
    s_add_u32 s39, m0, 1056
    s_mov_b32 m0, s39
    s_mul_i32 s39, s26, 1821
    s_lshr_b32 s39, s39, 16
    s_mul_i32 s40, s39, 36
    s_sub_u32 s40, s26, s40
    s_mul_i32 s39, s39, 72
    s_lshl_b32 s40, s40, 1
    s_add_u32 s39, s39, s40
    s_lshl_b32 s39, s39, 10
    s_add_u32 s39, s39, 87171072
    s_add_u32 s40, s16, s39
    s_addc_u32 s41, s17, 0
    s_waitcnt vmcnt(0)
    ds_read_b64_tr_b16 v[8:9], v3 offset:0
    ds_read_b64_tr_b16 v[10:11], v3 offset:16896
    ds_read_b64_tr_b16 v[12:13], v3 offset:32
    ds_read_b64_tr_b16 v[14:15], v3 offset:16928
    ds_read_b64_tr_b16 v[16:17], v3 offset:64
    ds_read_b64_tr_b16 v[18:19], v3 offset:16960
    ds_read_b64_tr_b16 v[20:21], v3 offset:96
    ds_read_b64_tr_b16 v[22:23], v3 offset:16992
    ds_read_b64_tr_b16 v[24:25], v3 offset:128
    ds_read_b64_tr_b16 v[26:27], v3 offset:17024
    ds_read_b64_tr_b16 v[28:29], v3 offset:160
    ds_read_b64_tr_b16 v[30:31], v3 offset:17056
    s_waitcnt lgkmcnt(4)
    ds_read_b64_tr_b16 v[32:33], v3 offset:192
    ds_read_b64_tr_b16 v[34:35], v3 offset:17088
    ds_read_b64_tr_b16 v[36:37], v3 offset:224
    ds_read_b64_tr_b16 v[38:39], v3 offset:17120
    ds_read_b64_tr_b16 v[40:41], v3 offset:256
    ds_read_b64_tr_b16 v[42:43], v3 offset:17152
    ds_read_b64_tr_b16 v[44:45], v3 offset:288
    ds_read_b64_tr_b16 v[46:47], v3 offset:17184
    ds_read_b64_tr_b16 v[48:49], v3 offset:320
    ds_read_b64_tr_b16 v[50:51], v3 offset:17216
    ds_read_b64_tr_b16 v[52:53], v3 offset:352
    ds_read_b64_tr_b16 v[54:55], v3 offset:17248
    s_waitcnt lgkmcnt(4)
    ds_read_b64_tr_b16 v[56:57], v3 offset:384
    ds_read_b64_tr_b16 v[58:59], v3 offset:17280
    ds_read_b64_tr_b16 v[60:61], v3 offset:416
    ds_read_b64_tr_b16 v[62:63], v3 offset:17312
    ds_read_b64_tr_b16 v[64:65], v3 offset:448
    ds_read_b64_tr_b16 v[66:67], v3 offset:17344
    ds_read_b64_tr_b16 v[68:69], v3 offset:480
    ds_read_b64_tr_b16 v[70:71], v3 offset:17376
    ds_read_b64_tr_b16 v[72:73], v3 offset:512
    ds_read_b64_tr_b16 v[74:75], v3 offset:17408
    ds_read_b64_tr_b16 v[76:77], v3 offset:544
    ds_read_b64_tr_b16 v[78:79], v3 offset:17440
    s_waitcnt lgkmcnt(4)
    ds_read_b64_tr_b16 v[80:81], v3 offset:576
    ds_read_b64_tr_b16 v[82:83], v3 offset:17472
    ds_read_b64_tr_b16 v[84:85], v3 offset:608
    ds_read_b64_tr_b16 v[86:87], v3 offset:17504
    ds_read_b64_tr_b16 v[88:89], v3 offset:640
    ds_read_b64_tr_b16 v[90:91], v3 offset:17536
    ds_read_b64_tr_b16 v[92:93], v3 offset:672
    ds_read_b64_tr_b16 v[94:95], v3 offset:17568
    ds_read_b64_tr_b16 v[96:97], v3 offset:704
    ds_read_b64_tr_b16 v[98:99], v3 offset:17600
    ds_read_b64_tr_b16 v[100:101], v3 offset:736
    ds_read_b64_tr_b16 v[102:103], v3 offset:17632
    s_waitcnt lgkmcnt(4)
    ds_read_b64_tr_b16 v[104:105], v3 offset:768
    ds_read_b64_tr_b16 v[106:107], v3 offset:17664
    ds_read_b64_tr_b16 v[108:109], v3 offset:800
    ds_read_b64_tr_b16 v[110:111], v3 offset:17696
    ds_read_b64_tr_b16 v[112:113], v3 offset:832
    ds_read_b64_tr_b16 v[114:115], v3 offset:17728
    ds_read_b64_tr_b16 v[116:117], v3 offset:864
    ds_read_b64_tr_b16 v[118:119], v3 offset:17760
    ds_read_b64_tr_b16 v[120:121], v3 offset:896
    ds_read_b64_tr_b16 v[122:123], v3 offset:17792
    ds_read_b64_tr_b16 v[124:125], v3 offset:928
    ds_read_b64_tr_b16 v[126:127], v3 offset:17824
    s_waitcnt lgkmcnt(4)
    ds_read_b64_tr_b16 v[128:129], v3 offset:960
    ds_read_b64_tr_b16 v[130:131], v3 offset:17856
    ds_read_b64_tr_b16 v[132:133], v3 offset:992
    ds_read_b64_tr_b16 v[134:135], v3 offset:17888
    s_waitcnt lgkmcnt(0)
    global_store_dwordx4 v2, v[8:11], s[40:41] offset:0 sc1
    global_store_dwordx4 v2, v[12:15], s[40:41] offset:1024 sc1
    s_add_u32 s40, s40, 294912
    s_addc_u32 s41, s41, 0
    global_store_dwordx4 v2, v[16:19], s[40:41] offset:0 sc1
    global_store_dwordx4 v2, v[20:23], s[40:41] offset:1024 sc1
    s_add_u32 s40, s40, 294912
    s_addc_u32 s41, s41, 0
    global_store_dwordx4 v2, v[24:27], s[40:41] offset:0 sc1
    global_store_dwordx4 v2, v[28:31], s[40:41] offset:1024 sc1
    s_add_u32 s40, s40, 294912
    s_addc_u32 s41, s41, 0
    global_store_dwordx4 v2, v[32:35], s[40:41] offset:0 sc1
    global_store_dwordx4 v2, v[36:39], s[40:41] offset:1024 sc1
    s_add_u32 s40, s40, 294912
    s_addc_u32 s41, s41, 0
    global_store_dwordx4 v2, v[40:43], s[40:41] offset:0 sc1
    global_store_dwordx4 v2, v[44:47], s[40:41] offset:1024 sc1
    s_add_u32 s40, s40, 294912
    s_addc_u32 s41, s41, 0
    global_store_dwordx4 v2, v[48:51], s[40:41] offset:0 sc1
    global_store_dwordx4 v2, v[52:55], s[40:41] offset:1024 sc1
    s_add_u32 s40, s40, 294912
    s_addc_u32 s41, s41, 0
    global_store_dwordx4 v2, v[56:59], s[40:41] offset:0 sc1
    global_store_dwordx4 v2, v[60:63], s[40:41] offset:1024 sc1
    s_add_u32 s40, s40, 294912
    s_addc_u32 s41, s41, 0
    global_store_dwordx4 v2, v[64:67], s[40:41] offset:0 sc1
    global_store_dwordx4 v2, v[68:71], s[40:41] offset:1024 sc1
    s_add_u32 s40, s40, 294912
    s_addc_u32 s41, s41, 0
    global_store_dwordx4 v2, v[72:75], s[40:41] offset:0 sc1
    global_store_dwordx4 v2, v[76:79], s[40:41] offset:1024 sc1
    s_add_u32 s40, s40, 294912
    s_addc_u32 s41, s41, 0
    global_store_dwordx4 v2, v[80:83], s[40:41] offset:0 sc1
    global_store_dwordx4 v2, v[84:87], s[40:41] offset:1024 sc1
    s_add_u32 s40, s40, 294912
    s_addc_u32 s41, s41, 0
    global_store_dwordx4 v2, v[88:91], s[40:41] offset:0 sc1
    global_store_dwordx4 v2, v[92:95], s[40:41] offset:1024 sc1
    s_add_u32 s40, s40, 294912
    s_addc_u32 s41, s41, 0
    global_store_dwordx4 v2, v[96:99], s[40:41] offset:0 sc1
    global_store_dwordx4 v2, v[100:103], s[40:41] offset:1024 sc1
    s_add_u32 s40, s40, 294912
    s_addc_u32 s41, s41, 0
    global_store_dwordx4 v2, v[104:107], s[40:41] offset:0 sc1
    global_store_dwordx4 v2, v[108:111], s[40:41] offset:1024 sc1
    s_add_u32 s40, s40, 294912
    s_addc_u32 s41, s41, 0
    global_store_dwordx4 v2, v[112:115], s[40:41] offset:0 sc1
    global_store_dwordx4 v2, v[116:119], s[40:41] offset:1024 sc1
    s_add_u32 s40, s40, 294912
    s_addc_u32 s41, s41, 0
    global_store_dwordx4 v2, v[120:123], s[40:41] offset:0 sc1
    global_store_dwordx4 v2, v[124:127], s[40:41] offset:1024 sc1
    s_add_u32 s40, s40, 294912
    s_addc_u32 s41, s41, 0
    global_store_dwordx4 v2, v[128:131], s[40:41] offset:0 sc1
    global_store_dwordx4 v2, v[132:135], s[40:41] offset:1024 sc1
    s_add_u32 s40, s40, 294912
    s_addc_u32 s41, s41, 0
    s_add_u32 s26, s26, 32
    s_cmp_lt_u32 s26, 144
    s_cbranch_scc1 PH1_WL
    s_waitcnt vmcnt(0)
    s_barrier
    v_mov_b32 v4, 16768
    v_mov_b32 v5, 1
    s_cmp_eq_u32 s22, 0
    s_cselect_b64 exec, 1, 0
    global_atomic_add v4, v5, s[2:3]
    s_mov_b64 exec, -1
    s_branch PH1
PH1_DONE:
    s_cmp_lt_u32 s26, 64
    s_cbranch_scc1 PH1
    v_mov_b32 v4, 16384
    v_mov_b32 v5, 1
    s_cmp_eq_u32 s22, 0
    s_cselect_b64 exec, 1, 0
    global_atomic_add v4, v5, s[2:3]
    s_mov_b64 exec, -1
    s_cmp_lt_u32 s26, 128
    s_cbranch_scc1 PH1
    v_mov_b32 v4, 16512
    v_mov_b32 v5, 1
    s_cmp_eq_u32 s22, 0
    s_cselect_b64 exec, 1, 0
    global_atomic_add v4, v5, s[2:3]
    s_mov_b64 exec, -1
    s_branch PH1
PH1_NONE:
    s_sub_u32 s51, s26, 160
    s_cmp_ge_u32 s51, 32
    s_cbranch_scc1 PH1_END
    v_mbcnt_lo_u32_b32 v1, -1, 0
    v_mbcnt_hi_u32_b32 v1, -1, v1
    s_mul_i32 s51, s51, 131072
    s_mul_i32 s52, s22, 32768
    s_add_u32 s51, s51, s52
    v_lshlrev_b32 v1, 7, v1
    v_add_u32 v1, s51, v1
    v_mov_b32 v2, v1
    global_load_dword v8, v2, s[10:11]
    v_add_u32 v2, 8192, v2
    global_load_dword v9, v2, s[10:11]
    v_add_u32 v2, 8192, v2
    global_load_dword v10, v2, s[10:11]
    v_add_u32 v2, 8192, v2
    global_load_dword v11, v2, s[10:11]
    v_add_u32 v2, 8192, v2
    s_waitcnt vmcnt(0)
PH1_END:
    v_mov_b32 v125, 162816
    v_mov_b32 v2, 192
    s_mov_b32 s25, 0
    s_mov_b32 s44, 0
    s_cmp_lg_u32 s22, 0
    s_cbranch_scc1 ST_DEC
ST_POLL:
    global_load_dword v3, v2, s[14:15] sc1
    s_waitcnt vmcnt(0)
    v_readfirstlane_b32 s51, v3
    s_nop 1
    s_cmp_ge_u32 s51, 32
    s_cbranch_scc1 ST_WR
    s_sleep 8
    s_add_u32 s25, s25, 1
    s_cmp_lt_u32 s25, 100
    s_cbranch_scc1 ST_POLL
    s_mov_b32 s44, 1
ST_WR:
    v_mov_b32 v3, s44
    ds_write_b32 v125, v3 offset:4
    s_waitcnt lgkmcnt(0)
ST_DEC:
    s_barrier
    ds_read_b32 v3, v125 offset:4
    s_waitcnt lgkmcnt(0)
    v_readfirstlane_b32 s44, v3
    s_barrier
    s_cmp_eq_u32 s44, 0
    s_cbranch_scc1 STAFFED
    v_mbcnt_lo_u32_b32 v0, -1, 0
    v_mbcnt_hi_u32_b32 v0, -1, v0
    s_mov_b32 s67, 1
    s_lshl_b32 s51, s22, 6
    v_add_u32 v0, s51, v0
    v_lshlrev_b32 v121, 6, v0
    s_branch TAKE
STAFFED:
    s_cmp_eq_u32 s90, 0
    s_cbranch_scc1 CH_EXIT
    s_add_u32 s2, s16, 1835008
    s_addc_u32 s3, s17, 0
    v_mov_b32 v4, 12
    s_mov_b32 s25, 0
    s_cmp_lg_u32 s22, 0
    s_cbranch_scc1 wd_11
wt_10:
    global_load_dword v5, v4, s[14:15] sc1
    s_add_u32 s25, s25, 1
    s_cmp_gt_u32 s25, 300000
    s_cbranch_scc1 W_ABORT
    s_waitcnt vmcnt(0)
    v_readfirstlane_b32 s51, v5
    s_nop 1
    s_cmp_ge_u32 s51, 1
    s_cbranch_scc1 wd_11
    s_sleep 2
    s_branch wt_10
wd_11:
    s_barrier
    v_mov_b32 v4, 16512
    s_mov_b32 s25, 0
    s_cmp_lg_u32 s22, 0
    s_cbranch_scc1 wd_13
wt_12:
    global_load_dword v5, v4, s[2:3] sc1
    s_add_u32 s25, s25, 1
    s_cmp_gt_u32 s25, 300000
    s_cbranch_scc1 W_ABORT
    s_waitcnt vmcnt(0)
    v_readfirstlane_b32 s51, v5
    s_nop 1
    s_cmp_ge_u32 s51, 32
    s_cbranch_scc1 wd_13
    s_sleep 16
    s_branch wt_12
wd_13:
    s_barrier
    s_cmp_lg_u32 s22, 0
    s_cbranch_scc1 aq_14
    buffer_inv sc1
    s_waitcnt vmcnt(0)
aq_14:
    s_barrier
PH2:
    v_mov_b32 v4, 16896
    v_mov_b32 v5, 1
    v_mov_b32 v6, 162816
    s_cmp_lg_u32 s22, 0
    s_cbranch_scc1 tk_15
    s_mov_b64 exec, 1
    global_atomic_add v7, v4, v5, s[2:3] sc0
    s_waitcnt vmcnt(0)
    ds_write_b32 v6, v7
    s_mov_b64 exec, -1
    s_waitcnt lgkmcnt(0)
tk_15:
    s_barrier
    ds_read_b32 v7, v6
    s_waitcnt lgkmcnt(0)
    v_readfirstlane_b32 s43, v7
    s_barrier
    s_cmp_ge_u32 s43, 224
    s_cbranch_scc1 PH2_END
    s_lshl_b32 s43, s43, 2
    s_add_u32 s43, s43, s22
PH2_L:
    s_mov_b32 s26, s43
    v_mbcnt_lo_u32_b32 v1, -1, 0
    v_mbcnt_hi_u32_b32 v1, -1, v1
    v_and_b32 v2, 15, v1
    v_lshrrev_b32 v3, 4, v1
    s_lshr_b32 s27, s26, 4
    s_and_b32 s28, s26, 15
    s_lshl_b32 s29, s27, 4
    v_add_u32 v4, s29, v2
    s_lshl_b32 s51, s28, 10
    s_add_u32 s51, s51, 80805888
    s_add_u32 s30, s16, s51
    s_addc_u32 s31, s17, 0
    s_add_u32 s32, s30, 16384
    s_addc_u32 s33, s31, 0
    s_add_u32 s34, s30, 32768
    s_addc_u32 s35, s31, 0
    s_mov_b32 s36, 49152
    v_lshlrev_b32 v5, 8, v3
    v_subrev_u32 v6, 0, v4
    v_max_i32 v6, 0, v6
    v_lshrrev_b32 v7, 4, v6
    v_mul_lo_u32 v7, v7, s36
    v_and_b32 v6, 15, v6
    v_lshl_add_u32 v6, v6, 4, v5
    v_add_u32 v8, v6, v7
    v_subrev_u32 v6, 2, v4
    v_max_i32 v6, 0, v6
    v_lshrrev_b32 v7, 4, v6
    v_mul_lo_u32 v7, v7, s36
    v_and_b32 v6, 15, v6
    v_lshl_add_u32 v6, v6, 4, v5
    v_add_u32 v9, v6, v7
    v_subrev_u32 v6, 4, v4
    v_max_i32 v6, 0, v6
    v_lshrrev_b32 v7, 4, v6
    v_mul_lo_u32 v7, v7, s36
    v_and_b32 v6, 15, v6
    v_lshl_add_u32 v6, v6, 4, v5
    v_add_u32 v10, v6, v7
    v_subrev_u32 v6, 6, v4
    v_max_i32 v6, 0, v6
    v_lshrrev_b32 v7, 4, v6
    v_mul_lo_u32 v7, v7, s36
    v_and_b32 v6, 15, v6
    v_lshl_add_u32 v6, v6, 4, v5
    v_add_u32 v11, v6, v7
    v_subrev_u32 v6, 8, v4
    v_max_i32 v6, 0, v6
    v_lshrrev_b32 v7, 4, v6
    v_mul_lo_u32 v7, v7, s36
    v_and_b32 v6, 15, v6
    v_lshl_add_u32 v6, v6, 4, v5
    v_add_u32 v12, v6, v7
    v_subrev_u32 v6, 10, v4
    v_max_i32 v6, 0, v6
    v_lshrrev_b32 v7, 4, v6
    v_mul_lo_u32 v7, v7, s36
    v_and_b32 v6, 15, v6
    v_lshl_add_u32 v6, v6, 4, v5
    v_add_u32 v13, v6, v7
    v_subrev_u32 v6, 12, v4
    v_max_i32 v6, 0, v6
    v_lshrrev_b32 v7, 4, v6
    v_mul_lo_u32 v7, v7, s36
    v_and_b32 v6, 15, v6
    v_lshl_add_u32 v6, v6, 4, v5
    v_add_u32 v14, v6, v7
    v_subrev_u32 v6, 14, v4
    v_max_i32 v6, 0, v6
    v_lshrrev_b32 v7, 4, v6
    v_mul_lo_u32 v7, v7, s36
    v_and_b32 v6, 15, v6
    v_lshl_add_u32 v6, v6, 4, v5
    v_add_u32 v15, v6, v7
    global_load_dwordx4 v[16:19], v8, s[30:31] sc1
    global_load_dwordx4 v[20:23], v8, s[32:33] sc1
    global_load_dwordx4 v[24:27], v9, s[32:33] sc1
    global_load_dwordx4 v[28:31], v10, s[32:33] sc1
    global_load_dwordx4 v[32:35], v11, s[32:33] sc1
    global_load_dwordx4 v[36:39], v12, s[32:33] sc1
    global_load_dwordx4 v[40:43], v13, s[32:33] sc1
    global_load_dwordx4 v[44:47], v14, s[32:33] sc1
    global_load_dwordx4 v[48:51], v15, s[32:33] sc1
    global_load_dwordx4 v[52:55], v8, s[34:35] sc1
    global_load_dwordx4 v[56:59], v9, s[34:35] sc1
    global_load_dwordx4 v[60:63], v10, s[34:35] sc1
    global_load_dwordx4 v[64:67], v11, s[34:35] sc1
    global_load_dwordx4 v[68:71], v12, s[34:35] sc1
    global_load_dwordx4 v[72:75], v13, s[34:35] sc1
    global_load_dwordx4 v[76:79], v14, s[34:35] sc1
    global_load_dwordx4 v[80:83], v15, s[34:35] sc1
    s_add_u32 s38, s16, 87097344
    s_addc_u32 s39, s17, 0
    v_lshlrev_b32 v6, 2, v4
    global_load_dword v84, v6, s[38:39] sc1
    v_mov_b32 v88, 0
    v_mov_b32 v89, 0
    v_mov_b32 v90, 0
    v_mov_b32 v91, 0
    v_mov_b32 v92, 0
    v_mov_b32 v93, 0
    v_mov_b32 v94, 0
    v_mov_b32 v95, 0
    s_waitcnt vmcnt(9)
    v_dot2c_f32_bf16 v88, v16, v20
    v_dot2c_f32_bf16 v89, v16, v24
    v_dot2c_f32_bf16 v90, v16, v28
    v_dot2c_f32_bf16 v91, v16, v32
    v_dot2c_f32_bf16 v92, v16, v36
    v_dot2c_f32_bf16 v93, v16, v40
    v_dot2c_f32_bf16 v94, v16, v44
    v_dot2c_f32_bf16 v95, v16, v48
    v_dot2c_f32_bf16 v88, v17, v21
    v_dot2c_f32_bf16 v89, v17, v25
    v_dot2c_f32_bf16 v90, v17, v29
    v_dot2c_f32_bf16 v91, v17, v33
    v_dot2c_f32_bf16 v92, v17, v37
    v_dot2c_f32_bf16 v93, v17, v41
    v_dot2c_f32_bf16 v94, v17, v45
    v_dot2c_f32_bf16 v95, v17, v49
    v_dot2c_f32_bf16 v88, v18, v22
    v_dot2c_f32_bf16 v89, v18, v26
    v_dot2c_f32_bf16 v90, v18, v30
    v_dot2c_f32_bf16 v91, v18, v34
    v_dot2c_f32_bf16 v92, v18, v38
    v_dot2c_f32_bf16 v93, v18, v42
    v_dot2c_f32_bf16 v94, v18, v46
    v_dot2c_f32_bf16 v95, v18, v50
    v_dot2c_f32_bf16 v88, v19, v23
    v_dot2c_f32_bf16 v89, v19, v27
    v_dot2c_f32_bf16 v90, v19, v31
    v_dot2c_f32_bf16 v91, v19, v35
    v_dot2c_f32_bf16 v92, v19, v39
    v_dot2c_f32_bf16 v93, v19, v43
    v_dot2c_f32_bf16 v94, v19, v47
    v_dot2c_f32_bf16 v95, v19, v51
    s_nop 2
    v_mov_b32 v96, v88
    v_mov_b32 v97, v89
    v_mov_b32 v98, v90
    v_mov_b32 v99, v91
    v_mov_b32 v100, v92
    v_mov_b32 v101, v93
    v_mov_b32 v102, v94
    v_mov_b32 v103, v95
    s_nop 1
    v_permlane16_swap_b32 v88, v96
    v_permlane16_swap_b32 v89, v97
    v_permlane16_swap_b32 v90, v98
    v_permlane16_swap_b32 v91, v99
    v_permlane16_swap_b32 v92, v100
    v_permlane16_swap_b32 v93, v101
    v_permlane16_swap_b32 v94, v102
    v_permlane16_swap_b32 v95, v103
    v_add_f32 v88, v88, v96
    v_add_f32 v89, v89, v97
    v_add_f32 v90, v90, v98
    v_add_f32 v91, v91, v99
    v_add_f32 v92, v92, v100
    v_add_f32 v93, v93, v101
    v_add_f32 v94, v94, v102
    v_add_f32 v95, v95, v103
    s_mov_b32 s36, 0x3eb8aa3b
    v_mov_b32 v104, 0xceabfb8f
    v_mul_f32 v88, s36, v88
    v_mul_f32 v89, s36, v89
    v_mul_f32 v90, s36, v90
    v_mul_f32 v91, s36, v91
    v_mul_f32 v92, s36, v92
    v_mul_f32 v93, s36, v93
    v_mul_f32 v94, s36, v94
    v_mul_f32 v95, s36, v95
    v_cmp_le_u32 vcc, 2, v4
    s_nop 1
    v_cndmask_b32 v89, v104, v89, vcc
    v_cmp_le_u32 vcc, 4, v4
    s_nop 1
    v_cndmask_b32 v90, v104, v90, vcc
    v_cmp_le_u32 vcc, 6, v4
    s_nop 1
    v_cndmask_b32 v91, v104, v91, vcc
    v_cmp_le_u32 vcc, 8, v4
    s_nop 1
    v_cndmask_b32 v92, v104, v92, vcc
    v_cmp_le_u32 vcc, 10, v4
    s_nop 1
    v_cndmask_b32 v93, v104, v93, vcc
    v_cmp_le_u32 vcc, 12, v4
    s_nop 1
    v_cndmask_b32 v94, v104, v94, vcc
    v_cmp_le_u32 vcc, 14, v4
    s_nop 1
    v_cndmask_b32 v95, v104, v95, vcc
    v_max3_f32 v105, v88, v89, v90
    v_max3_f32 v106, v91, v92, v93
    v_max3_f32 v105, v105, v94, v95
    v_max_f32 v105, v105, v106
    v_sub_f32 v88, v88, v105
    v_sub_f32 v89, v89, v105
    v_sub_f32 v90, v90, v105
    v_sub_f32 v91, v91, v105
    v_sub_f32 v92, v92, v105
    v_sub_f32 v93, v93, v105
    v_sub_f32 v94, v94, v105
    v_sub_f32 v95, v95, v105
    v_exp_f32 v88, v88
    v_exp_f32 v89, v89
    v_exp_f32 v90, v90
    v_exp_f32 v91, v91
    v_exp_f32 v92, v92
    v_exp_f32 v93, v93
    v_exp_f32 v94, v94
    v_exp_f32 v95, v95
    s_nop 0
    v_add_f32 v105, v88, v89
    v_add_f32 v106, v90, v91
    v_add_f32 v107, v92, v93
    v_add_f32 v108, v94, v95
    v_add_f32 v105, v105, v106
    v_add_f32 v107, v107, v108
    v_add_f32 v105, v105, v107
    v_rcp_f32 v105, v105
    s_waitcnt vmcnt(0)
    v_sub_f32 v84, 1.0, v84
    v_mul_f32 v105, v105, v84
    v_lshlrev_b32 v106, 16, v52
    v_and_b32 v107, 0xffff0000, v52
    v_mul_f32 v112, v88, v106
    v_mul_f32 v113, v88, v107
    v_lshlrev_b32 v106, 16, v53
    v_and_b32 v107, 0xffff0000, v53
    v_mul_f32 v114, v88, v106
    v_mul_f32 v115, v88, v107
    v_lshlrev_b32 v106, 16, v54
    v_and_b32 v107, 0xffff0000, v54
    v_mul_f32 v116, v88, v106
    v_mul_f32 v117, v88, v107
    v_lshlrev_b32 v106, 16, v55
    v_and_b32 v107, 0xffff0000, v55
    v_mul_f32 v118, v88, v106
    v_mul_f32 v119, v88, v107
    v_lshlrev_b32 v106, 16, v56
    v_and_b32 v107, 0xffff0000, v56
    v_fmac_f32 v112, v89, v106
    v_fmac_f32 v113, v89, v107
    v_lshlrev_b32 v106, 16, v57
    v_and_b32 v107, 0xffff0000, v57
    v_fmac_f32 v114, v89, v106
    v_fmac_f32 v115, v89, v107
    v_lshlrev_b32 v106, 16, v58
    v_and_b32 v107, 0xffff0000, v58
    v_fmac_f32 v116, v89, v106
    v_fmac_f32 v117, v89, v107
    v_lshlrev_b32 v106, 16, v59
    v_and_b32 v107, 0xffff0000, v59
    v_fmac_f32 v118, v89, v106
    v_fmac_f32 v119, v89, v107
    v_lshlrev_b32 v106, 16, v60
    v_and_b32 v107, 0xffff0000, v60
    v_fmac_f32 v112, v90, v106
    v_fmac_f32 v113, v90, v107
    v_lshlrev_b32 v106, 16, v61
    v_and_b32 v107, 0xffff0000, v61
    v_fmac_f32 v114, v90, v106
    v_fmac_f32 v115, v90, v107
    v_lshlrev_b32 v106, 16, v62
    v_and_b32 v107, 0xffff0000, v62
    v_fmac_f32 v116, v90, v106
    v_fmac_f32 v117, v90, v107
    v_lshlrev_b32 v106, 16, v63
    v_and_b32 v107, 0xffff0000, v63
    v_fmac_f32 v118, v90, v106
    v_fmac_f32 v119, v90, v107
    v_lshlrev_b32 v106, 16, v64
    v_and_b32 v107, 0xffff0000, v64
    v_fmac_f32 v112, v91, v106
    v_fmac_f32 v113, v91, v107
    v_lshlrev_b32 v106, 16, v65
    v_and_b32 v107, 0xffff0000, v65
    v_fmac_f32 v114, v91, v106
    v_fmac_f32 v115, v91, v107
    v_lshlrev_b32 v106, 16, v66
    v_and_b32 v107, 0xffff0000, v66
    v_fmac_f32 v116, v91, v106
    v_fmac_f32 v117, v91, v107
    v_lshlrev_b32 v106, 16, v67
    v_and_b32 v107, 0xffff0000, v67
    v_fmac_f32 v118, v91, v106
    v_fmac_f32 v119, v91, v107
    v_lshlrev_b32 v106, 16, v68
    v_and_b32 v107, 0xffff0000, v68
    v_fmac_f32 v112, v92, v106
    v_fmac_f32 v113, v92, v107
    v_lshlrev_b32 v106, 16, v69
    v_and_b32 v107, 0xffff0000, v69
    v_fmac_f32 v114, v92, v106
    v_fmac_f32 v115, v92, v107
    v_lshlrev_b32 v106, 16, v70
    v_and_b32 v107, 0xffff0000, v70
    v_fmac_f32 v116, v92, v106
    v_fmac_f32 v117, v92, v107
    v_lshlrev_b32 v106, 16, v71
    v_and_b32 v107, 0xffff0000, v71
    v_fmac_f32 v118, v92, v106
    v_fmac_f32 v119, v92, v107
    v_lshlrev_b32 v106, 16, v72
    v_and_b32 v107, 0xffff0000, v72
    v_fmac_f32 v112, v93, v106
    v_fmac_f32 v113, v93, v107
    v_lshlrev_b32 v106, 16, v73
    v_and_b32 v107, 0xffff0000, v73
    v_fmac_f32 v114, v93, v106
    v_fmac_f32 v115, v93, v107
    v_lshlrev_b32 v106, 16, v74
    v_and_b32 v107, 0xffff0000, v74
    v_fmac_f32 v116, v93, v106
    v_fmac_f32 v117, v93, v107
    v_lshlrev_b32 v106, 16, v75
    v_and_b32 v107, 0xffff0000, v75
    v_fmac_f32 v118, v93, v106
    v_fmac_f32 v119, v93, v107
    v_lshlrev_b32 v106, 16, v76
    v_and_b32 v107, 0xffff0000, v76
    v_fmac_f32 v112, v94, v106
    v_fmac_f32 v113, v94, v107
    v_lshlrev_b32 v106, 16, v77
    v_and_b32 v107, 0xffff0000, v77
    v_fmac_f32 v114, v94, v106
    v_fmac_f32 v115, v94, v107
    v_lshlrev_b32 v106, 16, v78
    v_and_b32 v107, 0xffff0000, v78
    v_fmac_f32 v116, v94, v106
    v_fmac_f32 v117, v94, v107
    v_lshlrev_b32 v106, 16, v79
    v_and_b32 v107, 0xffff0000, v79
    v_fmac_f32 v118, v94, v106
    v_fmac_f32 v119, v94, v107
    v_lshlrev_b32 v106, 16, v80
    v_and_b32 v107, 0xffff0000, v80
    v_fmac_f32 v112, v95, v106
    v_fmac_f32 v113, v95, v107
    v_lshlrev_b32 v106, 16, v81
    v_and_b32 v107, 0xffff0000, v81
    v_fmac_f32 v114, v95, v106
    v_fmac_f32 v115, v95, v107
    v_lshlrev_b32 v106, 16, v82
    v_and_b32 v107, 0xffff0000, v82
    v_fmac_f32 v116, v95, v106
    v_fmac_f32 v117, v95, v107
    v_lshlrev_b32 v106, 16, v83
    v_and_b32 v107, 0xffff0000, v83
    v_fmac_f32 v118, v95, v106
    v_fmac_f32 v119, v95, v107
    v_mul_f32 v112, v112, v105
    v_mul_f32 v113, v113, v105
    v_mul_f32 v114, v114, v105
    v_mul_f32 v115, v115, v105
    v_mul_f32 v116, v116, v105
    v_mul_f32 v117, v117, v105
    v_mul_f32 v118, v118, v105
    v_mul_f32 v119, v119, v105
    v_cvt_pk_bf16_f32 v120, v112, v113
    v_cvt_pk_bf16_f32 v121, v114, v115
    v_cvt_pk_bf16_f32 v122, v116, v117
    v_cvt_pk_bf16_f32 v123, v118, v119
    s_mul_i32 s51, s27, 147456
    s_add_u32 s28, s28, 128
    s_lshl_b32 s28, s28, 10
    s_add_u32 s51, s51, s28
    s_add_u32 s51, s51, 61931520
    s_add_u32 s30, s16, s51
    s_addc_u32 s31, s17, 0
    v_min_u32 v123, -2, v123
    v_lshlrev_b32 v6, 4, v1
    global_store_dwordx4 v6, v[120:123], s[30:31] sc1
    s_add_u32 s43, s43, 896
    s_cmp_lt_u32 s43, 2048
    s_cbranch_scc1 PH2_L
    s_waitcnt vmcnt(0)
    s_barrier
    v_mov_b32 v4, 16640
    v_mov_b32 v5, 1
    s_cmp_eq_u32 s22, 0
    s_cselect_b64 exec, 1, 0
    global_atomic_add v4, v5, s[2:3]
    s_mov_b64 exec, -1
    s_branch PH2
PH2_END:
    v_mov_b32 v4, 17024
    v_mov_b32 v5, 1
    v_mov_b32 v6, 162816
    s_cmp_lg_u32 s22, 0
    s_cbranch_scc1 tk_16
    s_mov_b64 exec, 1
    global_atomic_add v7, v4, v5, s[2:3] sc0
    s_waitcnt vmcnt(0)
    ds_write_b32 v6, v7
    s_mov_b64 exec, -1
    s_waitcnt lgkmcnt(0)
tk_16:
    s_barrier
    ds_read_b32 v7, v6
    s_waitcnt lgkmcnt(0)
    v_readfirstlane_b32 s45, v7
    s_barrier
    s_cmp_lt_u32 s45, 16
    s_cbranch_scc1 ROLE4
    s_cmp_ge_u32 s45, 192
    s_cbranch_scc1 CH_EXIT
    s_cmp_ge_u32 s45, 64
    s_cbranch_scc1 ROLE4
ROLE3:
    v_mov_b32 v4, 16384
    s_mov_b32 s25, 0
    s_cmp_lg_u32 s22, 0
    s_cbranch_scc1 wd_18
wt_17:
    global_load_dword v5, v4, s[2:3] sc1
    s_add_u32 s25, s25, 1
    s_cmp_gt_u32 s25, 300000
    s_cbranch_scc1 W_ABORT
    s_waitcnt vmcnt(0)
    v_readfirstlane_b32 s51, v5
    s_nop 1
    s_cmp_ge_u32 s51, 96
    s_cbranch_scc1 wd_18
    s_sleep 16
    s_branch wt_17
wd_18:
    s_barrier
    s_cmp_lg_u32 s22, 0
    s_cbranch_scc1 aq_19
    buffer_inv sc1
    s_waitcnt vmcnt(0)
aq_19:
    s_barrier
    v_mbcnt_lo_u32_b32 v4, -1, 0
    v_mbcnt_hi_u32_b32 v4, -1, v4
    v_lshlrev_b32 v0, 4, v4
    v_lshlrev_b32 v2, 3, v4
    v_and_b32 v5, 15, v4
    v_lshrrev_b32 v6, 4, v4
    v_lshlrev_b32 v3, 2, v5
    v_lshrrev_b32 v7, 2, v5
    v_lshlrev_b32 v7, 1, v7
    v_and_b32 v8, 1, v5
    v_add_u32 v7, v7, v8
    v_lshlrev_b32 v7, 8, v7
    v_lshl_add_u32 v1, v6, 4, v7
    v_lshl_add_u32 v7, v6, 2, 0
    v_cmp_le_u32 s[84:85], v7, v5
    v_lshl_add_u32 v7, v6, 2, 1
    v_cmp_le_u32 s[86:87], v7, v5
    v_lshl_add_u32 v7, v6, 2, 2
    v_cmp_le_u32 s[88:89], v7, v5
    v_lshl_add_u32 v7, v6, 2, 3
    v_cmp_le_u32 s[90:91], v7, v5
    s_mov_b32 s27, 0
    s_mov_b64 s[44:45], 0
    v_mov_b32 v203, 0
W3_L:
    v_mov_b32 v200, 17152
    v_mov_b32 v201, 1
    s_mov_b64 exec, 1
    global_atomic_add v202, v200, v201, s[2:3] sc0
    s_mov_b64 exec, -1
    s_waitcnt vmcnt(0)
    v_readfirstlane_b32 s28, v202
    s_nop 1
    s_mov_b64 exec, s[44:45]
    global_atomic_add v203, v201, s[2:3]
    s_mov_b64 exec, -1
    s_cmp_ge_u32 s28, 2048
    s_cbranch_scc1 CH_EXIT
    s_lshr_b32 s27, s28, 5
    s_and_b32 s28, s28, 31
    s_lshl_b32 s48, s28, 7
    v_mov_b32 v204, s48
    s_mov_b32 s25, 0
W3_KV:
    global_load_dwordx4 v[208:211], v204, s[2:3] sc1
    s_add_u32 s25, s25, 1
    s_cmp_gt_u32 s25, 300000
    s_cbranch_scc1 W_ABORT
    s_waitcnt vmcnt(0)
    v_min_u32 v208, v208, v210
    s_nop 0
    v_readfirstlane_b32 s55, v208
    s_nop 1
    s_cmp_ge_u32 s55, 64
    s_cselect_b32 s55, 100, s55
    s_cmp_gt_u32 s55, s27
    s_cbranch_scc1 W3_KVOK
    s_sleep 8
    s_branch W3_KV
W3_KVOK:
    s_lshl_b32 s51, s27, 5
    s_add_u32 s51, s51, s28
    s_lshl_b32 s52, s51, 13
    s_add_u32 s52, s52, 35655680
    s_add_u32 s30, s16, s52
    s_addc_u32 s31, s17, 0
    s_lshl_b32 s52, s51, 13
    s_add_u32 s52, s52, 2101248
    s_add_u32 s32, s16, s52
    s_addc_u32 s33, s17, 0
    s_lshl_b32 s52, s51, 13
    s_add_u32 s52, s52, 18878464
    s_add_u32 s34, s16, s52
    s_addc_u32 s35, s17, 0
    s_lshl_b32 s52, s51, 11
    s_add_u32 s52, s52, 52494336
    s_add_u32 s36, s16, s52
    s_addc_u32 s37, s17, 0
    s_lshl_b32 s52, s51, 11
    s_add_u32 s52, s52, 57737216
    s_add_u32 s38, s16, s52
    s_addc_u32 s39, s17, 0
    s_lshl_b32 s52, s27, 7
    s_add_u32 s52, s52, 87097344
    s_add_u32 s40, s16, s52
    s_addc_u32 s41, s17, 0
    global_load_dwordx4 v[4:7], v0, s[30:31] offset:-4096 sc1
    global_load_dwordx4 v[8:11], v0, s[30:31] offset:-3072 sc1
    global_load_dwordx4 v[12:15], v0, s[30:31] offset:-2048 sc1
    global_load_dwordx4 v[16:19], v0, s[30:31] offset:-1024 sc1
    global_load_dwordx4 v[20:23], v0, s[30:31] offset:0 sc1
    global_load_dwordx4 v[24:27], v0, s[30:31] offset:1024 sc1
    global_load_dwordx4 v[28:31], v0, s[30:31] offset:2048 sc1
    global_load_dwordx4 v[32:35], v0, s[30:31] offset:3072 sc1
    global_load_dwordx4 v[36:39], v0, s[32:33] offset:-4096 sc1
    global_load_dwordx4 v[40:43], v0, s[32:33] offset:-3072 sc1
    global_load_dwordx4 v[44:47], v0, s[32:33] offset:-2048 sc1
    global_load_dwordx4 v[48:51], v0, s[32:33] offset:-1024 sc1
    global_load_dwordx4 v[52:55], v0, s[32:33] offset:0 sc1
    global_load_dwordx4 v[56:59], v0, s[32:33] offset:1024 sc1
    global_load_dwordx4 v[60:63], v0, s[32:33] offset:2048 sc1
    global_load_dwordx4 v[64:67], v0, s[32:33] offset:3072 sc1
    global_load_dwordx4 v[84:87], v0, s[34:35] offset:-4096 sc1
    global_load_dwordx4 v[88:91], v0, s[34:35] offset:-3072 sc1
    global_load_dwordx4 v[92:95], v0, s[34:35] offset:-2048 sc1
    global_load_dwordx4 v[96:99], v0, s[34:35] offset:-1024 sc1
    global_load_dwordx4 v[100:103], v0, s[34:35] offset:0 sc1
    global_load_dwordx4 v[104:107], v0, s[34:35] offset:1024 sc1
    global_load_dwordx4 v[108:111], v0, s[34:35] offset:2048 sc1
    global_load_dwordx4 v[112:115], v0, s[34:35] offset:3072 sc1
    global_load_dword v126, v3, s[40:41] offset:0 sc1
    global_load_dword v127, v3, s[40:41] offset:64 sc1
    s_mul_i32 s51, s27, 294912
    s_lshl_b32 s52, s28, 12
    s_add_u32 s51, s51, s52
    s_add_u32 s51, s51, 61931520
    s_add_u32 s30, s16, s51
    s_addc_u32 s31, s17, 0
    s_add_u32 s32, s30, 147456
    s_addc_u32 s33, s31, 0
    s_mov_b32 s42, 0x3e0293ee
    v_mov_b32 v124, 0
    v_mov_b32 v155, 0xff800000
    s_waitcnt vmcnt(10)
    v_mfma_f32_16x16x32_bf16 v[132:135], v[36:39], v[4:7], 0
    v_mfma_f32_16x16x32_bf16 v[140:143], v[36:39], v[20:23], 0
    v_mfma_f32_16x16x32_bf16 v[144:147], v[52:55], v[20:23], 0
    v_mfma_f32_16x16x32_bf16 v[132:135], v[40:43], v[8:11], v[132:135]
    v_mfma_f32_16x16x32_bf16 v[140:143], v[40:43], v[24:27], v[140:143]
    v_mfma_f32_16x16x32_bf16 v[144:147], v[56:59], v[24:27], v[144:147]
    v_mfma_f32_16x16x32_bf16 v[132:135], v[44:47], v[12:15], v[132:135]
    v_mfma_f32_16x16x32_bf16 v[140:143], v[44:47], v[28:31], v[140:143]
    v_mfma_f32_16x16x32_bf16 v[144:147], v[60:63], v[28:31], v[144:147]
    v_mfma_f32_16x16x32_bf16 v[132:135], v[48:51], v[16:19], v[132:135]
    v_mfma_f32_16x16x32_bf16 v[140:143], v[48:51], v[32:35], v[140:143]
    v_mfma_f32_16x16x32_bf16 v[144:147], v[64:67], v[32:35], v[144:147]
    s_lshl_b32 s48, s28, 7
    s_add_u32 s48, s48, 4096
    s_add_u32 s49, s27, 1
    s_min_u32 s52, s27, 62
    s_cmp_ge_u32 s27, 56
    s_cselect_b32 s49, s52, s49
    v_mov_b32 v200, s48
    s_mov_b32 s25, 0
wt_20:
    global_load_dword v201, v200, s[2:3] sc1
    s_add_u32 s25, s25, 1
    s_cmp_gt_u32 s25, 300000
    s_cbranch_scc1 W_ABORT
    s_waitcnt vmcnt(0)
    v_readfirstlane_b32 s51, v201
    s_nop 1
    s_cmp_ge_u32 s51, s49
    s_cbranch_scc1 wd_21
    s_sleep 4
    s_branch wt_20
wd_21:
    s_mov_b32 s25, 0
W3_M:
    global_load_dwordx4 v[68:71], v1, s[36:37] offset:0 sc1
    global_load_dwordx4 v[72:75], v1, s[36:37] offset:64 sc1
    global_load_dwordx4 v[76:79], v1, s[36:37] offset:128 sc1
    global_load_dwordx4 v[80:83], v1, s[36:37] offset:192 sc1
    global_load_dwordx2 v[116:117], v2, s[38:39] offset:0 sc1
    global_load_dwordx2 v[118:119], v2, s[38:39] offset:512 sc1
    global_load_dwordx2 v[120:121], v2, s[38:39] offset:1024 sc1
    global_load_dwordx2 v[122:123], v2, s[38:39] offset:1536 sc1
    s_cmp_lt_u32 s27, 56
    s_cbranch_scc1 W3_MOK
    s_add_u32 s25, s25, 1
    s_cmp_gt_u32 s25, 300000
    s_cbranch_scc1 W_ABORT
    s_waitcnt vmcnt(0)
    v_max3_u32 v148, v68, v69, v70
    v_max3_u32 v149, v71, v72, v73
    v_max3_u32 v149, v149, v74, v75
    v_max3_u32 v148, v148, v76, v77
    v_max3_u32 v149, v149, v78, v79
    v_max3_u32 v148, v148, v80, v81
    v_max3_u32 v149, v149, v82, v83
    v_max3_u32 v148, v148, v116, v117
    v_max3_u32 v149, v149, v118, v119
    v_max3_u32 v148, v148, v120, v121
    v_max3_u32 v149, v149, v122, v123
    v_max_u32 v148, v148, v149
    v_cmp_eq_u32 vcc, -1, v148
    s_cbranch_vccnz W3_M
W3_MOK:
    s_waitcnt vmcnt(4)
    v_mfma_f32_16x16x32_bf16 v[128:131], v[68:71], v[4:7], 0
    v_mfma_f32_16x16x32_bf16 v[136:139], v[68:71], v[20:23], 0
    v_mfma_f32_16x16x32_bf16 v[128:131], v[72:75], v[8:11], v[128:131]
    v_mfma_f32_16x16x32_bf16 v[136:139], v[72:75], v[24:27], v[136:139]
    v_mfma_f32_16x16x32_bf16 v[128:131], v[76:79], v[12:15], v[128:131]
    v_mfma_f32_16x16x32_bf16 v[136:139], v[76:79], v[28:31], v[136:139]
    v_mfma_f32_16x16x32_bf16 v[128:131], v[80:83], v[16:19], v[128:131]
    v_mfma_f32_16x16x32_bf16 v[136:139], v[80:83], v[32:35], v[136:139]
    v_cndmask_b32 v132, v155, v132, s[84:85]
    v_cndmask_b32 v133, v155, v133, s[86:87]
    v_cndmask_b32 v134, v155, v134, s[88:89]
    v_cndmask_b32 v135, v155, v135, s[90:91]
    v_cndmask_b32 v144, v155, v144, s[84:85]
    v_cndmask_b32 v145, v155, v145, s[86:87]
    v_cndmask_b32 v146, v155, v146, s[88:89]
    v_cndmask_b32 v147, v155, v147, s[90:91]
    v_max3_f32 v148, v132, v133, v134
    v_max3_f32 v148, v148, v135, v128
    v_max_f32 v148, v148, v129
    v_max3_f32 v149, v140, v141, v142
    v_max3_f32 v149, v149, v143, v144
    v_max3_f32 v149, v149, v145, v146
    v_max3_f32 v149, v149, v147, v136
    v_max_f32 v149, v149, v137
    v_mov_b32 v150, v148
    v_mov_b32 v151, v149
    s_nop 0
    v_permlane16_swap_b32 v148, v150
    v_permlane16_swap_b32 v149, v151
    v_max_f32 v148, v148, v150
    v_max_f32 v149, v149, v151
    v_mov_b32 v150, v148
    v_mov_b32 v151, v149
    s_nop 0
    v_permlane32_swap_b32 v148, v150
    v_permlane32_swap_b32 v149, v151
    v_max_f32 v148, v148, v150
    v_max_f32 v149, v149, v151
    v_mul_f32 v148, s42, v148
    v_fma_f32 v128, v128, s42, -v148
    v_fma_f32 v129, v129, s42, -v148
    v_fma_f32 v132, v132, s42, -v148
    v_fma_f32 v133, v133, s42, -v148
    v_fma_f32 v134, v134, s42, -v148
    v_fma_f32 v135, v135, s42, -v148
    v_exp_f32 v128, v128
    v_exp_f32 v129, v129
    v_exp_f32 v132, v132
    v_exp_f32 v133, v133
    v_exp_f32 v134, v134
    v_exp_f32 v135, v135
    v_mul_f32 v149, s42, v149
    v_fma_f32 v136, v136, s42, -v149
    v_fma_f32 v137, v137, s42, -v149
    v_fma_f32 v140, v140, s42, -v149
    v_fma_f32 v141, v141, s42, -v149
    v_fma_f32 v142, v142, s42, -v149
    v_fma_f32 v143, v143, s42, -v149
    v_fma_f32 v144, v144, s42, -v149
    v_fma_f32 v145, v145, s42, -v149
    v_fma_f32 v146, v146, s42, -v149
    v_fma_f32 v147, v147, s42, -v149
    v_exp_f32 v136, v136
    v_exp_f32 v137, v137
    v_exp_f32 v140, v140
    v_exp_f32 v141, v141
    v_exp_f32 v142, v142
    v_exp_f32 v143, v143
    v_exp_f32 v144, v144
    v_exp_f32 v145, v145
    v_exp_f32 v146, v146
    v_exp_f32 v147, v147
    v_cvt_pk_bf16_f32 v156, v132, v133
    v_cvt_pk_bf16_f32 v157, v134, v135
    v_mov_b32 v158, 0
    v_mov_b32 v159, 0
    v_cvt_pk_bf16_f32 v160, v128, v129
    v_mov_b32 v161, 0
    v_cvt_pk_bf16_f32 v162, v140, v141
    v_cvt_pk_bf16_f32 v163, v142, v143
    v_cvt_pk_bf16_f32 v164, v144, v145
    v_cvt_pk_bf16_f32 v165, v146, v147
    v_cvt_pk_bf16_f32 v166, v136, v137
    v_mov_b32 v167, 0
    v_mov_b32 v152, 0
    v_mov_b32 v153, v160
    v_mov_b32 v154, 0
    v_mov_b32 v155, v166
    v_add_f32 v148, v128, v129
    v_add_f32 v148, v148, v132
    v_add_f32 v148, v148, v133
    v_add_f32 v148, v148, v134
    v_add_f32 v148, v148, v135
    v_add_f32 v149, v136, v137
    v_add_f32 v149, v149, v140
    v_add_f32 v149, v149, v141
    v_add_f32 v149, v149, v142
    v_add_f32 v149, v149, v143
    v_add_f32 v149, v149, v144
    v_add_f32 v149, v149, v145
    v_add_f32 v149, v149, v146
    v_add_f32 v149, v149, v147
    s_waitcnt vmcnt(0)
    v_mfma_f32_16x16x32_bf16 v[4:7], v[84:87], v[156:159], 0
    v_mfma_f32_16x16x32_bf16 v[8:11], v[88:91], v[156:159], 0
    v_mfma_f32_16x16x32_bf16 v[12:15], v[92:95], v[156:159], 0
    v_mfma_f32_16x16x32_bf16 v[16:19], v[96:99], v[156:159], 0
    v_mfma_f32_16x16x32_bf16 v[20:23], v[100:103], v[156:159], 0
    v_mfma_f32_16x16x32_bf16 v[24:27], v[104:107], v[156:159], 0
    v_mfma_f32_16x16x32_bf16 v[28:31], v[108:111], v[156:159], 0
    v_mfma_f32_16x16x32_bf16 v[32:35], v[112:115], v[156:159], 0
    v_mov_b32 v150, v148
    v_mov_b32 v151, v149
    s_nop 0
    v_permlane16_swap_b32 v148, v150
    v_permlane16_swap_b32 v149, v151
    v_add_f32 v148, v148, v150
    v_add_f32 v149, v149, v151
    v_mov_b32 v150, v148
    v_mov_b32 v151, v149
    s_nop 0
    v_permlane32_swap_b32 v148, v150
    v_permlane32_swap_b32 v149, v151
    v_add_f32 v148, v148, v150
    v_add_f32 v149, v149, v151
    v_mfma_f32_16x16x16_bf16 v[4:7], v[116:117], v[160:161], v[4:7]
    v_mfma_f32_16x16x16_bf16 v[8:11], v[116:117], v[152:153], v[8:11]
    v_mfma_f32_16x16x16_bf16 v[12:15], v[118:119], v[160:161], v[12:15]
    v_mfma_f32_16x16x16_bf16 v[16:19], v[118:119], v[152:153], v[16:19]
    v_mfma_f32_16x16x16_bf16 v[20:23], v[120:121], v[160:161], v[20:23]
    v_mfma_f32_16x16x16_bf16 v[24:27], v[120:121], v[152:153], v[24:27]
    v_mfma_f32_16x16x16_bf16 v[28:31], v[122:123], v[160:161], v[28:31]
    v_mfma_f32_16x16x16_bf16 v[32:35], v[122:123], v[152:153], v[32:35]
    v_rcp_f32 v148, v148
    v_rcp_f32 v149, v149
    s_nop 0
    v_mul_f32 v148, v148, v126
    v_mul_f32 v149, v149, v127
    v_mfma_f32_16x16x32_bf16 v[36:39], v[84:87], v[162:165], 0
    v_mfma_f32_16x16x32_bf16 v[40:43], v[88:91], v[162:165], 0
    v_mfma_f32_16x16x32_bf16 v[44:47], v[92:95], v[162:165], 0
    v_mfma_f32_16x16x32_bf16 v[48:51], v[96:99], v[162:165], 0
    v_mfma_f32_16x16x32_bf16 v[52:55], v[100:103], v[162:165], 0
    v_mfma_f32_16x16x32_bf16 v[56:59], v[104:107], v[162:165], 0
    v_mfma_f32_16x16x32_bf16 v[60:63], v[108:111], v[162:165], 0
    v_mfma_f32_16x16x32_bf16 v[64:67], v[112:115], v[162:165], 0
    v_mfma_f32_16x16x16_bf16 v[36:39], v[116:117], v[166:167], v[36:39]
    v_mfma_f32_16x16x16_bf16 v[40:43], v[116:117], v[154:155], v[40:43]
    v_mfma_f32_16x16x16_bf16 v[44:47], v[118:119], v[166:167], v[44:47]
    v_mfma_f32_16x16x16_bf16 v[48:51], v[118:119], v[154:155], v[48:51]
    v_mfma_f32_16x16x16_bf16 v[52:55], v[120:121], v[166:167], v[52:55]
    v_mfma_f32_16x16x16_bf16 v[56:59], v[120:121], v[154:155], v[56:59]
    v_mfma_f32_16x16x16_bf16 v[60:63], v[122:123], v[166:167], v[60:63]
    v_mfma_f32_16x16x16_bf16 v[64:67], v[122:123], v[154:155], v[64:67]
    v_mul_f32 v4, v4, v148
    v_mul_f32 v5, v5, v148
    v_mul_f32 v6, v6, v148
    v_mul_f32 v7, v7, v148
    v_mul_f32 v8, v8, v148
    v_mul_f32 v9, v9, v148
    v_mul_f32 v10, v10, v148
    v_mul_f32 v11, v11, v148
    v_cvt_pk_bf16_f32 v4, v4, v5
    v_cvt_pk_bf16_f32 v5, v6, v7
    v_cvt_pk_bf16_f32 v6, v8, v9
    v_cvt_pk_bf16_f32 v7, v10, v11
    v_min_u32 v7, -2, v7
    global_store_dwordx4 v0, v[4:7], s[30:31] offset:0 sc1
    v_mul_f32 v12, v12, v148
    v_mul_f32 v13, v13, v148
    v_mul_f32 v14, v14, v148
    v_mul_f32 v15, v15, v148
    v_mul_f32 v16, v16, v148
    v_mul_f32 v17, v17, v148
    v_mul_f32 v18, v18, v148
    v_mul_f32 v19, v19, v148
    v_cvt_pk_bf16_f32 v12, v12, v13
    v_cvt_pk_bf16_f32 v13, v14, v15
    v_cvt_pk_bf16_f32 v14, v16, v17
    v_cvt_pk_bf16_f32 v15, v18, v19
    v_min_u32 v15, -2, v15
    global_store_dwordx4 v0, v[12:15], s[30:31] offset:1024 sc1
    v_mul_f32 v20, v20, v148
    v_mul_f32 v21, v21, v148
    v_mul_f32 v22, v22, v148
    v_mul_f32 v23, v23, v148
    v_mul_f32 v24, v24, v148
    v_mul_f32 v25, v25, v148
    v_mul_f32 v26, v26, v148
    v_mul_f32 v27, v27, v148
    v_cvt_pk_bf16_f32 v20, v20, v21
    v_cvt_pk_bf16_f32 v21, v22, v23
    v_cvt_pk_bf16_f32 v22, v24, v25
    v_cvt_pk_bf16_f32 v23, v26, v27
    v_min_u32 v23, -2, v23
    global_store_dwordx4 v0, v[20:23], s[30:31] offset:2048 sc1
    v_mul_f32 v28, v28, v148
    v_mul_f32 v29, v29, v148
    v_mul_f32 v30, v30, v148
    v_mul_f32 v31, v31, v148
    v_mul_f32 v32, v32, v148
    v_mul_f32 v33, v33, v148
    v_mul_f32 v34, v34, v148
    v_mul_f32 v35, v35, v148
    v_cvt_pk_bf16_f32 v28, v28, v29
    v_cvt_pk_bf16_f32 v29, v30, v31
    v_cvt_pk_bf16_f32 v30, v32, v33
    v_cvt_pk_bf16_f32 v31, v34, v35
    v_min_u32 v31, -2, v31
    global_store_dwordx4 v0, v[28:31], s[30:31] offset:3072 sc1
    v_mul_f32 v36, v36, v149
    v_mul_f32 v37, v37, v149
    v_mul_f32 v38, v38, v149
    v_mul_f32 v39, v39, v149
    v_mul_f32 v40, v40, v149
    v_mul_f32 v41, v41, v149
    v_mul_f32 v42, v42, v149
    v_mul_f32 v43, v43, v149
    v_cvt_pk_bf16_f32 v36, v36, v37
    v_cvt_pk_bf16_f32 v37, v38, v39
    v_cvt_pk_bf16_f32 v38, v40, v41
    v_cvt_pk_bf16_f32 v39, v42, v43
    v_min_u32 v39, -2, v39
    global_store_dwordx4 v0, v[36:39], s[32:33] offset:0 sc1
    v_mul_f32 v44, v44, v149
    v_mul_f32 v45, v45, v149
    v_mul_f32 v46, v46, v149
    v_mul_f32 v47, v47, v149
    v_mul_f32 v48, v48, v149
    v_mul_f32 v49, v49, v149
    v_mul_f32 v50, v50, v149
    v_mul_f32 v51, v51, v149
    v_cvt_pk_bf16_f32 v44, v44, v45
    v_cvt_pk_bf16_f32 v45, v46, v47
    v_cvt_pk_bf16_f32 v46, v48, v49
    v_cvt_pk_bf16_f32 v47, v50, v51
    v_min_u32 v47, -2, v47
    global_store_dwordx4 v0, v[44:47], s[32:33] offset:1024 sc1
    v_mul_f32 v52, v52, v149
    v_mul_f32 v53, v53, v149
    v_mul_f32 v54, v54, v149
    v_mul_f32 v55, v55, v149
    v_mul_f32 v56, v56, v149
    v_mul_f32 v57, v57, v149
    v_mul_f32 v58, v58, v149
    v_mul_f32 v59, v59, v149
    v_cvt_pk_bf16_f32 v52, v52, v53
    v_cvt_pk_bf16_f32 v53, v54, v55
    v_cvt_pk_bf16_f32 v54, v56, v57
    v_cvt_pk_bf16_f32 v55, v58, v59
    v_min_u32 v55, -2, v55
    global_store_dwordx4 v0, v[52:55], s[32:33] offset:2048 sc1
    s_nop 1
    v_mul_f32 v60, v60, v149
    v_mul_f32 v61, v61, v149
    v_mul_f32 v62, v62, v149
    v_mul_f32 v63, v63, v149
    v_mul_f32 v64, v64, v149
    v_mul_f32 v65, v65, v149
    v_mul_f32 v66, v66, v149
    v_mul_f32 v67, v67, v149
    v_cvt_pk_bf16_f32 v60, v60, v61
    v_cvt_pk_bf16_f32 v61, v62, v63
    v_cvt_pk_bf16_f32 v62, v64, v65
    v_cvt_pk_bf16_f32 v63, v66, v67
    v_min_u32 v63, -2, v63
    global_store_dwordx4 v0, v[60:63], s[32:33] offset:3072 sc1
    s_lshl_b32 s48, s27, 7
    s_add_u32 s48, s48, 8192
    v_mov_b32 v203, s48
    s_mov_b64 s[44:45], 1
    s_branch W3_L
ROLE4:
    s_and_b32 s26, s45, 15
    v_mov_b32 v4, 16768
    s_mov_b32 s25, 0
    s_cmp_lg_u32 s22, 0
    s_cbranch_scc1 wd_23
wt_22:
    global_load_dword v5, v4, s[2:3] sc1
    s_add_u32 s25, s25, 1
    s_cmp_gt_u32 s25, 300000
    s_cbranch_scc1 W_ABORT
    s_waitcnt vmcnt(0)
    v_readfirstlane_b32 s51, v5
    s_nop 1
    s_cmp_ge_u32 s51, 8
    s_cbranch_scc1 wd_23
    s_sleep 4
    s_branch wt_22
wd_23:
    s_barrier
    v_mbcnt_lo_u32_b32 v1, -1, 0
    v_mbcnt_hi_u32_b32 v1, -1, v1
    v_lshlrev_b32 v1, 4, v1
    s_lshl_b32 s51, s26, 2
    s_add_u32 s51, s51, s22
    s_mul_i32 s51, s51, 73728
    s_add_u32 s51, s51, 87175168
    s_add_u32 s28, s16, s51
    s_addc_u32 s29, s17, 0
    global_load_dwordx4 a[0:3], v1, s[28:29] offset:-4096 sc1
    global_load_dwordx4 a[4:7], v1, s[28:29] offset:-3072 sc1
    global_load_dwordx4 a[8:11], v1, s[28:29] offset:-2048 sc1
    global_load_dwordx4 a[12:15], v1, s[28:29] offset:-1024 sc1
    global_load_dwordx4 a[16:19], v1, s[28:29] offset:0 sc1
    global_load_dwordx4 a[20:23], v1, s[28:29] offset:1024 sc1
    global_load_dwordx4 a[24:27], v1, s[28:29] offset:2048 sc1
    global_load_dwordx4 a[28:31], v1, s[28:29] offset:3072 sc1
    s_add_u32 s28, s28, 8192
    s_addc_u32 s29, s29, 0
    global_load_dwordx4 a[32:35], v1, s[28:29] offset:-4096 sc1
    global_load_dwordx4 a[36:39], v1, s[28:29] offset:-3072 sc1
    global_load_dwordx4 a[40:43], v1, s[28:29] offset:-2048 sc1
    global_load_dwordx4 a[44:47], v1, s[28:29] offset:-1024 sc1
    global_load_dwordx4 a[48:51], v1, s[28:29] offset:0 sc1
    global_load_dwordx4 a[52:55], v1, s[28:29] offset:1024 sc1
    global_load_dwordx4 a[56:59], v1, s[28:29] offset:2048 sc1
    global_load_dwordx4 a[60:63], v1, s[28:29] offset:3072 sc1
    s_add_u32 s28, s28, 8192
    s_addc_u32 s29, s29, 0
    global_load_dwordx4 a[64:67], v1, s[28:29] offset:-4096 sc1
    global_load_dwordx4 a[68:71], v1, s[28:29] offset:-3072 sc1
    global_load_dwordx4 a[72:75], v1, s[28:29] offset:-2048 sc1
    global_load_dwordx4 a[76:79], v1, s[28:29] offset:-1024 sc1
    global_load_dwordx4 a[80:83], v1, s[28:29] offset:0 sc1
    global_load_dwordx4 a[84:87], v1, s[28:29] offset:1024 sc1
    global_load_dwordx4 a[88:91], v1, s[28:29] offset:2048 sc1
    global_load_dwordx4 a[92:95], v1, s[28:29] offset:3072 sc1
    s_add_u32 s28, s28, 8192
    s_addc_u32 s29, s29, 0
    global_load_dwordx4 a[96:99], v1, s[28:29] offset:-4096 sc1
    global_load_dwordx4 a[100:103], v1, s[28:29] offset:-3072 sc1
    global_load_dwordx4 a[104:107], v1, s[28:29] offset:-2048 sc1
    global_load_dwordx4 a[108:111], v1, s[28:29] offset:-1024 sc1
    global_load_dwordx4 a[112:115], v1, s[28:29] offset:0 sc1
    global_load_dwordx4 a[116:119], v1, s[28:29] offset:1024 sc1
    global_load_dwordx4 a[120:123], v1, s[28:29] offset:2048 sc1
    global_load_dwordx4 a[124:127], v1, s[28:29] offset:3072 sc1
    s_add_u32 s28, s28, 8192
    s_addc_u32 s29, s29, 0
    global_load_dwordx4 a[128:131], v1, s[28:29] offset:-4096 sc1
    global_load_dwordx4 a[132:135], v1, s[28:29] offset:-3072 sc1
    global_load_dwordx4 a[136:139], v1, s[28:29] offset:-2048 sc1
    global_load_dwordx4 a[140:143], v1, s[28:29] offset:-1024 sc1
    global_load_dwordx4 a[144:147], v1, s[28:29] offset:0 sc1
    global_load_dwordx4 a[148:151], v1, s[28:29] offset:1024 sc1
    global_load_dwordx4 a[152:155], v1, s[28:29] offset:2048 sc1
    global_load_dwordx4 a[156:159], v1, s[28:29] offset:3072 sc1
    s_add_u32 s28, s28, 8192
    s_addc_u32 s29, s29, 0
    global_load_dwordx4 a[160:163], v1, s[28:29] offset:-4096 sc1
    s_waitcnt vmcnt(20)
    global_load_dwordx4 a[164:167], v1, s[28:29] offset:-3072 sc1
    global_load_dwordx4 a[168:171], v1, s[28:29] offset:-2048 sc1
    global_load_dwordx4 a[172:175], v1, s[28:29] offset:-1024 sc1
    global_load_dwordx4 a[176:179], v1, s[28:29] offset:0 sc1
    global_load_dwordx4 a[180:183], v1, s[28:29] offset:1024 sc1
    global_load_dwordx4 a[184:187], v1, s[28:29] offset:2048 sc1
    global_load_dwordx4 a[188:191], v1, s[28:29] offset:3072 sc1
    s_add_u32 s28, s28, 8192
    s_addc_u32 s29, s29, 0
    global_load_dwordx4 a[192:195], v1, s[28:29] offset:-4096 sc1
    global_load_dwordx4 a[196:199], v1, s[28:29] offset:-3072 sc1
    global_load_dwordx4 a[200:203], v1, s[28:29] offset:-2048 sc1
    global_load_dwordx4 a[204:207], v1, s[28:29] offset:-1024 sc1
    global_load_dwordx4 a[208:211], v1, s[28:29] offset:0 sc1
    global_load_dwordx4 a[212:215], v1, s[28:29] offset:1024 sc1
    global_load_dwordx4 a[216:219], v1, s[28:29] offset:2048 sc1
    global_load_dwordx4 a[220:223], v1, s[28:29] offset:3072 sc1
    s_add_u32 s28, s28, 8192
    s_addc_u32 s29, s29, 0
    global_load_dwordx4 a[224:227], v1, s[28:29] offset:-4096 sc1
    global_load_dwordx4 a[228:231], v1, s[28:29] offset:-3072 sc1
    global_load_dwordx4 a[232:235], v1, s[28:29] offset:-2048 sc1
    global_load_dwordx4 a[236:239], v1, s[28:29] offset:-1024 sc1
    global_load_dwordx4 a[240:243], v1, s[28:29] offset:0 sc1
    global_load_dwordx4 a[244:247], v1, s[28:29] offset:1024 sc1
    global_load_dwordx4 a[248:251], v1, s[28:29] offset:2048 sc1
    global_load_dwordx4 a[252:255], v1, s[28:29] offset:3072 sc1
    s_add_u32 s28, s28, 8192
    s_addc_u32 s29, s29, 0
    global_load_dwordx4 v[224:227], v1, s[28:29] offset:-4096 sc1
    global_load_dwordx4 v[228:231], v1, s[28:29] offset:-3072 sc1
    global_load_dwordx4 v[232:235], v1, s[28:29] offset:-2048 sc1
    global_load_dwordx4 v[236:239], v1, s[28:29] offset:-1024 sc1
    global_load_dwordx4 v[240:243], v1, s[28:29] offset:0 sc1
    global_load_dwordx4 v[244:247], v1, s[28:29] offset:1024 sc1
    global_load_dwordx4 v[248:251], v1, s[28:29] offset:2048 sc1
    global_load_dwordx4 v[252:255], v1, s[28:29] offset:3072 sc1
    s_waitcnt vmcnt(0)
    v_mbcnt_lo_u32_b32 v4, -1, 0
    v_mbcnt_hi_u32_b32 v4, -1, v4
    v_lshlrev_b32 v0, 4, v4
    s_lshl_b32 s51, s22, 11
    s_add_u32 s51, s51, 131072
    v_add_u32 v1, s51, v0
    s_and_b32 s52, s22, 1
    s_lshr_b32 s53, s22, 1
    s_lshl_b32 s51, s52, 10
    s_lshl_b32 s54, s53, 3
    s_add_u32 s51, s51, s54
    s_add_u32 s51, s51, 131072
    v_add_u32 v2, s51, v0
    v_and_b32 v5, 15, v4
    v_lshrrev_b32 v6, 4, v4
    v_lshlrev_b32 v5, 10, v5
    v_lshl_add_u32 v3, v6, 3, v5
    s_lshl_b32 s52, s52, 5
    s_lshl_b32 s53, s53, 2
    s_add_u32 s51, s52, s53
    s_lshl_b32 s52, s26, 6
    s_add_u32 s51, s51, s52
    v_add_u32 v3, s51, v3
    v_mov_b32 v4, 16640
    s_mov_b32 s25, 0
    s_cmp_lg_u32 s22, 0
    s_cbranch_scc1 wd_25
wt_24:
    global_load_dword v5, v4, s[2:3] sc1
    s_add_u32 s25, s25, 1
    s_cmp_gt_u32 s25, 300000
    s_cbranch_scc1 W_ABORT
    s_waitcnt vmcnt(0)
    v_readfirstlane_b32 s51, v5
    s_nop 1
    s_cmp_ge_u32 s51, 224
    s_cbranch_scc1 wd_25
    s_sleep 4
    s_branch wt_24
wd_25:
    s_barrier
    s_lshl_b32 s44, s26, 7
    s_add_u32 s44, s44, 17280
W4_L:
    v_mov_b32 v4, s44
    v_mov_b32 v5, 1
    v_mov_b32 v6, 162816
    s_cmp_lg_u32 s22, 0
    s_cbranch_scc1 tk_26
    s_mov_b64 exec, 1
    global_atomic_add v7, v4, v5, s[2:3] sc0
    s_waitcnt vmcnt(0)
    ds_write_b32 v6, v7
    s_mov_b64 exec, -1
    s_waitcnt lgkmcnt(0)
tk_26:
    s_barrier
    ds_read_b32 v7, v6
    s_waitcnt lgkmcnt(0)
    v_readfirstlane_b32 s27, v7
    s_barrier
    s_cmp_ge_u32 s27, 128
    s_cbranch_scc1 W4_END
    s_lshr_b32 s48, s27, 1
    s_lshl_b32 s48, s48, 7
    s_add_u32 s48, s48, 8192
    s_cmp_ge_u32 s27, 112
    s_cselect_b32 s49, 1, 32
    v_mov_b32 v4, s48
    s_mov_b32 s25, 0
    s_cmp_lg_u32 s22, 0
    s_cbranch_scc1 wd_28
wt_27:
    global_load_dword v5, v4, s[2:3] sc1
    s_add_u32 s25, s25, 1
    s_cmp_gt_u32 s25, 300000
    s_cbranch_scc1 W_ABORT
    s_waitcnt vmcnt(0)
    v_readfirstlane_b32 s51, v5
    s_nop 1
    s_cmp_ge_u32 s51, s49
    s_cbranch_scc1 wd_28
    s_sleep 4
    s_branch wt_27
wd_28:
    s_barrier
    s_mul_i32 s51, s27, 147456
    s_mul_i32 s52, s22, 36864
    s_add_u32 s51, s51, s52
    s_add_u32 s51, s51, 61935616
    s_add_u32 s28, s16, s51
    s_addc_u32 s29, s17, 0
    v_mov_b32 v16, s44
    v_mov_b32 v18, 162816
    global_load_dword v17, v16, s[2:3] sc1
    s_mov_b64 s[30:31], s[28:29]
    s_mov_b32 s25, 0
    s_mov_b64 s[32:33], 0
    v_add_u32 v24, 0, v0
    v_add_u32 v25, 8192, v0
    v_add_u32 v26, 16384, v0
    v_add_u32 v27, 24576, v0
    v_add_u32 v28, 32768, v0
    v_mov_b32 v8, 0
    v_mov_b32 v9, 0
    v_mov_b32 v10, 0
    v_mov_b32 v11, 0
    v_mov_b32 v12, 0
    v_mov_b32 v13, 0
    v_mov_b32 v14, 0
    v_mov_b32 v15, 0
    global_load_dwordx4 v[32:35], v0, s[28:29] offset:-4096 sc1
    global_load_dwordx4 v[36:39], v0, s[28:29] offset:-3072 sc1
    global_load_dwordx4 v[40:43], v0, s[28:29] offset:-2048 sc1
    global_load_dwordx4 v[44:47], v0, s[28:29] offset:-1024 sc1
    global_load_dwordx4 v[48:51], v0, s[28:29] offset:0 sc1
    global_load_dwordx4 v[52:55], v0, s[28:29] offset:1024 sc1
    global_load_dwordx4 v[56:59], v0, s[28:29] offset:2048 sc1
    global_load_dwordx4 v[60:63], v0, s[28:29] offset:3072 sc1
    s_add_u32 s28, s28, 8192
    s_addc_u32 s29, s29, 0
    global_load_dwordx4 v[64:67], v0, s[28:29] offset:-4096 sc1
    global_load_dwordx4 v[68:71], v0, s[28:29] offset:-3072 sc1
    global_load_dwordx4 v[72:75], v0, s[28:29] offset:-2048 sc1
    global_load_dwordx4 v[76:79], v0, s[28:29] offset:-1024 sc1
    global_load_dwordx4 v[80:83], v0, s[28:29] offset:0 sc1
    global_load_dwordx4 v[84:87], v0, s[28:29] offset:1024 sc1
    global_load_dwordx4 v[88:91], v0, s[28:29] offset:2048 sc1
    global_load_dwordx4 v[92:95], v0, s[28:29] offset:3072 sc1
    s_add_u32 s28, s28, 8192
    s_addc_u32 s29, s29, 0
    global_load_dwordx4 v[96:99], v0, s[28:29] offset:-4096 sc1
    global_load_dwordx4 v[100:103], v0, s[28:29] offset:-3072 sc1
    global_load_dwordx4 v[104:107], v0, s[28:29] offset:-2048 sc1
    global_load_dwordx4 v[108:111], v0, s[28:29] offset:-1024 sc1
    global_load_dwordx4 v[112:115], v0, s[28:29] offset:0 sc1
    global_load_dwordx4 v[116:119], v0, s[28:29] offset:1024 sc1
    global_load_dwordx4 v[120:123], v0, s[28:29] offset:2048 sc1
    global_load_dwordx4 v[124:127], v0, s[28:29] offset:3072 sc1
    s_add_u32 s28, s28, 8192
    s_addc_u32 s29, s29, 0
    global_load_dwordx4 v[128:131], v0, s[28:29] offset:-4096 sc1
    global_load_dwordx4 v[132:135], v0, s[28:29] offset:-3072 sc1
    global_load_dwordx4 v[136:139], v0, s[28:29] offset:-2048 sc1
    global_load_dwordx4 v[140:143], v0, s[28:29] offset:-1024 sc1
    global_load_dwordx4 v[144:147], v0, s[28:29] offset:0 sc1
    global_load_dwordx4 v[148:151], v0, s[28:29] offset:1024 sc1
    global_load_dwordx4 v[152:155], v0, s[28:29] offset:2048 sc1
    global_load_dwordx4 v[156:159], v0, s[28:29] offset:3072 sc1
    s_add_u32 s28, s28, 8192
    s_addc_u32 s29, s29, 0
    global_load_dwordx4 v[160:163], v0, s[28:29] offset:-4096 sc1
    global_load_dwordx4 v[164:167], v0, s[28:29] offset:-3072 sc1
    global_load_dwordx4 v[168:171], v0, s[28:29] offset:-2048 sc1
    global_load_dwordx4 v[172:175], v0, s[28:29] offset:-1024 sc1
    s_lshl_b32 s51, s27, 14
    s_add_u32 s28, s82, s51
    s_addc_u32 s29, s83, 0
    s_waitcnt vmcnt(35)
    v_cmp_eq_u32 vcc, -1, v35
    s_cbranch_vccnz W4S_r0
    v_mfma_f32_16x16x32_bf16 v[8:11], a[0:3], v[32:35], v[8:11]
    v_mfma_f32_16x16x32_bf16 v[12:15], a[4:7], v[32:35], v[12:15]
W4S_n0:
    s_waitcnt vmcnt(34)
    v_cmp_eq_u32 vcc, -1, v39
    s_cbranch_vccnz W4S_r1
    v_mfma_f32_16x16x32_bf16 v[8:11], a[8:11], v[36:39], v[8:11]
    v_mfma_f32_16x16x32_bf16 v[12:15], a[12:15], v[36:39], v[12:15]
W4S_n1:
    s_waitcnt vmcnt(33)
    v_cmp_eq_u32 vcc, -1, v43
    s_cbranch_vccnz W4S_r2
    v_mfma_f32_16x16x32_bf16 v[8:11], a[16:19], v[40:43], v[8:11]
    v_mfma_f32_16x16x32_bf16 v[12:15], a[20:23], v[40:43], v[12:15]
W4S_n2:
    s_waitcnt vmcnt(32)
    v_cmp_eq_u32 vcc, -1, v47
    s_cbranch_vccnz W4S_r3
    v_mfma_f32_16x16x32_bf16 v[8:11], a[24:27], v[44:47], v[8:11]
    v_mfma_f32_16x16x32_bf16 v[12:15], a[28:31], v[44:47], v[12:15]
W4S_n3:
    s_waitcnt vmcnt(31)
    v_cmp_eq_u32 vcc, -1, v51
    s_cbranch_vccnz W4S_r4
    v_mfma_f32_16x16x32_bf16 v[8:11], a[32:35], v[48:51], v[8:11]
    v_mfma_f32_16x16x32_bf16 v[12:15], a[36:39], v[48:51], v[12:15]
W4S_n4:
    s_waitcnt vmcnt(30)
    v_cmp_eq_u32 vcc, -1, v55
    s_cbranch_vccnz W4S_r5
    v_mfma_f32_16x16x32_bf16 v[8:11], a[40:43], v[52:55], v[8:11]
    v_mfma_f32_16x16x32_bf16 v[12:15], a[44:47], v[52:55], v[12:15]
W4S_n5:
    s_waitcnt vmcnt(29)
    v_cmp_eq_u32 vcc, -1, v59
    s_cbranch_vccnz W4S_r6
    v_mfma_f32_16x16x32_bf16 v[8:11], a[48:51], v[56:59], v[8:11]
    v_mfma_f32_16x16x32_bf16 v[12:15], a[52:55], v[56:59], v[12:15]
W4S_n6:
    s_waitcnt vmcnt(28)
    v_cmp_eq_u32 vcc, -1, v63
    s_cbranch_vccnz W4S_r7
    v_mfma_f32_16x16x32_bf16 v[8:11], a[56:59], v[60:63], v[8:11]
    v_mfma_f32_16x16x32_bf16 v[12:15], a[60:63], v[60:63], v[12:15]
W4S_n7:
    s_waitcnt vmcnt(27)
    v_cmp_eq_u32 vcc, -1, v67
    s_cbranch_vccnz W4S_r8
    v_mfma_f32_16x16x32_bf16 v[8:11], a[64:67], v[64:67], v[8:11]
    v_mfma_f32_16x16x32_bf16 v[12:15], a[68:71], v[64:67], v[12:15]
W4S_n8:
    s_waitcnt vmcnt(26)
    v_cmp_eq_u32 vcc, -1, v71
    s_cbranch_vccnz W4S_r9
    v_mfma_f32_16x16x32_bf16 v[8:11], a[72:75], v[68:71], v[8:11]
    v_mfma_f32_16x16x32_bf16 v[12:15], a[76:79], v[68:71], v[12:15]
W4S_n9:
    s_waitcnt vmcnt(25)
    v_cmp_eq_u32 vcc, -1, v75
    s_cbranch_vccnz W4S_r10
    v_mfma_f32_16x16x32_bf16 v[8:11], a[80:83], v[72:75], v[8:11]
    v_mfma_f32_16x16x32_bf16 v[12:15], a[84:87], v[72:75], v[12:15]
W4S_n10:
    s_waitcnt vmcnt(24)
    v_cmp_eq_u32 vcc, -1, v79
    s_cbranch_vccnz W4S_r11
    v_mfma_f32_16x16x32_bf16 v[8:11], a[88:91], v[76:79], v[8:11]
    v_mfma_f32_16x16x32_bf16 v[12:15], a[92:95], v[76:79], v[12:15]
W4S_n11:
    s_waitcnt vmcnt(23)
    v_cmp_eq_u32 vcc, -1, v83
    s_cbranch_vccnz W4S_r12
    v_mfma_f32_16x16x32_bf16 v[8:11], a[96:99], v[80:83], v[8:11]
    v_mfma_f32_16x16x32_bf16 v[12:15], a[100:103], v[80:83], v[12:15]
W4S_n12:
    s_waitcnt vmcnt(22)
    v_cmp_eq_u32 vcc, -1, v87
    s_cbranch_vccnz W4S_r13
    v_mfma_f32_16x16x32_bf16 v[8:11], a[104:107], v[84:87], v[8:11]
    v_mfma_f32_16x16x32_bf16 v[12:15], a[108:111], v[84:87], v[12:15]
W4S_n13:
    s_waitcnt vmcnt(21)
    v_cmp_eq_u32 vcc, -1, v91
    s_cbranch_vccnz W4S_r14
    v_mfma_f32_16x16x32_bf16 v[8:11], a[112:115], v[88:91], v[8:11]
    v_mfma_f32_16x16x32_bf16 v[12:15], a[116:119], v[88:91], v[12:15]
W4S_n14:
    s_waitcnt vmcnt(20)
    v_cmp_eq_u32 vcc, -1, v95
    s_cbranch_vccnz W4S_r15
    v_mfma_f32_16x16x32_bf16 v[8:11], a[120:123], v[92:95], v[8:11]
    v_mfma_f32_16x16x32_bf16 v[12:15], a[124:127], v[92:95], v[12:15]
W4S_n15:
    s_waitcnt vmcnt(19)
    v_cmp_eq_u32 vcc, -1, v99
    s_cbranch_vccnz W4S_r16
    v_mfma_f32_16x16x32_bf16 v[8:11], a[128:131], v[96:99], v[8:11]
    v_mfma_f32_16x16x32_bf16 v[12:15], a[132:135], v[96:99], v[12:15]
W4S_n16:
    s_waitcnt vmcnt(18)
    v_cmp_eq_u32 vcc, -1, v103
    s_cbranch_vccnz W4S_r17
    v_mfma_f32_16x16x32_bf16 v[8:11], a[136:139], v[100:103], v[8:11]
    v_mfma_f32_16x16x32_bf16 v[12:15], a[140:143], v[100:103], v[12:15]
W4S_n17:
    s_waitcnt vmcnt(17)
    v_cmp_eq_u32 vcc, -1, v107
    s_cbranch_vccnz W4S_r18
    v_mfma_f32_16x16x32_bf16 v[8:11], a[144:147], v[104:107], v[8:11]
    v_mfma_f32_16x16x32_bf16 v[12:15], a[148:151], v[104:107], v[12:15]
W4S_n18:
    s_waitcnt vmcnt(16)
    v_cmp_eq_u32 vcc, -1, v111
    s_cbranch_vccnz W4S_r19
    v_mfma_f32_16x16x32_bf16 v[8:11], a[152:155], v[108:111], v[8:11]
    v_mfma_f32_16x16x32_bf16 v[12:15], a[156:159], v[108:111], v[12:15]
W4S_n19:
    s_waitcnt vmcnt(15)
    v_cmp_eq_u32 vcc, -1, v115
    s_cbranch_vccnz W4S_r20
    v_mfma_f32_16x16x32_bf16 v[8:11], a[160:163], v[112:115], v[8:11]
    v_mfma_f32_16x16x32_bf16 v[12:15], a[164:167], v[112:115], v[12:15]
W4S_n20:
    s_waitcnt vmcnt(14)
    v_cmp_eq_u32 vcc, -1, v119
    s_cbranch_vccnz W4S_r21
    v_mfma_f32_16x16x32_bf16 v[8:11], a[168:171], v[116:119], v[8:11]
    v_mfma_f32_16x16x32_bf16 v[12:15], a[172:175], v[116:119], v[12:15]
W4S_n21:
    s_waitcnt vmcnt(13)
    v_cmp_eq_u32 vcc, -1, v123
    s_cbranch_vccnz W4S_r22
    v_mfma_f32_16x16x32_bf16 v[8:11], a[176:179], v[120:123], v[8:11]
    v_mfma_f32_16x16x32_bf16 v[12:15], a[180:183], v[120:123], v[12:15]
W4S_n22:
    s_waitcnt vmcnt(12)
    v_cmp_eq_u32 vcc, -1, v127
    s_cbranch_vccnz W4S_r23
    v_mfma_f32_16x16x32_bf16 v[8:11], a[184:187], v[124:127], v[8:11]
    v_mfma_f32_16x16x32_bf16 v[12:15], a[188:191], v[124:127], v[12:15]
W4S_n23:
    s_waitcnt vmcnt(11)
    v_cmp_eq_u32 vcc, -1, v131
    s_cbranch_vccnz W4S_r24
    v_mfma_f32_16x16x32_bf16 v[8:11], a[192:195], v[128:131], v[8:11]
    v_mfma_f32_16x16x32_bf16 v[12:15], a[196:199], v[128:131], v[12:15]
W4S_n24:
    s_waitcnt vmcnt(10)
    v_cmp_eq_u32 vcc, -1, v135
    s_cbranch_vccnz W4S_r25
    v_mfma_f32_16x16x32_bf16 v[8:11], a[200:203], v[132:135], v[8:11]
    v_mfma_f32_16x16x32_bf16 v[12:15], a[204:207], v[132:135], v[12:15]
W4S_n25:
    s_waitcnt vmcnt(9)
    v_cmp_eq_u32 vcc, -1, v139
    s_cbranch_vccnz W4S_r26
    v_mfma_f32_16x16x32_bf16 v[8:11], a[208:211], v[136:139], v[8:11]
    v_mfma_f32_16x16x32_bf16 v[12:15], a[212:215], v[136:139], v[12:15]
W4S_n26:
    s_waitcnt vmcnt(8)
    v_cmp_eq_u32 vcc, -1, v143
    s_cbranch_vccnz W4S_r27
    v_mfma_f32_16x16x32_bf16 v[8:11], a[216:219], v[140:143], v[8:11]
    v_mfma_f32_16x16x32_bf16 v[12:15], a[220:223], v[140:143], v[12:15]
W4S_n27:
    s_waitcnt vmcnt(7)
    v_cmp_eq_u32 vcc, -1, v147
    s_cbranch_vccnz W4S_r28
    v_mfma_f32_16x16x32_bf16 v[8:11], a[224:227], v[144:147], v[8:11]
    v_mfma_f32_16x16x32_bf16 v[12:15], a[228:231], v[144:147], v[12:15]
W4S_n28:
    s_waitcnt vmcnt(6)
    v_cmp_eq_u32 vcc, -1, v151
    s_cbranch_vccnz W4S_r29
    v_mfma_f32_16x16x32_bf16 v[8:11], a[232:235], v[148:151], v[8:11]
    v_mfma_f32_16x16x32_bf16 v[12:15], a[236:239], v[148:151], v[12:15]
W4S_n29:
    s_waitcnt vmcnt(5)
    v_cmp_eq_u32 vcc, -1, v155
    s_cbranch_vccnz W4S_r30
    v_mfma_f32_16x16x32_bf16 v[8:11], a[240:243], v[152:155], v[8:11]
    v_mfma_f32_16x16x32_bf16 v[12:15], a[244:247], v[152:155], v[12:15]
W4S_n30:
    s_waitcnt vmcnt(4)
    v_cmp_eq_u32 vcc, -1, v159
    s_cbranch_vccnz W4S_r31
    v_mfma_f32_16x16x32_bf16 v[8:11], a[248:251], v[156:159], v[8:11]
    v_mfma_f32_16x16x32_bf16 v[12:15], a[252:255], v[156:159], v[12:15]
W4S_n31:
    s_waitcnt vmcnt(3)
    v_cmp_eq_u32 vcc, -1, v163
    s_cbranch_vccnz W4S_r32
    v_mfma_f32_16x16x32_bf16 v[8:11], v[224:227], v[160:163], v[8:11]
    v_mfma_f32_16x16x32_bf16 v[12:15], v[228:231], v[160:163], v[12:15]
W4S_n32:
    s_waitcnt vmcnt(2)
    v_cmp_eq_u32 vcc, -1, v167
    s_cbranch_vccnz W4S_r33
    v_mfma_f32_16x16x32_bf16 v[8:11], v[232:235], v[164:167], v[8:11]
    v_mfma_f32_16x16x32_bf16 v[12:15], v[236:239], v[164:167], v[12:15]
W4S_n33:
    s_waitcnt vmcnt(1)
    v_cmp_eq_u32 vcc, -1, v171
    s_cbranch_vccnz W4S_r34
    v_mfma_f32_16x16x32_bf16 v[8:11], v[240:243], v[168:171], v[8:11]
    v_mfma_f32_16x16x32_bf16 v[12:15], v[244:247], v[168:171], v[12:15]
W4S_n34:
    s_waitcnt vmcnt(0)
    v_cmp_eq_u32 vcc, -1, v175
    s_cbranch_vccnz W4S_r35
    v_mfma_f32_16x16x32_bf16 v[8:11], v[248:251], v[172:175], v[8:11]
    v_mfma_f32_16x16x32_bf16 v[12:15], v[252:255], v[172:175], v[12:15]
W4S_n35:
    s_cmp_lg_u64 s[32:33], 0
    s_cbranch_scc1 W4S_again
W4S_done:
    s_nop 6
    s_cmp_eq_u32 s22, 0
    s_cselect_b64 exec, 1, 0
    ds_write_b32 v18, v17 offset:8
    s_mov_b64 exec, -1
    ds_write_b128 v1, v[8:11] offset:0
    ds_write_b128 v1, v[12:15] offset:1024
    s_waitcnt lgkmcnt(0)
    s_barrier
    ds_read_b64 v[8:9], v2 offset:0
    ds_read_b64 v[10:11], v2 offset:2048
    ds_read_b64 v[12:13], v2 offset:4096
    ds_read_b64 v[14:15], v2 offset:6144
    s_waitcnt lgkmcnt(0)
    v_add_f32 v8, v8, v10
    v_add_f32 v12, v12, v14
    v_add_f32 v9, v9, v11
    v_add_f32 v13, v13, v15
    v_add_f32 v8, v8, v12
    v_add_f32 v9, v9, v13
    v_cvt_pk_bf16_f32 v8, v8, v9
    global_store_dword v3, v8, s[28:29]
    ds_read_b32 v17, v18 offset:8
    s_waitcnt lgkmcnt(0)
    v_readfirstlane_b32 s45, v17
    s_nop 1
    s_cmp_lt_u32 s45, 128
    s_cbranch_scc1 W4_L
W4_END:
    s_branch CH_EXIT
W4S_r0:
    global_load_dwordx4 v[32:35], v24, s[30:31] offset:-4096 sc1
    s_bitset1_b64 s[32:33], 0
    s_branch W4S_n0
W4S_r1:
    global_load_dwordx4 v[36:39], v24, s[30:31] offset:-3072 sc1
    s_bitset1_b64 s[32:33], 1
    s_branch W4S_n1
W4S_r2:
    global_load_dwordx4 v[40:43], v24, s[30:31] offset:-2048 sc1
    s_bitset1_b64 s[32:33], 2
    s_branch W4S_n2
W4S_r3:
    global_load_dwordx4 v[44:47], v24, s[30:31] offset:-1024 sc1
    s_bitset1_b64 s[32:33], 3
    s_branch W4S_n3
W4S_r4:
    global_load_dwordx4 v[48:51], v24, s[30:31] offset:0 sc1
    s_bitset1_b64 s[32:33], 4
    s_branch W4S_n4
W4S_r5:
    global_load_dwordx4 v[52:55], v24, s[30:31] offset:1024 sc1
    s_bitset1_b64 s[32:33], 5
    s_branch W4S_n5
W4S_r6:
    global_load_dwordx4 v[56:59], v24, s[30:31] offset:2048 sc1
    s_bitset1_b64 s[32:33], 6
    s_branch W4S_n6
W4S_r7:
    global_load_dwordx4 v[60:63], v24, s[30:31] offset:3072 sc1
    s_bitset1_b64 s[32:33], 7
    s_branch W4S_n7
W4S_r8:
    global_load_dwordx4 v[64:67], v25, s[30:31] offset:-4096 sc1
    s_bitset1_b64 s[32:33], 8
    s_branch W4S_n8
W4S_r9:
    global_load_dwordx4 v[68:71], v25, s[30:31] offset:-3072 sc1
    s_bitset1_b64 s[32:33], 9
    s_branch W4S_n9
W4S_r10:
    global_load_dwordx4 v[72:75], v25, s[30:31] offset:-2048 sc1
    s_bitset1_b64 s[32:33], 10
    s_branch W4S_n10
W4S_r11:
    global_load_dwordx4 v[76:79], v25, s[30:31] offset:-1024 sc1
    s_bitset1_b64 s[32:33], 11
    s_branch W4S_n11
W4S_r12:
    global_load_dwordx4 v[80:83], v25, s[30:31] offset:0 sc1
    s_bitset1_b64 s[32:33], 12
    s_branch W4S_n12
W4S_r13:
    global_load_dwordx4 v[84:87], v25, s[30:31] offset:1024 sc1
    s_bitset1_b64 s[32:33], 13
    s_branch W4S_n13
W4S_r14:
    global_load_dwordx4 v[88:91], v25, s[30:31] offset:2048 sc1
    s_bitset1_b64 s[32:33], 14
    s_branch W4S_n14
W4S_r15:
    global_load_dwordx4 v[92:95], v25, s[30:31] offset:3072 sc1
    s_bitset1_b64 s[32:33], 15
    s_branch W4S_n15
W4S_r16:
    global_load_dwordx4 v[96:99], v26, s[30:31] offset:-4096 sc1
    s_bitset1_b64 s[32:33], 16
    s_branch W4S_n16
W4S_r17:
    global_load_dwordx4 v[100:103], v26, s[30:31] offset:-3072 sc1
    s_bitset1_b64 s[32:33], 17
    s_branch W4S_n17
W4S_r18:
    global_load_dwordx4 v[104:107], v26, s[30:31] offset:-2048 sc1
    s_bitset1_b64 s[32:33], 18
    s_branch W4S_n18
W4S_r19:
    global_load_dwordx4 v[108:111], v26, s[30:31] offset:-1024 sc1
    s_bitset1_b64 s[32:33], 19
    s_branch W4S_n19
W4S_r20:
    global_load_dwordx4 v[112:115], v26, s[30:31] offset:0 sc1
    s_bitset1_b64 s[32:33], 20
    s_branch W4S_n20
W4S_r21:
    global_load_dwordx4 v[116:119], v26, s[30:31] offset:1024 sc1
    s_bitset1_b64 s[32:33], 21
    s_branch W4S_n21
W4S_r22:
    global_load_dwordx4 v[120:123], v26, s[30:31] offset:2048 sc1
    s_bitset1_b64 s[32:33], 22
    s_branch W4S_n22
W4S_r23:
    global_load_dwordx4 v[124:127], v26, s[30:31] offset:3072 sc1
    s_bitset1_b64 s[32:33], 23
    s_branch W4S_n23
W4S_r24:
    global_load_dwordx4 v[128:131], v27, s[30:31] offset:-4096 sc1
    s_bitset1_b64 s[32:33], 24
    s_branch W4S_n24
W4S_r25:
    global_load_dwordx4 v[132:135], v27, s[30:31] offset:-3072 sc1
    s_bitset1_b64 s[32:33], 25
    s_branch W4S_n25
W4S_r26:
    global_load_dwordx4 v[136:139], v27, s[30:31] offset:-2048 sc1
    s_bitset1_b64 s[32:33], 26
    s_branch W4S_n26
W4S_r27:
    global_load_dwordx4 v[140:143], v27, s[30:31] offset:-1024 sc1
    s_bitset1_b64 s[32:33], 27
    s_branch W4S_n27
W4S_r28:
    global_load_dwordx4 v[144:147], v27, s[30:31] offset:0 sc1
    s_bitset1_b64 s[32:33], 28
    s_branch W4S_n28
W4S_r29:
    global_load_dwordx4 v[148:151], v27, s[30:31] offset:1024 sc1
    s_bitset1_b64 s[32:33], 29
    s_branch W4S_n29
W4S_r30:
    global_load_dwordx4 v[152:155], v27, s[30:31] offset:2048 sc1
    s_bitset1_b64 s[32:33], 30
    s_branch W4S_n30
W4S_r31:
    global_load_dwordx4 v[156:159], v27, s[30:31] offset:3072 sc1
    s_bitset1_b64 s[32:33], 31
    s_branch W4S_n31
W4S_r32:
    global_load_dwordx4 v[160:163], v28, s[30:31] offset:-4096 sc1
    s_bitset1_b64 s[32:33], 32
    s_branch W4S_n32
W4S_r33:
    global_load_dwordx4 v[164:167], v28, s[30:31] offset:-3072 sc1
    s_bitset1_b64 s[32:33], 33
    s_branch W4S_n33
W4S_r34:
    global_load_dwordx4 v[168:171], v28, s[30:31] offset:-2048 sc1
    s_bitset1_b64 s[32:33], 34
    s_branch W4S_n34
W4S_r35:
    global_load_dwordx4 v[172:175], v28, s[30:31] offset:-1024 sc1
    s_bitset1_b64 s[32:33], 35
    s_branch W4S_n35
W4S_again:
    s_add_u32 s25, s25, 1
    s_cmp_gt_u32 s25, 300000
    s_cbranch_scc1 W_ABORT
    s_waitcnt vmcnt(0)
    s_lshr_b64 s[34:35], s[32:33], 0
    s_and_b32 s34, s34, 15
    s_cbranch_scc0 W4S_g0
    s_bitcmp1_b64 s[32:33], 0
    s_cbranch_scc0 W4S_s0
    v_cmp_eq_u32 vcc, -1, v35
    s_cbranch_vccz W4S_u0
    global_load_dwordx4 v[32:35], v24, s[30:31] offset:-4096 sc1
    s_branch W4S_s0
W4S_u0:
    v_mfma_f32_16x16x32_bf16 v[8:11], a[0:3], v[32:35], v[8:11]
    v_mfma_f32_16x16x32_bf16 v[12:15], a[4:7], v[32:35], v[12:15]
    s_bitset0_b64 s[32:33], 0
W4S_s0:
    s_bitcmp1_b64 s[32:33], 1
    s_cbranch_scc0 W4S_s1
    v_cmp_eq_u32 vcc, -1, v39
    s_cbranch_vccz W4S_u1
    global_load_dwordx4 v[36:39], v24, s[30:31] offset:-3072 sc1
    s_branch W4S_s1
W4S_u1:
    v_mfma_f32_16x16x32_bf16 v[8:11], a[8:11], v[36:39], v[8:11]
    v_mfma_f32_16x16x32_bf16 v[12:15], a[12:15], v[36:39], v[12:15]
    s_bitset0_b64 s[32:33], 1
W4S_s1:
    s_bitcmp1_b64 s[32:33], 2
    s_cbranch_scc0 W4S_s2
    v_cmp_eq_u32 vcc, -1, v43
    s_cbranch_vccz W4S_u2
    global_load_dwordx4 v[40:43], v24, s[30:31] offset:-2048 sc1
    s_branch W4S_s2
W4S_u2:
    v_mfma_f32_16x16x32_bf16 v[8:11], a[16:19], v[40:43], v[8:11]
    v_mfma_f32_16x16x32_bf16 v[12:15], a[20:23], v[40:43], v[12:15]
    s_bitset0_b64 s[32:33], 2
W4S_s2:
    s_bitcmp1_b64 s[32:33], 3
    s_cbranch_scc0 W4S_s3
    v_cmp_eq_u32 vcc, -1, v47
    s_cbranch_vccz W4S_u3
    global_load_dwordx4 v[44:47], v24, s[30:31] offset:-1024 sc1
    s_branch W4S_s3
W4S_u3:
    v_mfma_f32_16x16x32_bf16 v[8:11], a[24:27], v[44:47], v[8:11]
    v_mfma_f32_16x16x32_bf16 v[12:15], a[28:31], v[44:47], v[12:15]
    s_bitset0_b64 s[32:33], 3
W4S_s3:
W4S_g0:
    s_lshr_b64 s[34:35], s[32:33], 4
    s_and_b32 s34, s34, 15
    s_cbranch_scc0 W4S_g4
    s_bitcmp1_b64 s[32:33], 4
    s_cbranch_scc0 W4S_s4
    v_cmp_eq_u32 vcc, -1, v51
    s_cbranch_vccz W4S_u4
    global_load_dwordx4 v[48:51], v24, s[30:31] offset:0 sc1
    s_branch W4S_s4
W4S_u4:
    v_mfma_f32_16x16x32_bf16 v[8:11], a[32:35], v[48:51], v[8:11]
    v_mfma_f32_16x16x32_bf16 v[12:15], a[36:39], v[48:51], v[12:15]
    s_bitset0_b64 s[32:33], 4
W4S_s4:
    s_bitcmp1_b64 s[32:33], 5
    s_cbranch_scc0 W4S_s5
    v_cmp_eq_u32 vcc, -1, v55
    s_cbranch_vccz W4S_u5
    global_load_dwordx4 v[52:55], v24, s[30:31] offset:1024 sc1
    s_branch W4S_s5
W4S_u5:
    v_mfma_f32_16x16x32_bf16 v[8:11], a[40:43], v[52:55], v[8:11]
    v_mfma_f32_16x16x32_bf16 v[12:15], a[44:47], v[52:55], v[12:15]
    s_bitset0_b64 s[32:33], 5
W4S_s5:
    s_bitcmp1_b64 s[32:33], 6
    s_cbranch_scc0 W4S_s6
    v_cmp_eq_u32 vcc, -1, v59
    s_cbranch_vccz W4S_u6
    global_load_dwordx4 v[56:59], v24, s[30:31] offset:2048 sc1
    s_branch W4S_s6
W4S_u6:
    v_mfma_f32_16x16x32_bf16 v[8:11], a[48:51], v[56:59], v[8:11]
    v_mfma_f32_16x16x32_bf16 v[12:15], a[52:55], v[56:59], v[12:15]
    s_bitset0_b64 s[32:33], 6
W4S_s6:
    s_bitcmp1_b64 s[32:33], 7
    s_cbranch_scc0 W4S_s7
    v_cmp_eq_u32 vcc, -1, v63
    s_cbranch_vccz W4S_u7
    global_load_dwordx4 v[60:63], v24, s[30:31] offset:3072 sc1
    s_branch W4S_s7
W4S_u7:
    v_mfma_f32_16x16x32_bf16 v[8:11], a[56:59], v[60:63], v[8:11]
    v_mfma_f32_16x16x32_bf16 v[12:15], a[60:63], v[60:63], v[12:15]
    s_bitset0_b64 s[32:33], 7
W4S_s7:
W4S_g4:
    s_lshr_b64 s[34:35], s[32:33], 8
    s_and_b32 s34, s34, 15
    s_cbranch_scc0 W4S_g8
    s_bitcmp1_b64 s[32:33], 8
    s_cbranch_scc0 W4S_s8
    v_cmp_eq_u32 vcc, -1, v67
    s_cbranch_vccz W4S_u8
    global_load_dwordx4 v[64:67], v25, s[30:31] offset:-4096 sc1
    s_branch W4S_s8
W4S_u8:
    v_mfma_f32_16x16x32_bf16 v[8:11], a[64:67], v[64:67], v[8:11]
    v_mfma_f32_16x16x32_bf16 v[12:15], a[68:71], v[64:67], v[12:15]
    s_bitset0_b64 s[32:33], 8
W4S_s8:
    s_bitcmp1_b64 s[32:33], 9
    s_cbranch_scc0 W4S_s9
    v_cmp_eq_u32 vcc, -1, v71
    s_cbranch_vccz W4S_u9
    global_load_dwordx4 v[68:71], v25, s[30:31] offset:-3072 sc1
    s_branch W4S_s9
W4S_u9:
    v_mfma_f32_16x16x32_bf16 v[8:11], a[72:75], v[68:71], v[8:11]
    v_mfma_f32_16x16x32_bf16 v[12:15], a[76:79], v[68:71], v[12:15]
    s_bitset0_b64 s[32:33], 9
W4S_s9:
    s_bitcmp1_b64 s[32:33], 10
    s_cbranch_scc0 W4S_s10
    v_cmp_eq_u32 vcc, -1, v75
    s_cbranch_vccz W4S_u10
    global_load_dwordx4 v[72:75], v25, s[30:31] offset:-2048 sc1
    s_branch W4S_s10
W4S_u10:
    v_mfma_f32_16x16x32_bf16 v[8:11], a[80:83], v[72:75], v[8:11]
    v_mfma_f32_16x16x32_bf16 v[12:15], a[84:87], v[72:75], v[12:15]
    s_bitset0_b64 s[32:33], 10
W4S_s10:
    s_bitcmp1_b64 s[32:33], 11
    s_cbranch_scc0 W4S_s11
    v_cmp_eq_u32 vcc, -1, v79
    s_cbranch_vccz W4S_u11
    global_load_dwordx4 v[76:79], v25, s[30:31] offset:-1024 sc1
    s_branch W4S_s11
W4S_u11:
    v_mfma_f32_16x16x32_bf16 v[8:11], a[88:91], v[76:79], v[8:11]
    v_mfma_f32_16x16x32_bf16 v[12:15], a[92:95], v[76:79], v[12:15]
    s_bitset0_b64 s[32:33], 11
W4S_s11:
W4S_g8:
    s_lshr_b64 s[34:35], s[32:33], 12
    s_and_b32 s34, s34, 15
    s_cbranch_scc0 W4S_g12
    s_bitcmp1_b64 s[32:33], 12
    s_cbranch_scc0 W4S_s12
    v_cmp_eq_u32 vcc, -1, v83
    s_cbranch_vccz W4S_u12
    global_load_dwordx4 v[80:83], v25, s[30:31] offset:0 sc1
    s_branch W4S_s12
W4S_u12:
    v_mfma_f32_16x16x32_bf16 v[8:11], a[96:99], v[80:83], v[8:11]
    v_mfma_f32_16x16x32_bf16 v[12:15], a[100:103], v[80:83], v[12:15]
    s_bitset0_b64 s[32:33], 12
W4S_s12:
    s_bitcmp1_b64 s[32:33], 13
    s_cbranch_scc0 W4S_s13
    v_cmp_eq_u32 vcc, -1, v87
    s_cbranch_vccz W4S_u13
    global_load_dwordx4 v[84:87], v25, s[30:31] offset:1024 sc1
    s_branch W4S_s13
W4S_u13:
    v_mfma_f32_16x16x32_bf16 v[8:11], a[104:107], v[84:87], v[8:11]
    v_mfma_f32_16x16x32_bf16 v[12:15], a[108:111], v[84:87], v[12:15]
    s_bitset0_b64 s[32:33], 13
W4S_s13:
    s_bitcmp1_b64 s[32:33], 14
    s_cbranch_scc0 W4S_s14
    v_cmp_eq_u32 vcc, -1, v91
    s_cbranch_vccz W4S_u14
    global_load_dwordx4 v[88:91], v25, s[30:31] offset:2048 sc1
    s_branch W4S_s14
W4S_u14:
    v_mfma_f32_16x16x32_bf16 v[8:11], a[112:115], v[88:91], v[8:11]
    v_mfma_f32_16x16x32_bf16 v[12:15], a[116:119], v[88:91], v[12:15]
    s_bitset0_b64 s[32:33], 14
W4S_s14:
    s_bitcmp1_b64 s[32:33], 15
    s_cbranch_scc0 W4S_s15
    v_cmp_eq_u32 vcc, -1, v95
    s_cbranch_vccz W4S_u15
    global_load_dwordx4 v[92:95], v25, s[30:31] offset:3072 sc1
    s_branch W4S_s15
W4S_u15:
    v_mfma_f32_16x16x32_bf16 v[8:11], a[120:123], v[92:95], v[8:11]
    v_mfma_f32_16x16x32_bf16 v[12:15], a[124:127], v[92:95], v[12:15]
    s_bitset0_b64 s[32:33], 15
W4S_s15:
W4S_g12:
    s_lshr_b64 s[34:35], s[32:33], 16
    s_and_b32 s34, s34, 15
    s_cbranch_scc0 W4S_g16
    s_bitcmp1_b64 s[32:33], 16
    s_cbranch_scc0 W4S_s16
    v_cmp_eq_u32 vcc, -1, v99
    s_cbranch_vccz W4S_u16
    global_load_dwordx4 v[96:99], v26, s[30:31] offset:-4096 sc1
    s_branch W4S_s16
W4S_u16:
    v_mfma_f32_16x16x32_bf16 v[8:11], a[128:131], v[96:99], v[8:11]
    v_mfma_f32_16x16x32_bf16 v[12:15], a[132:135], v[96:99], v[12:15]
    s_bitset0_b64 s[32:33], 16
W4S_s16:
    s_bitcmp1_b64 s[32:33], 17
    s_cbranch_scc0 W4S_s17
    v_cmp_eq_u32 vcc, -1, v103
    s_cbranch_vccz W4S_u17
    global_load_dwordx4 v[100:103], v26, s[30:31] offset:-3072 sc1
    s_branch W4S_s17
W4S_u17:
    v_mfma_f32_16x16x32_bf16 v[8:11], a[136:139], v[100:103], v[8:11]
    v_mfma_f32_16x16x32_bf16 v[12:15], a[140:143], v[100:103], v[12:15]
    s_bitset0_b64 s[32:33], 17
W4S_s17:
    s_bitcmp1_b64 s[32:33], 18
    s_cbranch_scc0 W4S_s18
    v_cmp_eq_u32 vcc, -1, v107
    s_cbranch_vccz W4S_u18
    global_load_dwordx4 v[104:107], v26, s[30:31] offset:-2048 sc1
    s_branch W4S_s18
W4S_u18:
    v_mfma_f32_16x16x32_bf16 v[8:11], a[144:147], v[104:107], v[8:11]
    v_mfma_f32_16x16x32_bf16 v[12:15], a[148:151], v[104:107], v[12:15]
    s_bitset0_b64 s[32:33], 18
W4S_s18:
    s_bitcmp1_b64 s[32:33], 19
    s_cbranch_scc0 W4S_s19
    v_cmp_eq_u32 vcc, -1, v111
    s_cbranch_vccz W4S_u19
    global_load_dwordx4 v[108:111], v26, s[30:31] offset:-1024 sc1
    s_branch W4S_s19
W4S_u19:
    v_mfma_f32_16x16x32_bf16 v[8:11], a[152:155], v[108:111], v[8:11]
    v_mfma_f32_16x16x32_bf16 v[12:15], a[156:159], v[108:111], v[12:15]
    s_bitset0_b64 s[32:33], 19
W4S_s19:
W4S_g16:
    s_lshr_b64 s[34:35], s[32:33], 20
    s_and_b32 s34, s34, 15
    s_cbranch_scc0 W4S_g20
    s_bitcmp1_b64 s[32:33], 20
    s_cbranch_scc0 W4S_s20
    v_cmp_eq_u32 vcc, -1, v115
    s_cbranch_vccz W4S_u20
    global_load_dwordx4 v[112:115], v26, s[30:31] offset:0 sc1
    s_branch W4S_s20
W4S_u20:
    v_mfma_f32_16x16x32_bf16 v[8:11], a[160:163], v[112:115], v[8:11]
    v_mfma_f32_16x16x32_bf16 v[12:15], a[164:167], v[112:115], v[12:15]
    s_bitset0_b64 s[32:33], 20
W4S_s20:
    s_bitcmp1_b64 s[32:33], 21
    s_cbranch_scc0 W4S_s21
    v_cmp_eq_u32 vcc, -1, v119
    s_cbranch_vccz W4S_u21
    global_load_dwordx4 v[116:119], v26, s[30:31] offset:1024 sc1
    s_branch W4S_s21
W4S_u21:
    v_mfma_f32_16x16x32_bf16 v[8:11], a[168:171], v[116:119], v[8:11]
    v_mfma_f32_16x16x32_bf16 v[12:15], a[172:175], v[116:119], v[12:15]
    s_bitset0_b64 s[32:33], 21
W4S_s21:
    s_bitcmp1_b64 s[32:33], 22
    s_cbranch_scc0 W4S_s22
    v_cmp_eq_u32 vcc, -1, v123
    s_cbranch_vccz W4S_u22
    global_load_dwordx4 v[120:123], v26, s[30:31] offset:2048 sc1
    s_branch W4S_s22
W4S_u22:
    v_mfma_f32_16x16x32_bf16 v[8:11], a[176:179], v[120:123], v[8:11]
    v_mfma_f32_16x16x32_bf16 v[12:15], a[180:183], v[120:123], v[12:15]
    s_bitset0_b64 s[32:33], 22
W4S_s22:
    s_bitcmp1_b64 s[32:33], 23
    s_cbranch_scc0 W4S_s23
    v_cmp_eq_u32 vcc, -1, v127
    s_cbranch_vccz W4S_u23
    global_load_dwordx4 v[124:127], v26, s[30:31] offset:3072 sc1
    s_branch W4S_s23
W4S_u23:
    v_mfma_f32_16x16x32_bf16 v[8:11], a[184:187], v[124:127], v[8:11]
    v_mfma_f32_16x16x32_bf16 v[12:15], a[188:191], v[124:127], v[12:15]
    s_bitset0_b64 s[32:33], 23
W4S_s23:
W4S_g20:
    s_lshr_b64 s[34:35], s[32:33], 24
    s_and_b32 s34, s34, 15
    s_cbranch_scc0 W4S_g24
    s_bitcmp1_b64 s[32:33], 24
    s_cbranch_scc0 W4S_s24
    v_cmp_eq_u32 vcc, -1, v131
    s_cbranch_vccz W4S_u24
    global_load_dwordx4 v[128:131], v27, s[30:31] offset:-4096 sc1
    s_branch W4S_s24
W4S_u24:
    v_mfma_f32_16x16x32_bf16 v[8:11], a[192:195], v[128:131], v[8:11]
    v_mfma_f32_16x16x32_bf16 v[12:15], a[196:199], v[128:131], v[12:15]
    s_bitset0_b64 s[32:33], 24
W4S_s24:
    s_bitcmp1_b64 s[32:33], 25
    s_cbranch_scc0 W4S_s25
    v_cmp_eq_u32 vcc, -1, v135
    s_cbranch_vccz W4S_u25
    global_load_dwordx4 v[132:135], v27, s[30:31] offset:-3072 sc1
    s_branch W4S_s25
W4S_u25:
    v_mfma_f32_16x16x32_bf16 v[8:11], a[200:203], v[132:135], v[8:11]
    v_mfma_f32_16x16x32_bf16 v[12:15], a[204:207], v[132:135], v[12:15]
    s_bitset0_b64 s[32:33], 25
W4S_s25:
    s_bitcmp1_b64 s[32:33], 26
    s_cbranch_scc0 W4S_s26
    v_cmp_eq_u32 vcc, -1, v139
    s_cbranch_vccz W4S_u26
    global_load_dwordx4 v[136:139], v27, s[30:31] offset:-2048 sc1
    s_branch W4S_s26
W4S_u26:
    v_mfma_f32_16x16x32_bf16 v[8:11], a[208:211], v[136:139], v[8:11]
    v_mfma_f32_16x16x32_bf16 v[12:15], a[212:215], v[136:139], v[12:15]
    s_bitset0_b64 s[32:33], 26
W4S_s26:
    s_bitcmp1_b64 s[32:33], 27
    s_cbranch_scc0 W4S_s27
    v_cmp_eq_u32 vcc, -1, v143
    s_cbranch_vccz W4S_u27
    global_load_dwordx4 v[140:143], v27, s[30:31] offset:-1024 sc1
    s_branch W4S_s27
W4S_u27:
    v_mfma_f32_16x16x32_bf16 v[8:11], a[216:219], v[140:143], v[8:11]
    v_mfma_f32_16x16x32_bf16 v[12:15], a[220:223], v[140:143], v[12:15]
    s_bitset0_b64 s[32:33], 27
W4S_s27:
W4S_g24:
    s_lshr_b64 s[34:35], s[32:33], 28
    s_and_b32 s34, s34, 15
    s_cbranch_scc0 W4S_g28
    s_bitcmp1_b64 s[32:33], 28
    s_cbranch_scc0 W4S_s28
    v_cmp_eq_u32 vcc, -1, v147
    s_cbranch_vccz W4S_u28
    global_load_dwordx4 v[144:147], v27, s[30:31] offset:0 sc1
    s_branch W4S_s28
W4S_u28:
    v_mfma_f32_16x16x32_bf16 v[8:11], a[224:227], v[144:147], v[8:11]
    v_mfma_f32_16x16x32_bf16 v[12:15], a[228:231], v[144:147], v[12:15]
    s_bitset0_b64 s[32:33], 28
W4S_s28:
    s_bitcmp1_b64 s[32:33], 29
    s_cbranch_scc0 W4S_s29
    v_cmp_eq_u32 vcc, -1, v151
    s_cbranch_vccz W4S_u29
    global_load_dwordx4 v[148:151], v27, s[30:31] offset:1024 sc1
    s_branch W4S_s29
W4S_u29:
    v_mfma_f32_16x16x32_bf16 v[8:11], a[232:235], v[148:151], v[8:11]
    v_mfma_f32_16x16x32_bf16 v[12:15], a[236:239], v[148:151], v[12:15]
    s_bitset0_b64 s[32:33], 29
W4S_s29:
    s_bitcmp1_b64 s[32:33], 30
    s_cbranch_scc0 W4S_s30
    v_cmp_eq_u32 vcc, -1, v155
    s_cbranch_vccz W4S_u30
    global_load_dwordx4 v[152:155], v27, s[30:31] offset:2048 sc1
    s_branch W4S_s30
W4S_u30:
    v_mfma_f32_16x16x32_bf16 v[8:11], a[240:243], v[152:155], v[8:11]
    v_mfma_f32_16x16x32_bf16 v[12:15], a[244:247], v[152:155], v[12:15]
    s_bitset0_b64 s[32:33], 30
W4S_s30:
    s_bitcmp1_b64 s[32:33], 31
    s_cbranch_scc0 W4S_s31
    v_cmp_eq_u32 vcc, -1, v159
    s_cbranch_vccz W4S_u31
    global_load_dwordx4 v[156:159], v27, s[30:31] offset:3072 sc1
    s_branch W4S_s31
W4S_u31:
    v_mfma_f32_16x16x32_bf16 v[8:11], a[248:251], v[156:159], v[8:11]
    v_mfma_f32_16x16x32_bf16 v[12:15], a[252:255], v[156:159], v[12:15]
    s_bitset0_b64 s[32:33], 31
W4S_s31:
W4S_g28:
    s_lshr_b64 s[34:35], s[32:33], 32
    s_and_b32 s34, s34, 15
    s_cbranch_scc0 W4S_g32
    s_bitcmp1_b64 s[32:33], 32
    s_cbranch_scc0 W4S_s32
    v_cmp_eq_u32 vcc, -1, v163
    s_cbranch_vccz W4S_u32
    global_load_dwordx4 v[160:163], v28, s[30:31] offset:-4096 sc1
    s_branch W4S_s32
W4S_u32:
    v_mfma_f32_16x16x32_bf16 v[8:11], v[224:227], v[160:163], v[8:11]
    v_mfma_f32_16x16x32_bf16 v[12:15], v[228:231], v[160:163], v[12:15]
    s_bitset0_b64 s[32:33], 32
W4S_s32:
    s_bitcmp1_b64 s[32:33], 33
    s_cbranch_scc0 W4S_s33
    v_cmp_eq_u32 vcc, -1, v167
    s_cbranch_vccz W4S_u33
    global_load_dwordx4 v[164:167], v28, s[30:31] offset:-3072 sc1
    s_branch W4S_s33
W4S_u33:
    v_mfma_f32_16x16x32_bf16 v[8:11], v[232:235], v[164:167], v[8:11]
    v_mfma_f32_16x16x32_bf16 v[12:15], v[236:239], v[164:167], v[12:15]
    s_bitset0_b64 s[32:33], 33
W4S_s33:
    s_bitcmp1_b64 s[32:33], 34
    s_cbranch_scc0 W4S_s34
    v_cmp_eq_u32 vcc, -1, v171
    s_cbranch_vccz W4S_u34
    global_load_dwordx4 v[168:171], v28, s[30:31] offset:-2048 sc1
    s_branch W4S_s34
W4S_u34:
    v_mfma_f32_16x16x32_bf16 v[8:11], v[240:243], v[168:171], v[8:11]
    v_mfma_f32_16x16x32_bf16 v[12:15], v[244:247], v[168:171], v[12:15]
    s_bitset0_b64 s[32:33], 34
W4S_s34:
    s_bitcmp1_b64 s[32:33], 35
    s_cbranch_scc0 W4S_s35
    v_cmp_eq_u32 vcc, -1, v175
    s_cbranch_vccz W4S_u35
    global_load_dwordx4 v[172:175], v28, s[30:31] offset:-1024 sc1
    s_branch W4S_s35
W4S_u35:
    v_mfma_f32_16x16x32_bf16 v[8:11], v[248:251], v[172:175], v[8:11]
    v_mfma_f32_16x16x32_bf16 v[12:15], v[252:255], v[172:175], v[12:15]
    s_bitset0_b64 s[32:33], 35
W4S_s35:
W4S_g32:
    s_cmp_lg_u64 s[32:33], 0
    s_cbranch_scc1 W4S_again
    s_branch W4S_done
W_ABORT:
    s_mov_b64 exec, -1
    v_mov_b32 v4, 162816
    v_mov_b32 v5, 0x7fffffff
    ds_write_b32 v4, v5
    s_waitcnt lgkmcnt(0)
    s_branch CH_EXIT
CHAIN:
    s_lshl_b32 s23, s21, 2
    s_add_u32 s23, s23, s22
    s_mov_b32 s48, 0x000f000f
    s_mov_b32 s49, 0x000f000f
    s_mov_b32 s46, 0xff00ff00
    s_mov_b32 s47, 0xff00ff00
    s_mov_b32 s50, 1040356334
    s_mov_b32 s65, 1131102991
    s_xor_b32 s56, s22, 0
    s_lshl_b32 s56, s56, 11
    s_add_u32 s68, s56, 131072
    s_xor_b32 s57, s22, 1
    s_lshl_b32 s57, s57, 11
    s_add_u32 s69, s57, 131072
    s_xor_b32 s58, s22, 2
    s_lshl_b32 s58, s58, 11
    s_add_u32 s70, s58, 131072
    s_xor_b32 s59, s22, 3
    s_lshl_b32 s59, s59, 11
    s_add_u32 s71, s59, 131072
    v_mov_b32 v20, 0
    v_mov_b32 v21, 0
    v_mov_b32 v22, 0
    v_mov_b32 v23, 0
    v_mov_b32 v24, -1
    s_lshl_b32 s51, s21, 13
    s_add_u32 s51, s51, s56
    s_add_u32 s52, s51, 2097152
    s_add_u32 s38, s16, s52
    s_addc_u32 s39, s17, 0
    s_add_u32 s52, s51, 18874368
    s_add_u32 s40, s16, s52
    s_addc_u32 s41, s17, 0
    s_lshl_b32 s51, s21, 11
    s_lshl_b32 s52, s22, 9
    s_add_u32 s51, s51, s52
    s_add_u32 s52, s51, 52428800
    s_add_u32 s42, s16, s52
    s_addc_u32 s43, s17, 0
    s_add_u32 s52, s51, 57671680
    s_add_u32 s44, s16, s52
    s_addc_u32 s45, s17, 0
    s_mul_i32 s98, s22, 544
    s_add_u32 s98, s98, 141440
    s_mul_i32 s51, s23, 2176
    s_add_u32 s30, s16, s51
    s_addc_u32 s31, s17, 0
    s_add_u32 s26, s30, 278528
    s_addc_u32 s27, s31, 0
    s_lshl_b32 s51, s23, 6
    s_add_u32 s51, s51, 1056768
    s_add_u32 s34, s16, s51
    s_addc_u32 s35, s17, 0
    s_and_b32 s51, s23, 7
    s_lshl_b32 s51, s51, 7
    s_add_u32 s32, s12, s51
    s_addc_u32 s33, s13, 0
    s_waitcnt vmcnt(0)
    v_and_b32 v25, 0xf0, v0
    v_lshlrev_b32 v25, 1, v25
    v_add_u32 v25, 143616, v25
    v_lshrrev_b32 v26, 2, v0
    v_add_u32 v26, 143616, v26
    ds_write_b128 v25, v[12:15]
    ds_write_b32 v25, v11 offset:16
    ds_write_b32 v26, v10 offset:512
    s_waitcnt lgkmcnt(0)
    global_load_dword v12, v18, s[32:33] offset:0
    global_load_dword v13, v18, s[32:33] offset:16
    global_load_dword v14, v18, s[32:33] offset:32
    global_load_dword v15, v18, s[32:33] offset:48
    s_lshl_b32 s51, s21, 7
    s_add_u32 s51, s51, 1835008
    s_add_u32 s18, s16, s51
    s_addc_u32 s19, s17, 0
    s_lshl_b32 s51, s22, 2
    s_add_u32 s51, s51, 4096
    s_add_u32 s0, s18, s51
    s_addc_u32 s1, s19, 0
    global_store_dwordx4 v0, v[20:23], s[30:31] sc1
    global_store_dwordx4 v0, v[20:23], s[30:31] offset:1024 sc1
    global_store_dwordx4 v0, v[20:23], s[26:27] sc1
    global_store_dwordx4 v0, v[20:23], s[26:27] offset:1024 sc1
    v_lshrrev_b32 v10, 2, v0
    s_mov_b64 exec, 0xffff
    global_store_dword v10, v24, s[34:35] sc1
    s_add_u32 s34, s34, 8192
    s_addc_u32 s35, s35, 0
    global_store_dword v10, v24, s[34:35] sc1
    s_add_u32 s34, s34, 8192
    s_addc_u32 s35, s35, 0
    global_store_dword v10, v24, s[34:35] sc1
    s_add_u32 s34, s34, 8192
    s_addc_u32 s35, s35, 0
    s_mov_b64 exec, -1
    s_and_b32 s51, s23, 7
    s_lshl_b32 s51, s51, 10
    s_mov_b32 s52, 1572864
    s_cmp_lt_u32 s23, 8
    s_cselect_b32 s52, 1048576, s52
    s_add_u32 s51, s51, s52
    s_add_u32 s32, s16, s51
    s_addc_u32 s33, s17, 0
    v_mov_b32 v18, 0x05040100
    v_mov_b32 v19, 0x07060302
    s_mov_b32 s60, s6
    s_and_b32 s61, s7, 0xffff
    s_mov_b32 s62, 4194304
    s_mov_b32 s63, 0x20000
    s_lshl_b32 s51, s22, 20
    s_lshl_b32 s52, s21, 8
    s_add_u32 s64, s51, s52
    s_add_u32 s52, s64, 0
    buffer_load_dwordx4 v[32:35], v16, s[60:63], s52 offen
    s_add_u32 s52, s64, 8192
    buffer_load_dwordx4 v[36:39], v16, s[60:63], s52 offen
    s_add_u32 s52, s64, 262144
    buffer_load_dwordx4 v[40:43], v16, s[60:63], s52 offen
    s_add_u32 s52, s64, 270336
    buffer_load_dwordx4 v[44:47], v16, s[60:63], s52 offen
    s_add_u32 s52, s64, 65536
    buffer_load_dwordx4 v[48:51], v16, s[60:63], s52 offen
    s_add_u32 s52, s64, 73728
    buffer_load_dwordx4 v[52:55], v16, s[60:63], s52 offen
    s_add_u32 s52, s64, 327680
    buffer_load_dwordx4 v[56:59], v16, s[60:63], s52 offen
    s_add_u32 s52, s64, 335872
    buffer_load_dwordx4 v[60:63], v16, s[60:63], s52 offen
    s_add_u32 s52, s64, 32768
    buffer_load_dwordx4 v[64:67], v16, s[60:63], s52 offen
    s_add_u32 s52, s64, 40960
    buffer_load_dwordx4 v[68:71], v16, s[60:63], s52 offen
    s_add_u32 s52, s64, 294912
    buffer_load_dwordx4 v[72:75], v16, s[60:63], s52 offen
    s_add_u32 s52, s64, 303104
    buffer_load_dwordx4 v[76:79], v16, s[60:63], s52 offen
    s_add_u32 s52, s64, 98304
    buffer_load_dwordx4 v[80:83], v16, s[60:63], s52 offen
    s_add_u32 s52, s64, 106496
    buffer_load_dwordx4 v[84:87], v16, s[60:63], s52 offen
    s_add_u32 s52, s64, 360448
    buffer_load_dwordx4 v[88:91], v16, s[60:63], s52 offen
    s_add_u32 s52, s64, 368640
    buffer_load_dwordx4 v[92:95], v16, s[60:63], s52 offen
    s_add_u32 s52, s64, 524288
    buffer_load_dwordx4 v[96:99], v16, s[60:63], s52 offen
    s_add_u32 s52, s64, 532480
    buffer_load_dwordx4 v[100:103], v16, s[60:63], s52 offen
    s_add_u32 s52, s64, 786432
    buffer_load_dwordx4 v[104:107], v16, s[60:63], s52 offen
    s_add_u32 s52, s64, 794624
    buffer_load_dwordx4 v[108:111], v16, s[60:63], s52 offen
    s_add_u32 s52, s64, 589824
    buffer_load_dwordx4 v[112:115], v16, s[60:63], s52 offen
    s_add_u32 s52, s64, 598016
    buffer_load_dwordx4 v[116:119], v16, s[60:63], s52 offen
    s_add_u32 s52, s64, 851968
    buffer_load_dwordx4 v[120:123], v16, s[60:63], s52 offen
    s_add_u32 s52, s64, 860160
    buffer_load_dwordx4 v[124:127], v16, s[60:63], s52 offen
    s_waitcnt vmcnt(16)
    v_perm_b32 v20, v36, v32, v18
    v_perm_b32 v21, v44, v40, v18
    v_perm_b32 v22, v52, v48, v18
    v_perm_b32 v23, v60, v56, v18
    ds_write_b128 v1, v[20:23] offset:0
    v_perm_b32 v24, v36, v32, v19
    v_perm_b32 v25, v44, v40, v19
    v_perm_b32 v26, v52, v48, v19
    v_perm_b32 v27, v60, v56, v19
    ds_write_b128 v1, v[24:27] offset:16384
    v_perm_b32 v28, v37, v33, v18
    v_perm_b32 v29, v45, v41, v18
    v_perm_b32 v30, v53, v49, v18
    v_perm_b32 v31, v61, v57, v18
    ds_write_b128 v1, v[28:31] offset:32768
    v_perm_b32 v20, v37, v33, v19
    v_perm_b32 v21, v45, v41, v19
    v_perm_b32 v22, v53, v49, v19
    v_perm_b32 v23, v61, v57, v19
    ds_write_b128 v1, v[20:23] offset:49152
    v_perm_b32 v24, v38, v34, v18
    v_perm_b32 v25, v46, v42, v18
    v_perm_b32 v26, v54, v50, v18
    v_perm_b32 v27, v62, v58, v18
    ds_write_b128 v2, v[24:27] offset:0
    v_perm_b32 v28, v38, v34, v19
    v_perm_b32 v29, v46, v42, v19
    v_perm_b32 v30, v54, v50, v19
    v_perm_b32 v31, v62, v58, v19
    ds_write_b128 v2, v[28:31] offset:16384
    v_perm_b32 v20, v39, v35, v18
    v_perm_b32 v21, v47, v43, v18
    v_perm_b32 v22, v55, v51, v18
    v_perm_b32 v23, v63, v59, v18
    ds_write_b128 v2, v[20:23] offset:32768
    v_perm_b32 v24, v39, v35, v19
    v_perm_b32 v25, v47, v43, v19
    v_perm_b32 v26, v55, v51, v19
    v_perm_b32 v27, v63, v59, v19
    ds_write_b128 v2, v[24:27] offset:49152
    v_min_u32 v12, -2, v12
    v_min_u32 v13, -2, v13
    v_min_u32 v14, -2, v14
    v_min_u32 v15, -2, v15
    global_store_dwordx4 v0, v[12:15], s[32:33] sc1
    s_add_u32 s52, s64, 557056
    buffer_load_dwordx4 v[32:35], v16, s[60:63], s52 offen
    s_add_u32 s52, s64, 565248
    buffer_load_dwordx4 v[36:39], v16, s[60:63], s52 offen
    s_add_u32 s52, s64, 819200
    buffer_load_dwordx4 v[40:43], v16, s[60:63], s52 offen
    s_add_u32 s52, s64, 827392
    buffer_load_dwordx4 v[44:47], v16, s[60:63], s52 offen
    s_add_u32 s52, s64, 622592
    buffer_load_dwordx4 v[48:51], v16, s[60:63], s52 offen
    s_add_u32 s52, s64, 630784
    buffer_load_dwordx4 v[52:55], v16, s[60:63], s52 offen
    s_add_u32 s52, s64, 884736
    buffer_load_dwordx4 v[56:59], v16, s[60:63], s52 offen
    s_add_u32 s52, s64, 892928
    buffer_load_dwordx4 v[60:63], v16, s[60:63], s52 offen
    s_waitcnt vmcnt(17)
    v_perm_b32 v28, v68, v64, v18
    v_perm_b32 v29, v76, v72, v18
    v_perm_b32 v30, v84, v80, v18
    v_perm_b32 v31, v92, v88, v18
    ds_write_b128 v1, v[28:31] offset:1024
    v_perm_b32 v20, v68, v64, v19
    v_perm_b32 v21, v76, v72, v19
    v_perm_b32 v22, v84, v80, v19
    v_perm_b32 v23, v92, v88, v19
    ds_write_b128 v1, v[20:23] offset:17408
    v_perm_b32 v24, v69, v65, v18
    v_perm_b32 v25, v77, v73, v18
    v_perm_b32 v26, v85, v81, v18
    v_perm_b32 v27, v93, v89, v18
    ds_write_b128 v1, v[24:27] offset:33792
    v_perm_b32 v28, v69, v65, v19
    v_perm_b32 v29, v77, v73, v19
    v_perm_b32 v30, v85, v81, v19
    v_perm_b32 v31, v93, v89, v19
    ds_write_b128 v1, v[28:31] offset:50176
    v_perm_b32 v20, v70, v66, v18
    v_perm_b32 v21, v78, v74, v18
    v_perm_b32 v22, v86, v82, v18
    v_perm_b32 v23, v94, v90, v18
    ds_write_b128 v2, v[20:23] offset:1024
    v_perm_b32 v24, v70, v66, v19
    v_perm_b32 v25, v78, v74, v19
    v_perm_b32 v26, v86, v82, v19
    v_perm_b32 v27, v94, v90, v19
    ds_write_b128 v2, v[24:27] offset:17408
    v_perm_b32 v28, v71, v67, v18
    v_perm_b32 v29, v79, v75, v18
    v_perm_b32 v30, v87, v83, v18
    v_perm_b32 v31, v95, v91, v18
    ds_write_b128 v2, v[28:31] offset:33792
    v_perm_b32 v20, v71, v67, v19
    v_perm_b32 v21, v79, v75, v19
    v_perm_b32 v22, v87, v83, v19
    v_perm_b32 v23, v95, v91, v19
    ds_write_b128 v2, v[20:23] offset:50176
    s_mov_b32 s60, s8
    s_and_b32 s61, s9, 0xffff
    s_mov_b32 s62, 4194304
    s_mov_b32 s63, 0x20000
    s_lshl_b32 s51, s22, 20
    s_lshl_b32 s52, s21, 8
    s_add_u32 s64, s51, s52
    s_add_u32 s52, s64, 0
    buffer_load_dwordx4 v[64:67], v16, s[60:63], s52 offen
    s_add_u32 s52, s64, 8192
    buffer_load_dwordx4 v[68:71], v16, s[60:63], s52 offen
    s_add_u32 s52, s64, 262144
    buffer_load_dwordx4 v[72:75], v16, s[60:63], s52 offen
    s_add_u32 s52, s64, 270336
    buffer_load_dwordx4 v[76:79], v16, s[60:63], s52 offen
    s_add_u32 s52, s64, 65536
    buffer_load_dwordx4 v[80:83], v16, s[60:63], s52 offen
    s_add_u32 s52, s64, 73728
    buffer_load_dwordx4 v[84:87], v16, s[60:63], s52 offen
    s_add_u32 s52, s64, 327680
    buffer_load_dwordx4 v[88:91], v16, s[60:63], s52 offen
    s_add_u32 s52, s64, 335872
    buffer_load_dwordx4 v[92:95], v16, s[60:63], s52 offen
    s_waitcnt vmcnt(17)
    v_perm_b32 v24, v100, v96, v18
    v_perm_b32 v25, v108, v104, v18
    v_perm_b32 v26, v116, v112, v18
    v_perm_b32 v27, v124, v120, v18
    ds_write_b128 v1, v[24:27] offset:2048
    v_perm_b32 v28, v100, v96, v19
    v_perm_b32 v29, v108, v104, v19
    v_perm_b32 v30, v116, v112, v19
    v_perm_b32 v31, v124, v120, v19
    ds_write_b128 v1, v[28:31] offset:18432
    v_perm_b32 v20, v101, v97, v18
    v_perm_b32 v21, v109, v105, v18
    v_perm_b32 v22, v117, v113, v18
    v_perm_b32 v23, v125, v121, v18
    ds_write_b128 v1, v[20:23] offset:34816
    v_perm_b32 v24, v101, v97, v19
    v_perm_b32 v25, v109, v105, v19
    v_perm_b32 v26, v117, v113, v19
    v_perm_b32 v27, v125, v121, v19
    ds_write_b128 v1, v[24:27] offset:51200
    v_perm_b32 v28, v102, v98, v18
    v_perm_b32 v29, v110, v106, v18
    v_perm_b32 v30, v118, v114, v18
    v_perm_b32 v31, v126, v122, v18
    ds_write_b128 v2, v[28:31] offset:2048
    v_perm_b32 v20, v102, v98, v19
    v_perm_b32 v21, v110, v106, v19
    v_perm_b32 v22, v118, v114, v19
    v_perm_b32 v23, v126, v122, v19
    ds_write_b128 v2, v[20:23] offset:18432
    v_perm_b32 v24, v103, v99, v18
    v_perm_b32 v25, v111, v107, v18
    v_perm_b32 v26, v119, v115, v18
    v_perm_b32 v27, v127, v123, v18
    ds_write_b128 v2, v[24:27] offset:34816
    v_perm_b32 v28, v103, v99, v19
    v_perm_b32 v29, v111, v107, v19
    v_perm_b32 v30, v119, v115, v19
    v_perm_b32 v31, v127, v123, v19
    ds_write_b128 v2, v[28:31] offset:51200
    s_add_u32 s52, s64, 32768
    buffer_load_dwordx4 v[96:99], v16, s[60:63], s52 offen
    s_add_u32 s52, s64, 40960
    buffer_load_dwordx4 v[100:103], v16, s[60:63], s52 offen
    s_add_u32 s52, s64, 294912
    buffer_load_dwordx4 v[104:107], v16, s[60:63], s52 offen
    s_add_u32 s52, s64, 303104
    buffer_load_dwordx4 v[108:111], v16, s[60:63], s52 offen
    s_add_u32 s52, s64, 98304
    buffer_load_dwordx4 v[112:115], v16, s[60:63], s52 offen
    s_add_u32 s52, s64, 106496
    buffer_load_dwordx4 v[116:119], v16, s[60:63], s52 offen
    s_add_u32 s52, s64, 360448
    buffer_load_dwordx4 v[120:123], v16, s[60:63], s52 offen
    s_add_u32 s52, s64, 368640
    buffer_load_dwordx4 v[124:127], v16, s[60:63], s52 offen
    s_waitcnt vmcnt(16)
    v_perm_b32 v20, v36, v32, v18
    v_perm_b32 v21, v44, v40, v18
    v_perm_b32 v22, v52, v48, v18
    v_perm_b32 v23, v60, v56, v18
    ds_write_b128 v1, v[20:23] offset:3072
    v_perm_b32 v24, v36, v32, v19
    v_perm_b32 v25, v44, v40, v19
    v_perm_b32 v26, v52, v48, v19
    v_perm_b32 v27, v60, v56, v19
    ds_write_b128 v1, v[24:27] offset:19456
    v_perm_b32 v28, v37, v33, v18
    v_perm_b32 v29, v45, v41, v18
    v_perm_b32 v30, v53, v49, v18
    v_perm_b32 v31, v61, v57, v18
    ds_write_b128 v1, v[28:31] offset:35840
    v_perm_b32 v20, v37, v33, v19
    v_perm_b32 v21, v45, v41, v19
    v_perm_b32 v22, v53, v49, v19
    v_perm_b32 v23, v61, v57, v19
    ds_write_b128 v1, v[20:23] offset:52224
    v_perm_b32 v24, v38, v34, v18
    v_perm_b32 v25, v46, v42, v18
    v_perm_b32 v26, v54, v50, v18
    v_perm_b32 v27, v62, v58, v18
    ds_write_b128 v2, v[24:27] offset:3072
    v_perm_b32 v28, v38, v34, v19
    v_perm_b32 v29, v46, v42, v19
    v_perm_b32 v30, v54, v50, v19
    v_perm_b32 v31, v62, v58, v19
    ds_write_b128 v2, v[28:31] offset:19456
    v_perm_b32 v20, v39, v35, v18
    v_perm_b32 v21, v47, v43, v18
    v_perm_b32 v22, v55, v51, v18
    v_perm_b32 v23, v63, v59, v18
    ds_write_b128 v2, v[20:23] offset:35840
    v_perm_b32 v24, v39, v35, v19
    v_perm_b32 v25, v47, v43, v19
    v_perm_b32 v26, v55, v51, v19
    v_perm_b32 v27, v63, v59, v19
    ds_write_b128 v2, v[24:27] offset:52224
    s_add_u32 s52, s64, 524288
    buffer_load_dwordx4 v[32:35], v16, s[60:63], s52 offen
    s_add_u32 s52, s64, 532480
    buffer_load_dwordx4 v[36:39], v16, s[60:63], s52 offen
    s_add_u32 s52, s64, 786432
    buffer_load_dwordx4 v[40:43], v16, s[60:63], s52 offen
    s_add_u32 s52, s64, 794624
    buffer_load_dwordx4 v[44:47], v16, s[60:63], s52 offen
    s_add_u32 s52, s64, 589824
    buffer_load_dwordx4 v[48:51], v16, s[60:63], s52 offen
    s_add_u32 s52, s64, 598016
    buffer_load_dwordx4 v[52:55], v16, s[60:63], s52 offen
    s_add_u32 s52, s64, 851968
    buffer_load_dwordx4 v[56:59], v16, s[60:63], s52 offen
    s_add_u32 s52, s64, 860160
    buffer_load_dwordx4 v[60:63], v16, s[60:63], s52 offen
    s_waitcnt lgkmcnt(0)
    s_lshl_b32 s53, s22, 15
    s_lshl_b32 s52, s56, 1
    s_add_u32 s52, s52, s53
    v_add_u32 v20, s52, v0
    s_lshl_b32 s52, s57, 1
    s_add_u32 s52, s52, s53
    v_add_u32 v21, s52, v0
    s_lshl_b32 s52, s58, 1
    s_add_u32 s52, s52, s53
    v_add_u32 v22, s52, v0
    s_lshl_b32 s52, s59, 1
    s_add_u32 s52, s52, s53
    v_add_u32 v23, s52, v0
    s_barrier
    ds_read_b128 a[96:99], v20 offset:0
    ds_read_b128 a[100:103], v20 offset:1024
    ds_read_b128 a[200:203], v20 offset:16384
    ds_read_b128 a[204:207], v20 offset:17408
    s_waitcnt lgkmcnt(4)
    ds_read_b128 a[104:107], v20 offset:2048
    ds_read_b128 a[108:111], v20 offset:3072
    ds_read_b128 a[208:211], v20 offset:18432
    ds_read_b128 a[212:215], v20 offset:19456
    s_waitcnt lgkmcnt(4)
    ds_read_b128 a[112:115], v21 offset:0
    ds_read_b128 a[116:119], v21 offset:1024
    ds_read_b128 a[240:243], v21 offset:16384
    ds_read_b128 a[244:247], v21 offset:17408
    s_waitcnt lgkmcnt(4)
    ds_read_b128 a[120:123], v21 offset:2048
    ds_read_b128 a[124:127], v21 offset:3072
    ds_read_b128 a[248:251], v21 offset:18432
    ds_read_b128 a[252:255], v21 offset:19456
    s_waitcnt lgkmcnt(4)
    ds_read_b128 a[128:131], v22 offset:0
    ds_read_b128 a[132:135], v22 offset:1024
    ds_read_b128 a[136:139], v22 offset:16384
    ds_read_b128 a[140:143], v22 offset:17408
    s_waitcnt lgkmcnt(4)
    ds_read_b128 a[144:147], v22 offset:2048
    ds_read_b128 a[148:151], v22 offset:3072
    ds_read_b128 a[152:155], v22 offset:18432
    ds_read_b128 a[156:159], v22 offset:19456
    s_waitcnt lgkmcnt(4)
    ds_read_b128 a[160:163], v23 offset:0
    ds_read_b128 a[164:167], v23 offset:1024
    ds_read_b128 a[168:171], v23 offset:16384
    ds_read_b128 a[172:175], v23 offset:17408
    s_waitcnt lgkmcnt(4)
    ds_read_b128 a[176:179], v23 offset:2048
    ds_read_b128 a[180:183], v23 offset:3072
    ds_read_b128 a[184:187], v23 offset:18432
    ds_read_b128 a[188:191], v23 offset:19456
    s_waitcnt lgkmcnt(4)
    s_waitcnt lgkmcnt(0)
    s_barrier
    v_mov_b32 v20, 200
    v_mov_b32 v21, 1
    s_cmp_eq_u32 s22, 0
    s_cselect_b64 exec, 1, 0
    global_atomic_add v20, v21, s[14:15]
    s_mov_b64 exec, -1
    s_waitcnt vmcnt(16)
    v_perm_b32 v28, v68, v64, v18
    v_perm_b32 v29, v76, v72, v18
    v_perm_b32 v30, v84, v80, v18
    v_perm_b32 v31, v92, v88, v18
    ds_write_b128 v1, v[28:31] offset:0
    v_perm_b32 v20, v68, v64, v19
    v_perm_b32 v21, v76, v72, v19
    v_perm_b32 v22, v84, v80, v19
    v_perm_b32 v23, v92, v88, v19
    ds_write_b128 v1, v[20:23] offset:16384
    v_perm_b32 v24, v69, v65, v18
    v_perm_b32 v25, v77, v73, v18
    v_perm_b32 v26, v85, v81, v18
    v_perm_b32 v27, v93, v89, v18
    ds_write_b128 v1, v[24:27] offset:32768
    v_perm_b32 v28, v69, v65, v19
    v_perm_b32 v29, v77, v73, v19
    v_perm_b32 v30, v85, v81, v19
    v_perm_b32 v31, v93, v89, v19
    ds_write_b128 v1, v[28:31] offset:49152
    v_perm_b32 v20, v70, v66, v18
    v_perm_b32 v21, v78, v74, v18
    v_perm_b32 v22, v86, v82, v18
    v_perm_b32 v23, v94, v90, v18
    ds_write_b128 v2, v[20:23] offset:0
    v_perm_b32 v24, v70, v66, v19
    v_perm_b32 v25, v78, v74, v19
    v_perm_b32 v26, v86, v82, v19
    v_perm_b32 v27, v94, v90, v19
    ds_write_b128 v2, v[24:27] offset:16384
    v_perm_b32 v28, v71, v67, v18
    v_perm_b32 v29, v79, v75, v18
    v_perm_b32 v30, v87, v83, v18
    v_perm_b32 v31, v95, v91, v18
    ds_write_b128 v2, v[28:31] offset:32768
    v_perm_b32 v20, v71, v67, v19
    v_perm_b32 v21, v79, v75, v19
    v_perm_b32 v22, v87, v83, v19
    v_perm_b32 v23, v95, v91, v19
    ds_write_b128 v2, v[20:23] offset:49152
    s_add_u32 s52, s64, 557056
    buffer_load_dwordx4 v[64:67], v16, s[60:63], s52 offen
    s_add_u32 s52, s64, 565248
    buffer_load_dwordx4 v[68:71], v16, s[60:63], s52 offen
    s_add_u32 s52, s64, 819200
    buffer_load_dwordx4 v[72:75], v16, s[60:63], s52 offen
    s_add_u32 s52, s64, 827392
    buffer_load_dwordx4 v[76:79], v16, s[60:63], s52 offen
    s_add_u32 s52, s64, 622592
    buffer_load_dwordx4 v[80:83], v16, s[60:63], s52 offen
    s_add_u32 s52, s64, 630784
    buffer_load_dwordx4 v[84:87], v16, s[60:63], s52 offen
    s_add_u32 s52, s64, 884736
    buffer_load_dwordx4 v[88:91], v16, s[60:63], s52 offen
    s_add_u32 s52, s64, 892928
    buffer_load_dwordx4 v[92:95], v16, s[60:63], s52 offen
    s_waitcnt vmcnt(16)
    v_perm_b32 v24, v100, v96, v18
    v_perm_b32 v25, v108, v104, v18
    v_perm_b32 v26, v116, v112, v18
    v_perm_b32 v27, v124, v120, v18
    ds_write_b128 v1, v[24:27] offset:1024
    v_perm_b32 v28, v100, v96, v19
    v_perm_b32 v29, v108, v104, v19
    v_perm_b32 v30, v116, v112, v19
    v_perm_b32 v31, v124, v120, v19
    ds_write_b128 v1, v[28:31] offset:17408
    v_perm_b32 v20, v101, v97, v18
    v_perm_b32 v21, v109, v105, v18
    v_perm_b32 v22, v117, v113, v18
    v_perm_b32 v23, v125, v121, v18
    ds_write_b128 v1, v[20:23] offset:33792
    v_perm_b32 v24, v101, v97, v19
    v_perm_b32 v25, v109, v105, v19
    v_perm_b32 v26, v117, v113, v19
    v_perm_b32 v27, v125, v121, v19
    ds_write_b128 v1, v[24:27] offset:50176
    v_perm_b32 v28, v102, v98, v18
    v_perm_b32 v29, v110, v106, v18
    v_perm_b32 v30, v118, v114, v18
    v_perm_b32 v31, v126, v122, v18
    ds_write_b128 v2, v[28:31] offset:1024
    v_perm_b32 v20, v102, v98, v19
    v_perm_b32 v21, v110, v106, v19
    v_perm_b32 v22, v118, v114, v19
    v_perm_b32 v23, v126, v122, v19
    ds_write_b128 v2, v[20:23] offset:17408
    v_perm_b32 v24, v103, v99, v18
    v_perm_b32 v25, v111, v107, v18
    v_perm_b32 v26, v119, v115, v18
    v_perm_b32 v27, v127, v123, v18
    ds_write_b128 v2, v[24:27] offset:33792
    v_perm_b32 v28, v103, v99, v19
    v_perm_b32 v29, v111, v107, v19
    v_perm_b32 v30, v119, v115, v19
    v_perm_b32 v31, v127, v123, v19
    ds_write_b128 v2, v[28:31] offset:50176
    s_mov_b32 s60, s4
    s_and_b32 s61, s5, 0xffff
    s_mov_b32 s62, 4194304
    s_mov_b32 s63, 0x20000
    s_lshl_b32 s51, s22, 20
    s_lshl_b32 s52, s21, 8
    s_add_u32 s64, s51, s52
    s_add_u32 s52, s64, 0
    buffer_load_dwordx4 v[96:99], v16, s[60:63], s52 offen
    s_add_u32 s52, s64, 8192
    buffer_load_dwordx4 v[100:103], v16, s[60:63], s52 offen
    s_add_u32 s52, s64, 262144
    buffer_load_dwordx4 v[104:107], v16, s[60:63], s52 offen
    s_add_u32 s52, s64, 270336
    buffer_load_dwordx4 v[108:111], v16, s[60:63], s52 offen
    s_add_u32 s52, s64, 65536
    buffer_load_dwordx4 v[112:115], v16, s[60:63], s52 offen
    s_add_u32 s52, s64, 73728
    buffer_load_dwordx4 v[116:119], v16, s[60:63], s52 offen
    s_add_u32 s52, s64, 327680
    buffer_load_dwordx4 v[120:123], v16, s[60:63], s52 offen
    s_add_u32 s52, s64, 335872
    buffer_load_dwordx4 v[124:127], v16, s[60:63], s52 offen
    s_waitcnt vmcnt(16)
    v_perm_b32 v20, v36, v32, v18
    v_perm_b32 v21, v44, v40, v18
    v_perm_b32 v22, v52, v48, v18
    v_perm_b32 v23, v60, v56, v18
    ds_write_b128 v1, v[20:23] offset:2048
    v_perm_b32 v24, v36, v32, v19
    v_perm_b32 v25, v44, v40, v19
    v_perm_b32 v26, v52, v48, v19
    v_perm_b32 v27, v60, v56, v19
    ds_write_b128 v1, v[24:27] offset:18432
    v_perm_b32 v28, v37, v33, v18
    v_perm_b32 v29, v45, v41, v18
    v_perm_b32 v30, v53, v49, v18
    v_perm_b32 v31, v61, v57, v18
    ds_write_b128 v1, v[28:31] offset:34816
    v_perm_b32 v20, v37, v33, v19
    v_perm_b32 v21, v45, v41, v19
    v_perm_b32 v22, v53, v49, v19
    v_perm_b32 v23, v61, v57, v19
    ds_write_b128 v1, v[20:23] offset:51200
    v_perm_b32 v24, v38, v34, v18
    v_perm_b32 v25, v46, v42, v18
    v_perm_b32 v26, v54, v50, v18
    v_perm_b32 v27, v62, v58, v18
    ds_write_b128 v2, v[24:27] offset:2048
    v_perm_b32 v28, v38, v34, v19
    v_perm_b32 v29, v46, v42, v19
    v_perm_b32 v30, v54, v50, v19
    v_perm_b32 v31, v62, v58, v19
    ds_write_b128 v2, v[28:31] offset:18432
    v_perm_b32 v20, v39, v35, v18
    v_perm_b32 v21, v47, v43, v18
    v_perm_b32 v22, v55, v51, v18
    v_perm_b32 v23, v63, v59, v18
    ds_write_b128 v2, v[20:23] offset:34816
    v_perm_b32 v24, v39, v35, v19
    v_perm_b32 v25, v47, v43, v19
    v_perm_b32 v26, v55, v51, v19
    v_perm_b32 v27, v63, v59, v19
    ds_write_b128 v2, v[24:27] offset:51200
    s_add_u32 s52, s64, 32768
    buffer_load_dwordx4 v[32:35], v16, s[60:63], s52 offen
    s_add_u32 s52, s64, 40960
    buffer_load_dwordx4 v[36:39], v16, s[60:63], s52 offen
    s_add_u32 s52, s64, 294912
    buffer_load_dwordx4 v[40:43], v16, s[60:63], s52 offen
    s_add_u32 s52, s64, 303104
    buffer_load_dwordx4 v[44:47], v16, s[60:63], s52 offen
    s_add_u32 s52, s64, 98304
    buffer_load_dwordx4 v[48:51], v16, s[60:63], s52 offen
    s_add_u32 s52, s64, 106496
    buffer_load_dwordx4 v[52:55], v16, s[60:63], s52 offen
    s_add_u32 s52, s64, 360448
    buffer_load_dwordx4 v[56:59], v16, s[60:63], s52 offen
    s_add_u32 s52, s64, 368640
    buffer_load_dwordx4 v[60:63], v16, s[60:63], s52 offen
    s_waitcnt vmcnt(16)
    v_perm_b32 v28, v68, v64, v18
    v_perm_b32 v29, v76, v72, v18
    v_perm_b32 v30, v84, v80, v18
    v_perm_b32 v31, v92, v88, v18
    ds_write_b128 v1, v[28:31] offset:3072
    v_perm_b32 v20, v68, v64, v19
    v_perm_b32 v21, v76, v72, v19
    v_perm_b32 v22, v84, v80, v19
    v_perm_b32 v23, v92, v88, v19
    ds_write_b128 v1, v[20:23] offset:19456
    v_perm_b32 v24, v69, v65, v18
    v_perm_b32 v25, v77, v73, v18
    v_perm_b32 v26, v85, v81, v18
    v_perm_b32 v27, v93, v89, v18
    ds_write_b128 v1, v[24:27] offset:35840
    v_perm_b32 v28, v69, v65, v19
    v_perm_b32 v29, v77, v73, v19
    v_perm_b32 v30, v85, v81, v19
    v_perm_b32 v31, v93, v89, v19
    ds_write_b128 v1, v[28:31] offset:52224
    v_perm_b32 v20, v70, v66, v18
    v_perm_b32 v21, v78, v74, v18
    v_perm_b32 v22, v86, v82, v18
    v_perm_b32 v23, v94, v90, v18
    ds_write_b128 v2, v[20:23] offset:3072
    v_perm_b32 v24, v70, v66, v19
    v_perm_b32 v25, v78, v74, v19
    v_perm_b32 v26, v86, v82, v19
    v_perm_b32 v27, v94, v90, v19
    ds_write_b128 v2, v[24:27] offset:19456
    v_perm_b32 v28, v71, v67, v18
    v_perm_b32 v29, v79, v75, v18
    v_perm_b32 v30, v87, v83, v18
    v_perm_b32 v31, v95, v91, v18
    ds_write_b128 v2, v[28:31] offset:35840
    v_perm_b32 v20, v71, v67, v19
    v_perm_b32 v21, v79, v75, v19
    v_perm_b32 v22, v87, v83, v19
    v_perm_b32 v23, v95, v91, v19
    ds_write_b128 v2, v[20:23] offset:52224
    s_add_u32 s52, s64, 524288
    buffer_load_dwordx4 v[64:67], v16, s[60:63], s52 offen
    s_add_u32 s52, s64, 532480
    buffer_load_dwordx4 v[68:71], v16, s[60:63], s52 offen
    s_add_u32 s52, s64, 786432
    buffer_load_dwordx4 v[72:75], v16, s[60:63], s52 offen
    s_add_u32 s52, s64, 794624
    buffer_load_dwordx4 v[76:79], v16, s[60:63], s52 offen
    s_add_u32 s52, s64, 589824
    buffer_load_dwordx4 v[80:83], v16, s[60:63], s52 offen
    s_add_u32 s52, s64, 598016
    buffer_load_dwordx4 v[84:87], v16, s[60:63], s52 offen
    s_add_u32 s52, s64, 851968
    buffer_load_dwordx4 v[88:91], v16, s[60:63], s52 offen
    s_add_u32 s52, s64, 860160
    buffer_load_dwordx4 v[92:95], v16, s[60:63], s52 offen
    s_waitcnt lgkmcnt(0)
    s_lshl_b32 s53, s22, 15
    s_lshl_b32 s52, s56, 1
    s_add_u32 s52, s52, s53
    v_add_u32 v20, s52, v0
    s_lshl_b32 s52, s57, 1
    s_add_u32 s52, s52, s53
    v_add_u32 v21, s52, v0
    s_lshl_b32 s52, s58, 1
    s_add_u32 s52, s52, s53
    v_add_u32 v22, s52, v0
    s_lshl_b32 s52, s59, 1
    s_add_u32 s52, s52, s53
    v_add_u32 v23, s52, v0
    s_barrier
    ds_read_b128 v[128:131], v20 offset:0
    ds_read_b128 v[132:135], v20 offset:1024
    ds_read_b128 v[136:139], v20 offset:16384
    ds_read_b128 v[140:143], v20 offset:17408
    s_waitcnt lgkmcnt(4)
    ds_read_b128 v[144:147], v20 offset:2048
    ds_read_b128 v[148:151], v20 offset:3072
    ds_read_b128 v[152:155], v20 offset:18432
    ds_read_b128 v[156:159], v20 offset:19456
    s_waitcnt lgkmcnt(4)
    ds_read_b128 v[160:163], v21 offset:0
    ds_read_b128 v[164:167], v21 offset:1024
    ds_read_b128 v[168:171], v21 offset:16384
    ds_read_b128 v[172:175], v21 offset:17408
    s_waitcnt lgkmcnt(4)
    ds_read_b128 v[176:179], v21 offset:2048
    ds_read_b128 v[180:183], v21 offset:3072
    ds_read_b128 v[184:187], v21 offset:18432
    ds_read_b128 v[188:191], v21 offset:19456
    s_waitcnt lgkmcnt(4)
    ds_read_b128 v[192:195], v22 offset:0
    ds_read_b128 v[196:199], v22 offset:1024
    ds_read_b128 v[200:203], v22 offset:16384
    ds_read_b128 v[204:207], v22 offset:17408
    s_waitcnt lgkmcnt(4)
    ds_read_b128 v[208:211], v22 offset:2048
    ds_read_b128 v[212:215], v22 offset:3072
    ds_read_b128 v[216:219], v22 offset:18432
    ds_read_b128 v[220:223], v22 offset:19456
    s_waitcnt lgkmcnt(4)
    ds_read_b128 v[224:227], v23 offset:0
    ds_read_b128 v[228:231], v23 offset:1024
    ds_read_b128 v[232:235], v23 offset:16384
    ds_read_b128 v[236:239], v23 offset:17408
    s_waitcnt lgkmcnt(4)
    ds_read_b128 v[240:243], v23 offset:2048
    ds_read_b128 v[244:247], v23 offset:3072
    ds_read_b128 v[248:251], v23 offset:18432
    ds_read_b128 v[252:255], v23 offset:19456
    s_waitcnt lgkmcnt(4)
    s_waitcnt lgkmcnt(0)
    s_barrier
    s_waitcnt vmcnt(16)
    v_perm_b32 v24, v100, v96, v18
    v_perm_b32 v25, v108, v104, v18
    v_perm_b32 v26, v116, v112, v18
    v_perm_b32 v27, v124, v120, v18
    ds_write_b128 v1, v[24:27] offset:0
    v_perm_b32 v28, v100, v96, v19
    v_perm_b32 v29, v108, v104, v19
    v_perm_b32 v30, v116, v112, v19
    v_perm_b32 v31, v124, v120, v19
    ds_write_b128 v1, v[28:31] offset:16384
    v_perm_b32 v20, v101, v97, v18
    v_perm_b32 v21, v109, v105, v18
    v_perm_b32 v22, v117, v113, v18
    v_perm_b32 v23, v125, v121, v18
    ds_write_b128 v1, v[20:23] offset:32768
    v_perm_b32 v24, v101, v97, v19
    v_perm_b32 v25, v109, v105, v19
    v_perm_b32 v26, v117, v113, v19
    v_perm_b32 v27, v125, v121, v19
    ds_write_b128 v1, v[24:27] offset:49152
    v_perm_b32 v28, v102, v98, v18
    v_perm_b32 v29, v110, v106, v18
    v_perm_b32 v30, v118, v114, v18
    v_perm_b32 v31, v126, v122, v18
    ds_write_b128 v2, v[28:31] offset:0
    v_perm_b32 v20, v102, v98, v19
    v_perm_b32 v21, v110, v106, v19
    v_perm_b32 v22, v118, v114, v19
    v_perm_b32 v23, v126, v122, v19
    ds_write_b128 v2, v[20:23] offset:16384
    v_perm_b32 v24, v103, v99, v18
    v_perm_b32 v25, v111, v107, v18
    v_perm_b32 v26, v119, v115, v18
    v_perm_b32 v27, v127, v123, v18
    ds_write_b128 v2, v[24:27] offset:32768
    v_perm_b32 v28, v103, v99, v19
    v_perm_b32 v29, v111, v107, v19
    v_perm_b32 v30, v119, v115, v19
    v_perm_b32 v31, v127, v123, v19
    ds_write_b128 v2, v[28:31] offset:49152
    s_add_u32 s52, s64, 557056
    buffer_load_dwordx4 v[96:99], v16, s[60:63], s52 offen
    s_add_u32 s52, s64, 565248
    buffer_load_dwordx4 v[100:103], v16, s[60:63], s52 offen
    s_add_u32 s52, s64, 819200
    buffer_load_dwordx4 v[104:107], v16, s[60:63], s52 offen
    s_add_u32 s52, s64, 827392
    buffer_load_dwordx4 v[108:111], v16, s[60:63], s52 offen
    s_add_u32 s52, s64, 622592
    buffer_load_dwordx4 v[112:115], v16, s[60:63], s52 offen
    s_add_u32 s52, s64, 630784
    buffer_load_dwordx4 v[116:119], v16, s[60:63], s52 offen
    s_add_u32 s52, s64, 884736
    buffer_load_dwordx4 v[120:123], v16, s[60:63], s52 offen
    s_add_u32 s52, s64, 892928
    buffer_load_dwordx4 v[124:127], v16, s[60:63], s52 offen
    s_waitcnt vmcnt(16)
    v_perm_b32 v20, v36, v32, v18
    v_perm_b32 v21, v44, v40, v18
    v_perm_b32 v22, v52, v48, v18
    v_perm_b32 v23, v60, v56, v18
    ds_write_b128 v1, v[20:23] offset:1024
    v_perm_b32 v24, v36, v32, v19
    v_perm_b32 v25, v44, v40, v19
    v_perm_b32 v26, v52, v48, v19
    v_perm_b32 v27, v60, v56, v19
    ds_write_b128 v1, v[24:27] offset:17408
    v_perm_b32 v28, v37, v33, v18
    v_perm_b32 v29, v45, v41, v18
    v_perm_b32 v30, v53, v49, v18
    v_perm_b32 v31, v61, v57, v18
    ds_write_b128 v1, v[28:31] offset:33792
    v_perm_b32 v20, v37, v33, v19
    v_perm_b32 v21, v45, v41, v19
    v_perm_b32 v22, v53, v49, v19
    v_perm_b32 v23, v61, v57, v19
    ds_write_b128 v1, v[20:23] offset:50176
    v_perm_b32 v24, v38, v34, v18
    v_perm_b32 v25, v46, v42, v18
    v_perm_b32 v26, v54, v50, v18
    v_perm_b32 v27, v62, v58, v18
    ds_write_b128 v2, v[24:27] offset:1024
    v_perm_b32 v28, v38, v34, v19
    v_perm_b32 v29, v46, v42, v19
    v_perm_b32 v30, v54, v50, v19
    v_perm_b32 v31, v62, v58, v19
    ds_write_b128 v2, v[28:31] offset:17408
    v_perm_b32 v20, v39, v35, v18
    v_perm_b32 v21, v47, v43, v18
    v_perm_b32 v22, v55, v51, v18
    v_perm_b32 v23, v63, v59, v18
    ds_write_b128 v2, v[20:23] offset:33792
    v_perm_b32 v24, v39, v35, v19
    v_perm_b32 v25, v47, v43, v19
    v_perm_b32 v26, v55, v51, v19
    v_perm_b32 v27, v63, v59, v19
    ds_write_b128 v2, v[24:27] offset:50176
    s_mov_b32 s60, s10
    s_and_b32 s61, s11, 0xffff
    s_mov_b32 s62, 4194304
    s_mov_b32 s63, 0x20000
    s_lshl_b32 s64, s21, 17
    s_add_u32 s52, s64, 0
    buffer_load_dwordx4 v[32:35], v17, s[60:63], s52 offen
    s_add_u32 s52, s64, 8192
    buffer_load_dwordx4 v[36:39], v17, s[60:63], s52 offen
    s_add_u32 s52, s64, 16384
    buffer_load_dwordx4 v[40:43], v17, s[60:63], s52 offen
    s_add_u32 s52, s64, 24576
    buffer_load_dwordx4 v[44:47], v17, s[60:63], s52 offen
    s_add_u32 s52, s64, 1024
    buffer_load_dwordx4 v[48:51], v17, s[60:63], s52 offen
    s_add_u32 s52, s64, 9216
    buffer_load_dwordx4 v[52:55], v17, s[60:63], s52 offen
    s_add_u32 s52, s64, 17408
    buffer_load_dwordx4 v[56:59], v17, s[60:63], s52 offen
    s_add_u32 s52, s64, 25600
    buffer_load_dwordx4 v[60:63], v17, s[60:63], s52 offen
    s_waitcnt vmcnt(16)
    v_perm_b32 v28, v68, v64, v18
    v_perm_b32 v29, v76, v72, v18
    v_perm_b32 v30, v84, v80, v18
    v_perm_b32 v31, v92, v88, v18
    ds_write_b128 v1, v[28:31] offset:2048
    v_perm_b32 v20, v68, v64, v19
    v_perm_b32 v21, v76, v72, v19
    v_perm_b32 v22, v84, v80, v19
    v_perm_b32 v23, v92, v88, v19
    ds_write_b128 v1, v[20:23] offset:18432
    v_perm_b32 v24, v69, v65, v18
    v_perm_b32 v25, v77, v73, v18
    v_perm_b32 v26, v85, v81, v18
    v_perm_b32 v27, v93, v89, v18
    ds_write_b128 v1, v[24:27] offset:34816
    v_perm_b32 v28, v69, v65, v19
    v_perm_b32 v29, v77, v73, v19
    v_perm_b32 v30, v85, v81, v19
    v_perm_b32 v31, v93, v89, v19
    ds_write_b128 v1, v[28:31] offset:51200
    v_perm_b32 v20, v70, v66, v18
    v_perm_b32 v21, v78, v74, v18
    v_perm_b32 v22, v86, v82, v18
    v_perm_b32 v23, v94, v90, v18
    ds_write_b128 v2, v[20:23] offset:2048
    v_perm_b32 v24, v70, v66, v19
    v_perm_b32 v25, v78, v74, v19
    v_perm_b32 v26, v86, v82, v19
    v_perm_b32 v27, v94, v90, v19
    ds_write_b128 v2, v[24:27] offset:18432
    v_perm_b32 v28, v71, v67, v18
    v_perm_b32 v29, v79, v75, v18
    v_perm_b32 v30, v87, v83, v18
    v_perm_b32 v31, v95, v91, v18
    ds_write_b128 v2, v[28:31] offset:34816
    v_perm_b32 v20, v71, v67, v19
    v_perm_b32 v21, v79, v75, v19
    v_perm_b32 v22, v87, v83, v19
    v_perm_b32 v23, v95, v91, v19
    ds_write_b128 v2, v[20:23] offset:51200
    v_mov_b32 v10, 196
    v_mov_b32 v12, 0
    global_load_dwordx2 v[10:11], v10, s[14:15] sc1
    global_load_dwordx4 v[12:15], v12, s[18:19] sc1
    s_add_u32 s52, s64, 2048
    buffer_load_dwordx4 v[64:67], v17, s[60:63], s52 offen
    s_add_u32 s52, s64, 10240
    buffer_load_dwordx4 v[68:71], v17, s[60:63], s52 offen
    s_add_u32 s52, s64, 18432
    buffer_load_dwordx4 v[72:75], v17, s[60:63], s52 offen
    s_add_u32 s52, s64, 26624
    buffer_load_dwordx4 v[76:79], v17, s[60:63], s52 offen
    s_add_u32 s52, s64, 3072
    buffer_load_dwordx4 v[80:83], v17, s[60:63], s52 offen
    s_add_u32 s52, s64, 11264
    buffer_load_dwordx4 v[84:87], v17, s[60:63], s52 offen
    s_add_u32 s52, s64, 19456
    buffer_load_dwordx4 v[88:91], v17, s[60:63], s52 offen
    s_add_u32 s52, s64, 27648
    buffer_load_dwordx4 v[92:95], v17, s[60:63], s52 offen
    s_waitcnt vmcnt(18)
    v_perm_b32 v24, v100, v96, v18
    v_perm_b32 v25, v108, v104, v18
    v_perm_b32 v26, v116, v112, v18
    v_perm_b32 v27, v124, v120, v18
    ds_write_b128 v1, v[24:27] offset:3072
    v_perm_b32 v28, v100, v96, v19
    v_perm_b32 v29, v108, v104, v19
    v_perm_b32 v30, v116, v112, v19
    v_perm_b32 v31, v124, v120, v19
    ds_write_b128 v1, v[28:31] offset:19456
    v_perm_b32 v20, v101, v97, v18
    v_perm_b32 v21, v109, v105, v18
    v_perm_b32 v22, v117, v113, v18
    v_perm_b32 v23, v125, v121, v18
    ds_write_b128 v1, v[20:23] offset:35840
    v_perm_b32 v24, v101, v97, v19
    v_perm_b32 v25, v109, v105, v19
    v_perm_b32 v26, v117, v113, v19
    v_perm_b32 v27, v125, v121, v19
    ds_write_b128 v1, v[24:27] offset:52224
    v_perm_b32 v28, v102, v98, v18
    v_perm_b32 v29, v110, v106, v18
    v_perm_b32 v30, v118, v114, v18
    v_perm_b32 v31, v126, v122, v18
    ds_write_b128 v2, v[28:31] offset:3072
    v_perm_b32 v20, v102, v98, v19
    v_perm_b32 v21, v110, v106, v19
    v_perm_b32 v22, v118, v114, v19
    v_perm_b32 v23, v126, v122, v19
    ds_write_b128 v2, v[20:23] offset:19456
    v_perm_b32 v24, v103, v99, v18
    v_perm_b32 v25, v111, v107, v18
    v_perm_b32 v26, v119, v115, v18
    v_perm_b32 v27, v127, v123, v18
    ds_write_b128 v2, v[24:27] offset:35840
    v_perm_b32 v28, v103, v99, v19
    v_perm_b32 v29, v111, v107, v19
    v_perm_b32 v30, v119, v115, v19
    v_perm_b32 v31, v127, v123, v19
    ds_write_b128 v2, v[28:31] offset:52224
    s_add_u32 s52, s64, 4096
    buffer_load_dwordx4 v[96:99], v17, s[60:63], s52 offen
    s_add_u32 s52, s64, 12288
    buffer_load_dwordx4 v[100:103], v17, s[60:63], s52 offen
    s_add_u32 s52, s64, 20480
    buffer_load_dwordx4 v[104:107], v17, s[60:63], s52 offen
    s_add_u32 s52, s64, 28672
    buffer_load_dwordx4 v[108:111], v17, s[60:63], s52 offen
    s_add_u32 s52, s64, 5120
    buffer_load_dwordx4 v[112:115], v17, s[60:63], s52 offen
    s_add_u32 s52, s64, 13312
    buffer_load_dwordx4 v[116:119], v17, s[60:63], s52 offen
    s_add_u32 s52, s64, 21504
    buffer_load_dwordx4 v[120:123], v17, s[60:63], s52 offen
    s_add_u32 s52, s64, 29696
    buffer_load_dwordx4 v[124:127], v17, s[60:63], s52 offen
    s_waitcnt lgkmcnt(0)
    s_lshl_b32 s53, s22, 15
    s_lshl_b32 s52, s56, 1
    s_add_u32 s52, s52, s53
    v_add_u32 v20, s52, v0
    s_lshl_b32 s52, s57, 1
    s_add_u32 s52, s52, s53
    v_add_u32 v21, s52, v0
    s_lshl_b32 s52, s58, 1
    s_add_u32 s52, s52, s53
    v_add_u32 v22, s52, v0
    s_lshl_b32 s52, s59, 1
    s_add_u32 s52, s52, s53
    v_add_u32 v23, s52, v0
    s_barrier
    ds_read_b128 a[0:3], v20 offset:0
    ds_read_b128 a[4:7], v20 offset:1024
    ds_read_b128 a[8:11], v20 offset:16384
    ds_read_b128 a[12:15], v20 offset:17408
    s_waitcnt lgkmcnt(4)
    ds_read_b128 a[16:19], v20 offset:2048
    ds_read_b128 a[20:23], v20 offset:3072
    ds_read_b128 a[192:195], v20 offset:18432
    ds_read_b128 a[196:199], v20 offset:19456
    s_waitcnt lgkmcnt(4)
    ds_read_b128 a[24:27], v21 offset:0
    ds_read_b128 a[28:31], v21 offset:1024
    ds_read_b128 a[32:35], v21 offset:16384
    ds_read_b128 a[36:39], v21 offset:17408
    s_waitcnt lgkmcnt(4)
    ds_read_b128 a[40:43], v21 offset:2048
    ds_read_b128 a[44:47], v21 offset:3072
    ds_read_b128 a[216:219], v21 offset:18432
    ds_read_b128 a[220:223], v21 offset:19456
    s_waitcnt lgkmcnt(4)
    ds_read_b128 a[48:51], v22 offset:0
    ds_read_b128 a[52:55], v22 offset:1024
    ds_read_b128 a[56:59], v22 offset:16384
    ds_read_b128 a[60:63], v22 offset:17408
    s_waitcnt lgkmcnt(4)
    ds_read_b128 a[64:67], v22 offset:2048
    ds_read_b128 a[68:71], v22 offset:3072
    ds_read_b128 a[224:227], v22 offset:18432
    ds_read_b128 a[228:231], v22 offset:19456
    s_waitcnt lgkmcnt(4)
    ds_read_b128 a[72:75], v23 offset:0
    ds_read_b128 a[76:79], v23 offset:1024
    ds_read_b128 a[80:83], v23 offset:16384
    ds_read_b128 a[84:87], v23 offset:17408
    s_waitcnt lgkmcnt(4)
    ds_read_b128 a[88:91], v23 offset:2048
    ds_read_b128 a[92:95], v23 offset:3072
    ds_read_b128 a[232:235], v23 offset:18432
    ds_read_b128 a[236:239], v23 offset:19456
    s_waitcnt lgkmcnt(4)
    s_waitcnt lgkmcnt(0)
    s_barrier
    ds_write_b128 v2, a[192:195] offset:0
    ds_write_b128 v2, a[196:199] offset:1024
    ds_write_b128 v2, a[200:203] offset:2048
    ds_write_b128 v2, a[204:207] offset:3072
    ds_write_b128 v2, a[208:211] offset:16384
    ds_write_b128 v2, a[212:215] offset:17408
    ds_write_b128 v2, a[216:219] offset:18432
    ds_write_b128 v2, a[220:223] offset:19456
    s_waitcnt lgkmcnt(0)
    ds_write_b128 v2, a[224:227] offset:32768
    ds_write_b128 v2, a[228:231] offset:33792
    ds_write_b128 v2, a[232:235] offset:34816
    ds_write_b128 v2, a[236:239] offset:35840
    ds_write_b128 v2, a[240:243] offset:49152
    ds_write_b128 v2, a[244:247] offset:50176
    ds_write_b128 v2, a[248:251] offset:51200
    ds_write_b128 v2, a[252:255] offset:52224
    s_waitcnt lgkmcnt(0)
    s_waitcnt vmcnt(18)
    v_perm_b32 v20, v36, v32, v18
    v_perm_b32 v21, v36, v32, v19
    v_perm_b32 v22, v44, v40, v18
    v_perm_b32 v23, v44, v40, v19
    ds_write_b128 v1, v[20:23] offset:0
    v_perm_b32 v24, v52, v48, v18
    v_perm_b32 v25, v52, v48, v19
    v_perm_b32 v26, v60, v56, v18
    v_perm_b32 v27, v60, v56, v19
    ds_write_b128 v1, v[24:27] offset:1024
    v_perm_b32 v28, v37, v33, v18
    v_perm_b32 v29, v37, v33, v19
    v_perm_b32 v30, v45, v41, v18
    v_perm_b32 v31, v45, v41, v19
    ds_write_b128 v1, v[28:31] offset:32768
    v_perm_b32 v20, v53, v49, v18
    v_perm_b32 v21, v53, v49, v19
    v_perm_b32 v22, v61, v57, v18
    v_perm_b32 v23, v61, v57, v19
    ds_write_b128 v1, v[20:23] offset:33792
    v_perm_b32 v24, v38, v34, v18
    v_perm_b32 v25, v38, v34, v19
    v_perm_b32 v26, v46, v42, v18
    v_perm_b32 v27, v46, v42, v19
    v_accvgpr_write_b32 a192, v24
    v_accvgpr_write_b32 a193, v25
    v_accvgpr_write_b32 a194, v26
    v_accvgpr_write_b32 a195, v27
    v_perm_b32 v28, v54, v50, v18
    v_perm_b32 v29, v54, v50, v19
    v_perm_b32 v30, v62, v58, v18
    v_perm_b32 v31, v62, v58, v19
    v_accvgpr_write_b32 a196, v28
    v_accvgpr_write_b32 a197, v29
    v_accvgpr_write_b32 a198, v30
    v_accvgpr_write_b32 a199, v31
    v_perm_b32 v20, v39, v35, v18
    v_perm_b32 v21, v39, v35, v19
    v_perm_b32 v22, v47, v43, v18
    v_perm_b32 v23, v47, v43, v19
    v_accvgpr_write_b32 a224, v20
    v_accvgpr_write_b32 a225, v21
    v_accvgpr_write_b32 a226, v22
    v_accvgpr_write_b32 a227, v23
    v_perm_b32 v24, v55, v51, v18
    v_perm_b32 v25, v55, v51, v19
    v_perm_b32 v26, v63, v59, v18
    v_perm_b32 v27, v63, v59, v19
    v_accvgpr_write_b32 a228, v24
    v_accvgpr_write_b32 a229, v25
    v_accvgpr_write_b32 a230, v26
    v_accvgpr_write_b32 a231, v27
    s_add_u32 s52, s64, 6144
    buffer_load_dwordx4 v[32:35], v17, s[60:63], s52 offen
    s_add_u32 s52, s64, 14336
    buffer_load_dwordx4 v[36:39], v17, s[60:63], s52 offen
    s_add_u32 s52, s64, 22528
    buffer_load_dwordx4 v[40:43], v17, s[60:63], s52 offen
    s_add_u32 s52, s64, 30720
    buffer_load_dwordx4 v[44:47], v17, s[60:63], s52 offen
    s_add_u32 s52, s64, 7168
    buffer_load_dwordx4 v[48:51], v17, s[60:63], s52 offen
    s_add_u32 s52, s64, 15360
    buffer_load_dwordx4 v[52:55], v17, s[60:63], s52 offen
    s_add_u32 s52, s64, 23552
    buffer_load_dwordx4 v[56:59], v17, s[60:63], s52 offen
    s_add_u32 s52, s64, 31744
    buffer_load_dwordx4 v[60:63], v17, s[60:63], s52 offen
    s_waitcnt vmcnt(16)
    v_perm_b32 v28, v68, v64, v18
    v_perm_b32 v29, v68, v64, v19
    v_perm_b32 v30, v76, v72, v18
    v_perm_b32 v31, v76, v72, v19
    ds_write_b128 v1, v[28:31] offset:2048
    v_perm_b32 v20, v84, v80, v18
    v_perm_b32 v21, v84, v80, v19
    v_perm_b32 v22, v92, v88, v18
    v_perm_b32 v23, v92, v88, v19
    ds_write_b128 v1, v[20:23] offset:3072
    v_perm_b32 v24, v69, v65, v18
    v_perm_b32 v25, v69, v65, v19
    v_perm_b32 v26, v77, v73, v18
    v_perm_b32 v27, v77, v73, v19
    ds_write_b128 v1, v[24:27] offset:34816
    v_perm_b32 v28, v85, v81, v18
    v_perm_b32 v29, v85, v81, v19
    v_perm_b32 v30, v93, v89, v18
    v_perm_b32 v31, v93, v89, v19
    ds_write_b128 v1, v[28:31] offset:35840
    v_perm_b32 v20, v70, v66, v18
    v_perm_b32 v21, v70, v66, v19
    v_perm_b32 v22, v78, v74, v18
    v_perm_b32 v23, v78, v74, v19
    v_accvgpr_write_b32 a200, v20
    v_accvgpr_write_b32 a201, v21
    v_accvgpr_write_b32 a202, v22
    v_accvgpr_write_b32 a203, v23
    v_perm_b32 v24, v86, v82, v18
    v_perm_b32 v25, v86, v82, v19
    v_perm_b32 v26, v94, v90, v18
    v_perm_b32 v27, v94, v90, v19
    v_accvgpr_write_b32 a204, v24
    v_accvgpr_write_b32 a205, v25
    v_accvgpr_write_b32 a206, v26
    v_accvgpr_write_b32 a207, v27
    v_perm_b32 v28, v71, v67, v18
    v_perm_b32 v29, v71, v67, v19
    v_perm_b32 v30, v79, v75, v18
    v_perm_b32 v31, v79, v75, v19
    v_accvgpr_write_b32 a232, v28
    v_accvgpr_write_b32 a233, v29
    v_accvgpr_write_b32 a234, v30
    v_accvgpr_write_b32 a235, v31
    v_perm_b32 v20, v87, v83, v18
    v_perm_b32 v21, v87, v83, v19
    v_perm_b32 v22, v95, v91, v18
    v_perm_b32 v23, v95, v91, v19
    v_accvgpr_write_b32 a236, v20
    v_accvgpr_write_b32 a237, v21
    v_accvgpr_write_b32 a238, v22
    v_accvgpr_write_b32 a239, v23
    s_mov_b32 s25, 0
    s_branch CH_RV1
CH_RV:
    v_mov_b32 v10, 196
    v_mov_b32 v12, 0
    global_load_dwordx2 v[10:11], v10, s[14:15] sc1
    global_load_dwordx4 v[12:15], v12, s[18:19] sc1
    s_add_u32 s25, s25, 1
    s_cmp_gt_u32 s25, 200000
    s_cbranch_scc1 CH_ABORT
    s_waitcnt vmcnt(0)
CH_RV1:
    v_readfirstlane_b32 s51, v11
    v_readfirstlane_b32 s67, v10
    s_nop 1
    s_cmp_ge_u32 s51, 32
    s_cbranch_scc0 CH_RV
    s_bitcmp1_b32 s67, 8
    s_cbranch_scc0 CH_RV
    s_lshl_b32 s99, s22, 4
    s_add_u32 s99, s99, 163136
    v_mov_b32 v20, s99
    ds_write_b128 v20, v[12:15]
    s_waitcnt lgkmcnt(0)
    v_min_u32 v12, v12, v14
    s_nop 0
    v_readfirstlane_b32 s55, v12
    s_nop 1
    s_cmp_ge_u32 s55, 64
    s_cselect_b32 s55, 100, s55
    s_cmp_eq_u32 s55, 0
    s_cbranch_scc1 CH_RV
    s_and_b32 s67, s67, 1
    v_mov_b32 v20, 64
    v_mov_b32 v21, 1
    s_cmp_eq_u32 s22, 0
    s_cselect_b64 exec, 1, 0
    global_atomic_add v20, v21, s[14:15]
    s_mov_b64 exec, -1
    s_add_u32 s51, s56, 146432
    s_mov_b32 m0, s51
    s_nop 0
    global_load_lds_dwordx4 v0, s[38:39] sc1
    global_load_lds_dwordx4 v0, s[38:39] offset:1024 sc1
    s_add_u32 s51, s51, 8192
    s_mov_b32 m0, s51
    s_nop 0
    global_load_lds_dwordx4 v0, s[40:41] sc1
    global_load_lds_dwordx4 v0, s[40:41] offset:1024 sc1
    s_add_u32 s51, s56, 131072
    s_mov_b32 m0, s51
    s_and_b32 s51, s23, 31
    s_lshl_b32 s51, s51, 10
    s_add_u32 s51, s51, 1048576
    s_add_u32 s32, s16, s51
    s_addc_u32 s33, s17, 0
    global_load_lds_dwordx4 v0, s[30:31] sc1
    global_load_lds_dwordx4 v0, s[30:31] offset:1024 sc1
    global_load_lds_dwordx4 v0, s[26:27] sc1
    global_load_lds_dwordx4 v0, s[26:27] offset:1024 sc1
    global_load_lds_dwordx4 v0, s[32:33] sc1
    s_waitcnt lgkmcnt(0)
    v_lshrrev_b32 v20, 1, v0
    v_mov_b32 v24, -1
    v_mov_b32 v25, -1
    s_add_u32 s36, s42, 3735552
    s_addc_u32 s37, s43, 0
    global_store_dwordx2 v20, v[24:25], s[36:37] sc1
    s_add_u32 s36, s44, 3735552
    s_addc_u32 s37, s45, 0
    global_store_dwordx2 v20, v[24:25], s[36:37] sc1
    s_add_u32 s36, s42, 3801088
    s_addc_u32 s37, s43, 0
    global_store_dwordx2 v20, v[24:25], s[36:37] sc1
    s_add_u32 s36, s44, 3801088
    s_addc_u32 s37, s45, 0
    global_store_dwordx2 v20, v[24:25], s[36:37] sc1
    s_add_u32 s36, s42, 3866624
    s_addc_u32 s37, s43, 0
    global_store_dwordx2 v20, v[24:25], s[36:37] sc1
    s_add_u32 s36, s44, 3866624
    s_addc_u32 s37, s45, 0
    global_store_dwordx2 v20, v[24:25], s[36:37] sc1
    s_add_u32 s36, s42, 3932160
    s_addc_u32 s37, s43, 0
    global_store_dwordx2 v20, v[24:25], s[36:37] sc1
    s_add_u32 s36, s44, 3932160
    s_addc_u32 s37, s45, 0
    global_store_dwordx2 v20, v[24:25], s[36:37] sc1
    s_add_u32 s36, s42, 3997696
    s_addc_u32 s37, s43, 0
    global_store_dwordx2 v20, v[24:25], s[36:37] sc1
    s_add_u32 s36, s44, 3997696
    s_addc_u32 s37, s45, 0
    global_store_dwordx2 v20, v[24:25], s[36:37] sc1
    s_add_u32 s36, s42, 4063232
    s_addc_u32 s37, s43, 0
    global_store_dwordx2 v20, v[24:25], s[36:37] sc1
    s_add_u32 s36, s44, 4063232
    s_addc_u32 s37, s45, 0
    global_store_dwordx2 v20, v[24:25], s[36:37] sc1
    s_add_u32 s36, s42, 4128768
    s_addc_u32 s37, s43, 0
    global_store_dwordx2 v20, v[24:25], s[36:37] sc1
    s_add_u32 s36, s44, 4128768
    s_addc_u32 s37, s45, 0
    global_store_dwordx2 v20, v[24:25], s[36:37] sc1
    s_add_u32 s36, s42, 4194304
    s_addc_u32 s37, s43, 0
    global_store_dwordx2 v20, v[24:25], s[36:37] sc1
    s_add_u32 s36, s44, 4194304
    s_addc_u32 s37, s45, 0
    global_store_dwordx2 v20, v[24:25], s[36:37] sc1
    s_waitcnt vmcnt(17)
    v_perm_b32 v24, v100, v96, v18
    v_perm_b32 v25, v100, v96, v19
    v_perm_b32 v26, v108, v104, v18
    v_perm_b32 v27, v108, v104, v19
    ds_write_b128 v1, v[24:27] offset:16384
    v_perm_b32 v28, v116, v112, v18
    v_perm_b32 v29, v116, v112, v19
    v_perm_b32 v30, v124, v120, v18
    v_perm_b32 v31, v124, v120, v19
    ds_write_b128 v1, v[28:31] offset:17408
    v_perm_b32 v20, v101, v97, v18
    v_perm_b32 v21, v101, v97, v19
    v_perm_b32 v22, v109, v105, v18
    v_perm_b32 v23, v109, v105, v19
    ds_write_b128 v1, v[20:23] offset:49152
    v_perm_b32 v24, v117, v113, v18
    v_perm_b32 v25, v117, v113, v19
    v_perm_b32 v26, v125, v121, v18
    v_perm_b32 v27, v125, v121, v19
    ds_write_b128 v1, v[24:27] offset:50176
    v_perm_b32 v28, v102, v98, v18
    v_perm_b32 v29, v102, v98, v19
    v_perm_b32 v30, v110, v106, v18
    v_perm_b32 v31, v110, v106, v19
    v_accvgpr_write_b32 a208, v28
    v_accvgpr_write_b32 a209, v29
    v_accvgpr_write_b32 a210, v30
    v_accvgpr_write_b32 a211, v31
    v_perm_b32 v20, v118, v114, v18
    v_perm_b32 v21, v118, v114, v19
    v_perm_b32 v22, v126, v122, v18
    v_perm_b32 v23, v126, v122, v19
    v_accvgpr_write_b32 a212, v20
    v_accvgpr_write_b32 a213, v21
    v_accvgpr_write_b32 a214, v22
    v_accvgpr_write_b32 a215, v23
    v_perm_b32 v24, v103, v99, v18
    v_perm_b32 v25, v103, v99, v19
    v_perm_b32 v26, v111, v107, v18
    v_perm_b32 v27, v111, v107, v19
    v_accvgpr_write_b32 a240, v24
    v_accvgpr_write_b32 a241, v25
    v_accvgpr_write_b32 a242, v26
    v_accvgpr_write_b32 a243, v27
    v_perm_b32 v28, v119, v115, v18
    v_perm_b32 v29, v119, v115, v19
    v_perm_b32 v30, v127, v123, v18
    v_perm_b32 v31, v127, v123, v19
    v_accvgpr_write_b32 a244, v28
    v_accvgpr_write_b32 a245, v29
    v_accvgpr_write_b32 a246, v30
    v_accvgpr_write_b32 a247, v31
    s_waitcnt vmcnt(9)
    v_perm_b32 v20, v36, v32, v18
    v_perm_b32 v21, v36, v32, v19
    v_perm_b32 v22, v44, v40, v18
    v_perm_b32 v23, v44, v40, v19
    ds_write_b128 v1, v[20:23] offset:18432
    v_perm_b32 v24, v52, v48, v18
    v_perm_b32 v25, v52, v48, v19
    v_perm_b32 v26, v60, v56, v18
    v_perm_b32 v27, v60, v56, v19
    ds_write_b128 v1, v[24:27] offset:19456
    v_perm_b32 v28, v37, v33, v18
    v_perm_b32 v29, v37, v33, v19
    v_perm_b32 v30, v45, v41, v18
    v_perm_b32 v31, v45, v41, v19
    ds_write_b128 v1, v[28:31] offset:51200
    v_perm_b32 v20, v53, v49, v18
    v_perm_b32 v21, v53, v49, v19
    v_perm_b32 v22, v61, v57, v18
    v_perm_b32 v23, v61, v57, v19
    ds_write_b128 v1, v[20:23] offset:52224
    v_perm_b32 v24, v38, v34, v18
    v_perm_b32 v25, v38, v34, v19
    v_perm_b32 v26, v46, v42, v18
    v_perm_b32 v27, v46, v42, v19
    v_accvgpr_write_b32 a216, v24
    v_accvgpr_write_b32 a217, v25
    v_accvgpr_write_b32 a218, v26
    v_accvgpr_write_b32 a219, v27
    v_perm_b32 v28, v54, v50, v18
    v_perm_b32 v29, v54, v50, v19
    v_perm_b32 v30, v62, v58, v18
    v_perm_b32 v31, v62, v58, v19
    v_accvgpr_write_b32 a220, v28
    v_accvgpr_write_b32 a221, v29
    v_accvgpr_write_b32 a222, v30
    v_accvgpr_write_b32 a223, v31
    v_perm_b32 v20, v39, v35, v18
    v_perm_b32 v21, v39, v35, v19
    v_perm_b32 v22, v47, v43, v18
    v_perm_b32 v23, v47, v43, v19
    v_accvgpr_write_b32 a248, v20
    v_accvgpr_write_b32 a249, v21
    v_accvgpr_write_b32 a250, v22
    v_accvgpr_write_b32 a251, v23
    v_perm_b32 v24, v55, v51, v18
    v_perm_b32 v25, v55, v51, v19
    v_perm_b32 v26, v63, v59, v18
    v_perm_b32 v27, v63, v59, v19
    v_accvgpr_write_b32 a252, v24
    v_accvgpr_write_b32 a253, v25
    v_accvgpr_write_b32 a254, v26
    v_accvgpr_write_b32 a255, v27
    v_mov_b32 v10, 0
    v_mov_b32 v11, 0
    s_mov_b32 s24, 0
    s_mov_b32 s100, 0
    s_mov_b32 s101, 0
    s_and_b32 s51, s24, 3
    s_lshl_b32 s51, s51, 13
    s_add_u32 s51, s51, s56
    s_add_u32 s51, s51, 1048576
    s_add_u32 s32, s16, s51
    s_addc_u32 s33, s17, 0
    s_waitcnt vmcnt(0) lgkmcnt(0)
    s_barrier
    v_add_u32 v64, 146432, v0
    v_add_u32 v65, s68, v0
    ds_read_b128 v[96:99], v64 offset:0
    ds_read_b128 v[100:103], v64 offset:1024
    ds_read_b128 v[104:107], v64 offset:2048
    ds_read_b128 v[108:111], v64 offset:3072
    ds_read_b128 v[112:115], v64 offset:4096
    ds_read_b128 v[116:119], v64 offset:5120
    ds_read_b128 v[120:123], v64 offset:6144
    ds_read_b128 v[124:127], v64 offset:7168
    ds_read_b128 v[12:15], v65 offset:23552
    ds_read_b128 v[16:19], v65 offset:24576
    v_mov_b32 v92, s99
    ds_read_b128 v[92:95], v92
    s_waitcnt lgkmcnt(0)
    s_cmp_lg_u32 s67, 0
    s_cbranch_scc1 ENTRY_slow
ENTRY_fast:
    s_branch STEP_fast
.p2align 6
STEP_fast:
KVC_fast:
    v_min_u32 v92, v92, v94
    s_nop 0
    v_readfirstlane_b32 s55, v92
    s_nop 1
    s_cmp_ge_u32 s55, 64
    s_cselect_b32 s55, 100, s55
    s_add_u32 s51, s24, 2
    s_cmp_lt_u32 s55, s51
    s_cbranch_scc1 KVP_fast
KVOK_fast:
    s_mov_b32 s25, 0
    ds_read_b128 v[28:31], v2 offset:0
    ds_read_b128 v[32:35], v2 offset:1024
    ds_read_b128 v[40:43], v2 offset:2048
    ds_read_b128 v[44:47], v2 offset:3072
    v_mfma_f32_32x32x8_bf16 v[48:63], v[10:11], v[10:11], 0
    v_lshrrev_b32 v36, 1, v0
    v_min_u32 v38, -2, v38
    v_min_u32 v39, -2, v39
    v_min_u32 v90, -2, v90
    v_min_u32 v91, -2, v91
    s_sub_u32 s51, s24, 1
    s_max_i32 s51, s51, 0
    v_mov_b32 v37, s51
    v_mov_b32 v20, 0
    v_mov_b32 v21, 0
    v_mov_b32 v22, 0
    global_load_dwordx4 v[64:67], v0, s[32:33] offset:0 sc1
    global_load_dwordx4 v[68:71], v0, s[32:33] offset:1024 sc1
    v_mov_b32 v23, 0
    v_mov_b32 v24, 0
    v_mov_b32 v25, 0
    v_mov_b32 v26, 0
    v_mov_b32 v27, 0
    v_add_u32 v92, s68, v0
    v_add_u32 v93, s69, v0
    v_add_u32 v94, s70, v0
    v_add_u32 v95, s71, v0
    s_lshl_b32 s53, s23, 6
    s_add_u32 s53, s53, 1048576
    s_add_u32 s51, s24, 1
    s_and_b32 s51, s51, 3
    s_lshl_b32 s51, s51, 13
    s_add_u32 s51, s51, s53
    s_add_u32 s34, s16, s51
    s_addc_u32 s35, s17, 0
    s_add_u32 s51, s24, 3
    s_and_b32 s51, s51, 3
    s_lshl_b32 s51, s51, 13
    s_add_u32 s51, s51, s53
    s_add_u32 s36, s16, s51
    s_addc_u32 s37, s17, 0
    s_and_b32 s51, s24, 1
    s_mul_i32 s51, s51, 278528
    s_lshl_b32 s52, s21, 6
    s_add_u32 s52, s52, s51
    s_add_u32 s26, s16, s52
    s_addc_u32 s27, s17, 0
    s_add_u32 s28, s26, 8704
    s_addc_u32 s29, s27, 0
    s_add_u32 s60, s26, 17408
    s_addc_u32 s61, s27, 0
    s_add_u32 s62, s26, 26112
    s_addc_u32 s63, s27, 0
    s_mul_i32 s52, s23, 2176
    global_load_dwordx4 v[64:67], v0, s[32:33] offset:0 sc1
    global_load_dwordx4 v[68:71], v0, s[32:33] offset:1024 sc1
    s_add_u32 s53, s52, s51
    s_add_u32 s30, s16, s53
    s_addc_u32 s31, s17, 0
    s_lshr_b32 s66, s24, 1
    s_and_b32 s66, s66, 1
    s_xor_b32 s66, s66, 1
    s_add_u32 s51, s56, 146432
    s_mov_b32 m0, s51
    s_add_u32 s38, s38, 262144
    s_addc_u32 s39, s39, 0
    s_add_u32 s40, s40, 262144
    s_addc_u32 s41, s41, 0
    s_nop 0
    s_branch P2W_fast
P2R_fast:
    s_mov_b64 exec, vcc
    global_load_dwordx4 v[64:67], v0, s[32:33] offset:0 sc1
    global_load_dwordx4 v[68:71], v0, s[32:33] offset:1024 sc1
    s_mov_b64 exec, -1
    s_add_u32 s25, s25, 1
    s_add_u32 s100, s100, 1
    s_cmp_gt_u32 s25, 200000
    s_cbranch_scc1 CH_ABORT
    s_nop 7
P2W_fast:
    s_waitcnt vmcnt(2)
P2C_fast:
    v_max3_u32 v80, v64, v65, v66
    v_max3_u32 v81, v67, v68, v69
    v_max3_u32 v80, v80, v70, v71
    v_max_u32 v80, v80, v81
    v_cmp_eq_u32 vcc, -1, v80
    s_cbranch_vccnz P2R_fast
P2OK_fast:
    v_smfmac_f32_16x16x64_bf16 v[48:51], v[64:67], a[0:7], v9
    ds_write_b128 v92, v[64:67]
    ds_write_b128 v92, v[68:71] offset:1024
    v_smfmac_f32_16x16x64_bf16 v[52:55], v[64:67], a[8:15], v9
    global_store_dwordx2 v36, v[90:91], s[42:43] sc1
    v_smfmac_f32_16x16x64_bf16 v[48:51], v[68:71], a[16:23], v9
    s_waitcnt lgkmcnt(4)
    v_smfmac_f32_16x16x64_bf16 v[52:55], v[68:71], v[28:35], v9
    ds_read_b128 v[28:31], v2 offset:16384
    ds_read_b128 v[32:35], v2 offset:17408
    v_smfmac_f32_16x16x64_bf16 v[20:23], v[64:67], v[128:135], v9
    v_smfmac_f32_16x16x64_bf16 v[24:27], v[64:67], v[136:143], v9
    v_smfmac_f32_16x16x64_bf16 v[20:23], v[68:71], v[144:151], v9
    v_smfmac_f32_16x16x64_bf16 v[24:27], v[68:71], v[152:159], v9
    s_waitcnt lgkmcnt(2)
    s_barrier
    ds_read_b128 v[72:75], v93 offset:0
    v_smfmac_f32_16x16x64_bf16 v[56:59], v[64:67], a[96:103], v9
    ds_read_b128 v[76:79], v93 offset:1024
    v_smfmac_f32_16x16x64_bf16 v[60:63], v[64:67], v[40:47], v9
    ds_read_b128 v[40:43], v2 offset:18432
    global_load_lds_dwordx4 v0, s[38:39] offset:0 sc1
    v_smfmac_f32_16x16x64_bf16 v[56:59], v[68:71], a[104:111], v9
    ds_read_b128 v[44:47], v2 offset:19456
    s_waitcnt lgkmcnt(4)
    v_smfmac_f32_16x16x64_bf16 v[60:63], v[68:71], v[28:35], v9
    ds_read_b128 v[80:83], v94 offset:0
    s_waitcnt lgkmcnt(4)
    v_smfmac_f32_16x16x64_bf16 v[48:51], v[72:75], a[24:31], v9
    ds_read_b128 v[84:87], v94 offset:1024
    global_load_lds_dwordx4 v0, s[38:39] offset:1024 sc1
    s_add_u32 s51, m0, 8192
    s_mov_b32 m0, s51
    v_smfmac_f32_16x16x64_bf16 v[52:55], v[72:75], a[32:39], v9
    ds_read_b128 v[28:31], v2 offset:32768
    s_waitcnt lgkmcnt(5)
    v_smfmac_f32_16x16x64_bf16 v[48:51], v[76:79], a[40:47], v9
    ds_read_b128 v[32:35], v2 offset:33792
    s_waitcnt lgkmcnt(4)
    v_smfmac_f32_16x16x64_bf16 v[52:55], v[76:79], v[40:47], v9
    ds_read_b128 v[88:91], v95 offset:0
    global_load_lds_dwordx4 v0, s[40:41] offset:0 sc1
    s_waitcnt lgkmcnt(4)
    v_smfmac_f32_16x16x64_bf16 v[48:51], v[80:83], a[48:55], v9
    ds_read_b128 v[92:95], v95 offset:1024
    v_smfmac_f32_16x16x64_bf16 v[52:55], v[80:83], a[56:63], v9
    ds_read_b128 v[40:43], v2 offset:34816
    s_waitcnt lgkmcnt(5)
    v_smfmac_f32_16x16x64_bf16 v[48:51], v[84:87], a[64:71], v9
    ds_read_b128 v[44:47], v2 offset:35840
    global_load_lds_dwordx4 v0, s[40:41] offset:1024 sc1
    s_waitcnt lgkmcnt(4)
    v_smfmac_f32_16x16x64_bf16 v[52:55], v[84:87], v[28:35], v9
    s_waitcnt lgkmcnt(3)
    v_smfmac_f32_16x16x64_bf16 v[48:51], v[88:91], a[72:79], v9
    ds_read_b128 v[28:31], v2 offset:49152
    global_store_dwordx2 v36, v[38:39], s[44:45] sc1
    v_smfmac_f32_16x16x64_bf16 v[52:55], v[88:91], a[80:87], v9
    ds_read_b128 v[32:35], v2 offset:50176
    s_waitcnt lgkmcnt(4)
    v_smfmac_f32_16x16x64_bf16 v[48:51], v[92:95], a[88:95], v9
    s_mov_b64 exec, 1
    global_store_dword v10, v37, s[0:1] sc1
    s_mov_b64 exec, -1
    s_waitcnt lgkmcnt(2)
    v_smfmac_f32_16x16x64_bf16 v[52:55], v[92:95], v[40:47], v9
    ds_read_b128 v[40:43], v2 offset:51200
    s_mov_b32 m0, s99
    s_mov_b64 exec, 1
    global_load_lds_dwordx4 v10, s[18:19] sc1
    s_mov_b64 exec, -1
    v_smfmac_f32_16x16x64_bf16 v[56:59], v[80:83], a[128:135], v9
    ds_read_b128 v[44:47], v2 offset:52224
    v_smfmac_f32_16x16x64_bf16 v[60:63], v[80:83], a[136:143], v9
    v_add_f32 v48, v48, v49
    v_add_f32 v50, v50, v51
    v_smfmac_f32_16x16x64_bf16 v[56:59], v[72:75], a[112:119], v9
    v_add_f32 v52, v52, v53
    v_cvt_pk_bf16_f32 v36, v48, v52
    s_waitcnt lgkmcnt(2)
    v_smfmac_f32_16x16x64_bf16 v[60:63], v[72:75], v[28:35], v9
    ds_write_b32 v3, v36 offset:0
    v_add_f32 v54, v54, v55
    v_cvt_pk_bf16_f32 v37, v50, v54
    v_smfmac_f32_16x16x64_bf16 v[56:59], v[84:87], a[144:151], v9
    ds_write_b32 v3, v37 offset:272
    v_smfmac_f32_16x16x64_bf16 v[60:63], v[84:87], a[152:159], v9
    v_smfmac_f32_16x16x64_bf16 v[56:59], v[76:79], a[120:127], v9
    s_waitcnt lgkmcnt(2)
    v_smfmac_f32_16x16x64_bf16 v[60:63], v[76:79], v[40:47], v9
    v_smfmac_f32_16x16x64_bf16 v[56:59], v[88:91], a[160:167], v9
    s_waitcnt vmcnt(8)
    s_waitcnt lgkmcnt(0)
    s_barrier
    ds_read_b128 v[48:51], v4 offset:0
    v_smfmac_f32_16x16x64_bf16 v[60:63], v[88:91], a[168:175], v9
    ds_read_b128 v[52:55], v4 offset:64
    v_smfmac_f32_16x16x64_bf16 v[56:59], v[92:95], a[176:183], v9
    ds_read_b128 v[40:43], v4 offset:128
    v_smfmac_f32_16x16x64_bf16 v[60:63], v[92:95], a[184:191], v9
    ds_read_b128 v[44:47], v4 offset:192
    v_smfmac_f32_16x16x64_bf16 v[20:23], v[72:75], v[160:167], v9
    v_smfmac_f32_16x16x64_bf16 v[24:27], v[72:75], v[168:175], v9
    v_smfmac_f32_16x16x64_bf16 v[20:23], v[76:79], v[176:183], v9
    s_waitcnt lgkmcnt(3)
    v_mfma_f32_16x16x32_bf16 v[28:31], v[96:99], v[48:51], 0
    v_add_f32 v56, v56, v57
    v_add_f32 v60, v60, v61
    v_mfma_f32_16x16x32_bf16 v[32:35], v[112:115], v[48:51], 0
    v_cvt_pk_bf16_f32 v36, v56, v60
    v_add_f32 v58, v58, v59
    s_waitcnt lgkmcnt(2)
    v_mfma_f32_16x16x32_bf16 v[28:31], v[100:103], v[52:55], v[28:31]
    ds_write_b32 v3, v36 offset:2176
    v_add_f32 v62, v62, v63
    v_cvt_pk_bf16_f32 v37, v58, v62
    v_mfma_f32_16x16x32_bf16 v[32:35], v[116:119], v[52:55], v[32:35]
    ds_write_b32 v3, v37 offset:2448
    s_waitcnt lgkmcnt(3)
    v_mfma_f32_16x16x32_bf16 v[28:31], v[104:107], v[40:43], v[28:31]
    v_mfma_f32_16x16x32_bf16 v[32:35], v[120:123], v[40:43], v[32:35]
    s_waitcnt lgkmcnt(2)
    v_mfma_f32_16x16x32_bf16 v[28:31], v[108:111], v[44:47], v[28:31]
    v_mfma_f32_16x16x32_bf16 v[32:35], v[124:127], v[44:47], v[32:35]
    s_mov_b64 vcc, s[46:47]
    s_waitcnt lgkmcnt(0)
    s_barrier
    s_cmp_ge_u32 s24, 63
    s_cbranch_scc1 LAST_fast
    ds_read_b128 v[96:99], v5 offset:0
    v_smfmac_f32_16x16x64_bf16 v[24:27], v[76:79], v[184:191], v9
    ds_read_b128 v[100:103], v5 offset:64
    v_smfmac_f32_16x16x64_bf16 v[20:23], v[80:83], v[192:199], v9
    ds_read_b128 v[104:107], v5 offset:128
    v_smfmac_f32_16x16x64_bf16 v[24:27], v[80:83], v[200:207], v9
    ds_read_b128 v[108:111], v5 offset:192
    v_cndmask_b32 v28, v28, v32, vcc
    v_cndmask_b32 v29, v29, v33, vcc
    v_cndmask_b32 v30, v30, v34, vcc
    v_cndmask_b32 v31, v31, v35, vcc
    s_waitcnt lgkmcnt(3)
    v_mfma_f32_16x16x32_bf16 v[36:39], v[96:99], v[48:51], 0
    ds_read_b128 v[112:115], v1 offset:0
    s_waitcnt lgkmcnt(3)
    v_mfma_f32_16x16x32_bf16 v[36:39], v[100:103], v[52:55], v[36:39]
    ds_read_b128 v[116:119], v1 offset:1024
    s_waitcnt lgkmcnt(3)
    v_mfma_f32_16x16x32_bf16 v[36:39], v[104:107], v[40:43], v[36:39]
    ds_read_b128 v[120:123], v1 offset:2048
    s_waitcnt lgkmcnt(3)
    v_mfma_f32_16x16x32_bf16 v[36:39], v[108:111], v[44:47], v[36:39]
    ds_read_b128 v[124:127], v1 offset:3072
    v_smfmac_f32_16x16x64_bf16 v[20:23], v[84:87], v[208:215], v9
    ds_read_b128 v[96:99], v1 offset:16384
    v_smfmac_f32_16x16x64_bf16 v[24:27], v[84:87], v[216:223], v9
    s_nop 0
    v_cndmask_b32 v32, v36, v37, vcc
    v_max3_f32 v33, v28, v29, v30
    v_max3_f32 v33, v33, v31, v32
    v_smfmac_f32_16x16x64_bf16 v[20:23], v[88:91], v[224:231], v9
    ds_read_b128 v[100:103], v1 offset:17408
    v_max_f32_dpp v33, v33, v33 row_ror:8 row_mask:0xf bank_mask:0xf
    v_mov_b32 v34, v33
    v_smfmac_f32_16x16x64_bf16 v[24:27], v[88:91], v[232:239], v9
    ds_read_b128 v[104:107], v1 offset:18432
    v_permlane16_swap_b32 v33, v34
    v_max_f32 v33, v33, v34
    v_mov_b32 v34, v33
    v_smfmac_f32_16x16x64_bf16 v[20:23], v[92:95], v[240:247], v9
    ds_read_b128 v[108:111], v1 offset:19456
    v_permlane32_swap_b32 v33, v34
    v_max_f32 v33, v33, v34
    v_mul_f32 v33, s50, v33
    v_fma_f32 v28, v28, s50, -v33
    v_fma_f32 v29, v29, s50, -v33
    v_fma_f32 v30, v30, s50, -v33
    v_fma_f32 v31, v31, s50, -v33
    v_fma_f32 v32, v32, s50, -v33
    v_smfmac_f32_16x16x64_bf16 v[24:27], v[92:95], v[248:255], v9
    v_exp_f32 v28, v28
    v_exp_f32 v29, v29
    v_exp_f32 v30, v30
    v_exp_f32 v31, v31
    v_exp_f32 v32, v32
    v_cvt_pk_bf16_f32 v52, v28, v29
    v_cvt_pk_bf16_f32 v53, v30, v31
    v_cvt_pk_bf16_f32 v34, v32, v32
    v_cndmask_b32_dpp v50, v52, v52, vcc row_ror:8 row_mask:0xf bank_mask:0xf
    v_cndmask_b32_dpp v51, v53, v53, vcc row_ror:8 row_mask:0xf bank_mask:0xf
    v_cndmask_b32_dpp v55, v34, v34, vcc row_ror:8 row_mask:0xf bank_mask:0xf
    s_not_b64 vcc, vcc
    v_cndmask_b32_dpp v48, v52, v52, vcc row_ror:8 row_mask:0xf bank_mask:0xf
    v_cndmask_b32_dpp v49, v53, v53, vcc row_ror:8 row_mask:0xf bank_mask:0xf
    v_cndmask_b32_dpp v54, v34, v34, vcc row_ror:8 row_mask:0xf bank_mask:0xf
    v_cvt_pk_bf16_f32 v56, v20, v21
    v_mfma_f32_16x16x32_bf16 v[60:63], v[12:15], v[48:51], 0
    ds_read_b128 v[64:67], v1 offset:32768
    v_cvt_pk_bf16_f32 v57, v22, v23
    v_cvt_pk_bf16_f32 v58, v24, v25
    v_mfma_f32_16x16x32_bf16 v[36:39], v[16:19], v[48:51], 0
    ds_read_b128 v[68:71], v1 offset:33792
    v_cvt_pk_bf16_f32 v59, v26, v27
    v_add_f32 v33, v28, v29
    v_mfma_f32_16x16x16_bf16 v[60:63], v[56:57], v[54:55], v[60:63]
    ds_read_b128 v[72:75], v1 offset:34816
    v_add_f32 v34, v30, v31
    v_add_f32 v33, v33, v32
    v_mfma_f32_16x16x16_bf16 v[36:39], v[58:59], v[54:55], v[36:39]
    ds_read_b128 v[76:79], v1 offset:35840
    v_add_f32 v33, v33, v34
    s_nop 1
    v_add_f32_dpp v33, v33, v33 row_ror:8 row_mask:0xf bank_mask:0xf
    v_mov_b32 v34, v33
    s_nop 1
    v_permlane16_swap_b32 v33, v34
    v_add_f32 v33, v33, v34
    v_mov_b32 v34, v33
    v_cndmask_b32 v28, v36, v60, vcc
    v_cndmask_b32 v29, v37, v61, vcc
    v_permlane32_swap_b32 v33, v34
    v_add_f32 v33, v33, v34
    v_rcp_f32 v33, v33
    v_cndmask_b32 v30, v38, v62, vcc
    v_cndmask_b32 v31, v39, v63, vcc
    v_mul_f32 v28, v28, v33
    v_mul_f32 v29, v29, v33
    v_mul_f32 v30, v30, v33
    v_mul_f32 v31, v31, v33
    v_cvt_pk_bf16_f32 v36, v28, v29
    v_cvt_pk_bf16_f32 v37, v30, v31
    ds_write_b64 v6, v[36:37]
    v_mfma_f32_32x32x8_bf16 v[48:63], v[10:11], v[10:11], 0
    s_waitcnt lgkmcnt(0)
    s_barrier
    ds_read_b128 v[40:43], v7 offset:0
    ds_read_b128 v[44:47], v7 offset:64
    ds_read_b128 v[28:31], v7 offset:128
    ds_read_b128 v[32:35], v7 offset:192
    v_add_f32 v20, v20, v21
    v_add_f32 v22, v22, v23
    v_add_f32 v24, v24, v25
    v_add_f32 v26, v26, v27
    v_cvt_pk_bf16_f32 v38, v20, v22
    v_cvt_pk_bf16_f32 v39, v24, v26
    s_waitcnt lgkmcnt(3)
    v_smfmac_f32_16x16x64_bf16 v[48:51], v[40:43], v[112:119], v9
    ds_read_b128 v[80:83], v1 offset:49152
    s_waitcnt lgkmcnt(3)
    v_smfmac_f32_16x16x64_bf16 v[48:51], v[44:47], v[120:127], v9
    ds_read_b128 v[84:87], v1 offset:50176
    s_waitcnt lgkmcnt(3)
    v_smfmac_f32_16x16x64_bf16 v[48:51], v[28:31], v[96:103], v9
    ds_read_b128 v[88:91], v1 offset:51200
    s_waitcnt lgkmcnt(3)
    v_smfmac_f32_16x16x64_bf16 v[48:51], v[32:35], v[104:111], v9
    ds_read_b128 v[92:95], v1 offset:52224
    v_smfmac_f32_16x16x64_bf16 v[52:55], v[40:43], v[64:71], v9
    v_smfmac_f32_16x16x64_bf16 v[52:55], v[44:47], v[72:79], v9
    s_nop 0
    v_cvt_pk_bf16_f32 v20, v48, v49
    s_waitcnt lgkmcnt(2)
    v_smfmac_f32_16x16x64_bf16 v[52:55], v[28:31], v[80:87], v9
    v_cvt_pk_bf16_f32 v21, v50, v51
    v_and_or_b32 v20, v20, -2, s66
    s_waitcnt lgkmcnt(0)
    v_smfmac_f32_16x16x64_bf16 v[52:55], v[32:35], v[88:95], v9
    global_store_dwordx2 v8, v[20:21], s[26:27]
    v_smfmac_f32_16x16x64_bf16 v[56:59], v[40:43], a[192:199], v9
    v_smfmac_f32_16x16x64_bf16 v[56:59], v[44:47], a[200:207], v9
    s_nop 0
    v_cvt_pk_bf16_f32 v22, v52, v53
    v_smfmac_f32_16x16x64_bf16 v[56:59], v[28:31], a[208:215], v9
    v_cvt_pk_bf16_f32 v23, v54, v55
    v_and_or_b32 v22, v22, -2, s66
    v_smfmac_f32_16x16x64_bf16 v[56:59], v[32:35], a[216:223], v9
    global_store_dwordx2 v8, v[22:23], s[28:29]
    v_smfmac_f32_16x16x64_bf16 v[60:63], v[40:43], a[224:231], v9
    v_smfmac_f32_16x16x64_bf16 v[60:63], v[44:47], a[232:239], v9
    s_nop 0
    v_cvt_pk_bf16_f32 v24, v56, v57
    v_smfmac_f32_16x16x64_bf16 v[60:63], v[28:31], a[240:247], v9
    v_cvt_pk_bf16_f32 v25, v58, v59
    v_and_or_b32 v24, v24, -2, s66
    v_smfmac_f32_16x16x64_bf16 v[60:63], v[32:35], a[248:255], v9
    global_store_dwordx2 v8, v[24:25], s[60:61]
    v_lshrrev_b32 v65, 9, v0
    v_and_b32 v66, 0xf0, v0
    v_lshrrev_b32 v67, 2, v0
    s_nop 3
    s_nop 0
    v_cvt_pk_bf16_f32 v26, v60, v61
    v_cvt_pk_bf16_f32 v27, v62, v63
    v_and_or_b32 v26, v26, -2, s66
    global_store_dwordx2 v8, v[26:27], s[62:63]
    v_lshlrev_b32 v66, 1, v66
    v_add_u32 v66, 143616, v66
    v_add_u32 v67, 143616, v67
    ds_read_b128 v[84:87], v66
    ds_read_b32 v88, v66 offset:16
    ds_read_b32 v89, v67 offset:512
    v_mul_u32_u24 v65, 272, v65
    v_bfe_u32 v90, v0, 1, 8
    v_add3_u32 v65, v65, v90, s98
    ds_read_b64 v[90:91], v65
    v_add_u32 v64, 146432, v0
    v_add_u32 v65, s68, v0
    s_add_u32 s42, s42, 65536
    s_addc_u32 s43, s43, 0
    s_add_u32 s24, s24, 1
    s_add_u32 s44, s44, 65536
    s_addc_u32 s45, s45, 0
    s_and_b32 s51, s24, 3
    s_lshl_b32 s51, s51, 13
    s_add_u32 s51, s51, s56
    s_add_u32 s51, s51, 1048576
    s_add_u32 s32, s16, s51
    s_addc_u32 s33, s17, 0
    s_mov_b32 s25, 0
    v_mov_b32 v28, 0
    v_mov_b32 v29, 0
    v_mov_b32 v30, 0
    v_mov_b32 v31, 0
    v_mov_b32 v33, -1
    s_waitcnt vmcnt(0)
    global_load_dwordx4 v[68:71], v0, s[30:31] sc1
    global_load_dwordx4 v[72:75], v0, s[30:31] offset:1024 sc1
    s_barrier
    v_mov_b32 v92, s99
    ds_read_b128 v[92:95], v92
    ds_read_b128 v[96:99], v64 offset:0
    ds_read_b128 v[100:103], v64 offset:1024
    ds_read_b128 v[104:107], v64 offset:2048
    ds_read_b128 v[108:111], v64 offset:3072
    ds_read_b128 v[112:115], v64 offset:4096
    ds_read_b128 v[116:119], v64 offset:5120
    ds_read_b128 v[120:123], v64 offset:6144
    ds_read_b128 v[124:127], v64 offset:7168
    ds_read_b128 v[12:15], v65 offset:23552
    ds_read_b128 v[16:19], v65 offset:24576
    s_waitcnt vmcnt(0) lgkmcnt(10)
    v_bitop3_b32 v32, v68, v72, s66 bitop3:0x7e
    v_bitop3_b32 v34, v70, v74, s66 bitop3:0x7e
    v_smfmac_f32_16x16x64_bf16 v[28:31], v[84:87], v[68:75], v88
    v_bitop3_b32 v32, v32, v34, 1 bitop3:0xa8
    v_cmp_ne_u32 vcc, 0, v32
    s_cbranch_vccnz P1R_fast
P1OK_fast:
    s_nop 4
    v_add_f32_dpp v28, v28, v28 row_ror:4 row_mask:0xf bank_mask:0xf
    v_add_f32_dpp v29, v29, v29 row_ror:4 row_mask:0xf bank_mask:0xf
    s_nop 0
    v_add_f32_dpp v28, v28, v28 row_ror:8 row_mask:0xf bank_mask:0xf
    v_add_f32_dpp v29, v29, v29 row_ror:8 row_mask:0xf bank_mask:0xf
    s_mov_b64 exec, s[48:49]
    v_cvt_pk_bf16_f32 v28, v28, v29
    v_min_u32 v28, -2, v28
    global_store_dword v89, v28, s[34:35]
    global_store_dword v89, v33, s[36:37]
    s_mov_b64 exec, -1
    s_branch STEP_fast
LAST_fast:
    v_smfmac_f32_16x16x64_bf16 v[24:27], v[76:79], v[184:191], v9
    v_smfmac_f32_16x16x64_bf16 v[20:23], v[80:83], v[192:199], v9
    v_smfmac_f32_16x16x64_bf16 v[24:27], v[80:83], v[200:207], v9
    v_smfmac_f32_16x16x64_bf16 v[20:23], v[84:87], v[208:215], v9
    v_smfmac_f32_16x16x64_bf16 v[24:27], v[84:87], v[216:223], v9
    v_smfmac_f32_16x16x64_bf16 v[20:23], v[88:91], v[224:231], v9
    v_smfmac_f32_16x16x64_bf16 v[24:27], v[88:91], v[232:239], v9
    v_smfmac_f32_16x16x64_bf16 v[20:23], v[92:95], v[240:247], v9
    v_smfmac_f32_16x16x64_bf16 v[24:27], v[92:95], v[248:255], v9
    s_nop 7
    v_add_f32 v20, v20, v21
    v_add_f32 v22, v22, v23
    v_add_f32 v24, v24, v25
    v_add_f32 v26, v26, v27
    v_cvt_pk_bf16_f32 v38, v20, v22
    v_cvt_pk_bf16_f32 v39, v24, v26
    s_branch CH_DONE
KVP_fast:
    s_mov_b32 s25, 0
KVP2_fast:
    global_load_dwordx4 v[84:87], v10, s[18:19] sc1
    s_add_u32 s25, s25, 1
    s_cmp_gt_u32 s25, 200000
    s_cbranch_scc1 CH_ABORT
    s_waitcnt vmcnt(0)
    v_min_u32 v84, v84, v86
    s_nop 0
    v_readfirstlane_b32 s55, v84
    s_nop 1
    s_cmp_ge_u32 s55, 64
    s_cselect_b32 s55, 100, s55
    s_cmp_lt_u32 s55, s51
    s_cbranch_scc1 KVP2_fast
    s_branch KVOK_fast
P1R_fast:
    s_mov_b64 exec, vcc
    global_load_dwordx4 v[68:71], v0, s[30:31] sc1
    global_load_dwordx4 v[72:75], v0, s[30:31] offset:1024 sc1
    s_mov_b64 exec, -1
    s_add_u32 s25, s25, 1
    s_add_u32 s101, s101, 1
    s_cmp_gt_u32 s25, 200000
    s_cbranch_scc1 CH_ABORT
    v_mov_b32 v28, 0
    v_mov_b32 v29, 0
    v_mov_b32 v30, 0
    v_mov_b32 v31, 0
    s_waitcnt vmcnt(0)
    v_bitop3_b32 v32, v68, v72, s66 bitop3:0x7e
    v_bitop3_b32 v34, v70, v74, s66 bitop3:0x7e
    v_smfmac_f32_16x16x64_bf16 v[28:31], v[84:87], v[68:75], v88
    v_bitop3_b32 v32, v32, v34, 1 bitop3:0xa8
    v_cmp_ne_u32 vcc, 0, v32
    s_cbranch_vccnz P1R_fast
    s_branch P1OK_fast
ENTRY_slow:
    s_branch STEP_slow
.p2align 6
STEP_slow:
KVC_slow:
    v_min_u32 v92, v92, v94
    s_nop 0
    v_readfirstlane_b32 s55, v92
    s_nop 1
    s_cmp_ge_u32 s55, 64
    s_cselect_b32 s55, 100, s55
    s_add_u32 s51, s24, 2
    s_cmp_lt_u32 s55, s51
    s_cbranch_scc1 KVP_slow
KVOK_slow:
    s_mov_b32 s25, 0
    ds_read_b128 v[28:31], v2 offset:0
    ds_read_b128 v[32:35], v2 offset:1024
    ds_read_b128 v[40:43], v2 offset:2048
    ds_read_b128 v[44:47], v2 offset:3072
    v_mfma_f32_32x32x8_bf16 v[48:63], v[10:11], v[10:11], 0
    v_lshrrev_b32 v36, 1, v0
    v_min_u32 v38, -2, v38
    v_min_u32 v39, -2, v39
    v_min_u32 v90, -2, v90
    v_min_u32 v91, -2, v91
    s_sub_u32 s51, s24, 1
    s_max_i32 s51, s51, 0
    v_mov_b32 v37, s51
    v_mov_b32 v20, 0
    v_mov_b32 v21, 0
    v_mov_b32 v22, 0
    global_load_dwordx4 v[64:67], v0, s[32:33] offset:0 sc1
    global_load_dwordx4 v[68:71], v0, s[32:33] offset:1024 sc1
    v_mov_b32 v23, 0
    v_mov_b32 v24, 0
    v_mov_b32 v25, 0
    v_mov_b32 v26, 0
    v_mov_b32 v27, 0
    v_add_u32 v92, s68, v0
    v_add_u32 v93, s69, v0
    v_add_u32 v94, s70, v0
    v_add_u32 v95, s71, v0
    s_lshl_b32 s53, s23, 6
    s_add_u32 s53, s53, 1048576
    s_add_u32 s51, s24, 1
    s_and_b32 s51, s51, 3
    s_lshl_b32 s51, s51, 13
    s_add_u32 s51, s51, s53
    s_add_u32 s34, s16, s51
    s_addc_u32 s35, s17, 0
    s_add_u32 s51, s24, 3
    s_and_b32 s51, s51, 3
    s_lshl_b32 s51, s51, 13
    s_add_u32 s51, s51, s53
    s_add_u32 s36, s16, s51
    s_addc_u32 s37, s17, 0
    s_and_b32 s51, s24, 1
    s_mul_i32 s51, s51, 278528
    s_lshl_b32 s52, s21, 6
    s_add_u32 s52, s52, s51
    s_add_u32 s26, s16, s52
    s_addc_u32 s27, s17, 0
    s_add_u32 s28, s26, 8704
    s_addc_u32 s29, s27, 0
    s_add_u32 s60, s26, 17408
    s_addc_u32 s61, s27, 0
    s_add_u32 s62, s26, 26112
    s_addc_u32 s63, s27, 0
    s_mul_i32 s52, s23, 2176
    global_load_dwordx4 v[64:67], v0, s[32:33] offset:0 sc1
    global_load_dwordx4 v[68:71], v0, s[32:33] offset:1024 sc1
    s_add_u32 s53, s52, s51
    s_add_u32 s30, s16, s53
    s_addc_u32 s31, s17, 0
    s_lshr_b32 s66, s24, 1
    s_and_b32 s66, s66, 1
    s_xor_b32 s66, s66, 1
    s_add_u32 s51, s56, 146432
    s_mov_b32 m0, s51
    s_add_u32 s38, s38, 262144
    s_addc_u32 s39, s39, 0
    s_add_u32 s40, s40, 262144
    s_addc_u32 s41, s41, 0
    s_nop 0
    s_branch P2W_slow
P2R_slow:
    s_mov_b64 exec, vcc
    global_load_dwordx4 v[64:67], v0, s[32:33] offset:0 sc1
    global_load_dwordx4 v[68:71], v0, s[32:33] offset:1024 sc1
    s_mov_b64 exec, -1
    s_add_u32 s25, s25, 1
    s_add_u32 s100, s100, 1
    s_cmp_gt_u32 s25, 200000
    s_cbranch_scc1 CH_ABORT
    s_nop 7
P2W_slow:
    s_waitcnt vmcnt(2)
P2C_slow:
    v_max3_u32 v80, v64, v65, v66
    v_max3_u32 v81, v67, v68, v69
    v_max3_u32 v80, v80, v70, v71
    v_max_u32 v80, v80, v81
    v_cmp_eq_u32 vcc, -1, v80
    s_cbranch_vccnz P2R_slow
P2OK_slow:
    v_smfmac_f32_16x16x64_bf16 v[48:51], v[64:67], a[0:7], v9
    ds_write_b128 v92, v[64:67]
    ds_write_b128 v92, v[68:71] offset:1024
    v_smfmac_f32_16x16x64_bf16 v[52:55], v[64:67], a[8:15], v9
    global_store_dwordx2 v36, v[90:91], s[42:43] sc1
    v_smfmac_f32_16x16x64_bf16 v[48:51], v[68:71], a[16:23], v9
    s_waitcnt lgkmcnt(4)
    v_smfmac_f32_16x16x64_bf16 v[52:55], v[68:71], v[28:35], v9
    ds_read_b128 v[28:31], v2 offset:16384
    ds_read_b128 v[32:35], v2 offset:17408
    v_smfmac_f32_16x16x64_bf16 v[20:23], v[64:67], v[128:135], v9
    v_smfmac_f32_16x16x64_bf16 v[24:27], v[64:67], v[136:143], v9
    v_smfmac_f32_16x16x64_bf16 v[20:23], v[68:71], v[144:151], v9
    v_smfmac_f32_16x16x64_bf16 v[24:27], v[68:71], v[152:159], v9
    s_waitcnt lgkmcnt(2)
    s_barrier
    ds_read_b128 v[72:75], v93 offset:0
    v_smfmac_f32_16x16x64_bf16 v[56:59], v[64:67], a[96:103], v9
    ds_read_b128 v[76:79], v93 offset:1024
    v_smfmac_f32_16x16x64_bf16 v[60:63], v[64:67], v[40:47], v9
    ds_read_b128 v[40:43], v2 offset:18432
    global_load_lds_dwordx4 v0, s[38:39] offset:0 sc1
    v_smfmac_f32_16x16x64_bf16 v[56:59], v[68:71], a[104:111], v9
    ds_read_b128 v[44:47], v2 offset:19456
    s_waitcnt lgkmcnt(4)
    v_smfmac_f32_16x16x64_bf16 v[60:63], v[68:71], v[28:35], v9
    ds_read_b128 v[80:83], v94 offset:0
    s_waitcnt lgkmcnt(4)
    v_smfmac_f32_16x16x64_bf16 v[48:51], v[72:75], a[24:31], v9
    ds_read_b128 v[84:87], v94 offset:1024
    global_load_lds_dwordx4 v0, s[38:39] offset:1024 sc1
    s_add_u32 s51, m0, 8192
    s_mov_b32 m0, s51
    v_smfmac_f32_16x16x64_bf16 v[52:55], v[72:75], a[32:39], v9
    ds_read_b128 v[28:31], v2 offset:32768
    s_waitcnt lgkmcnt(5)
    v_smfmac_f32_16x16x64_bf16 v[48:51], v[76:79], a[40:47], v9
    ds_read_b128 v[32:35], v2 offset:33792
    s_waitcnt lgkmcnt(4)
    v_smfmac_f32_16x16x64_bf16 v[52:55], v[76:79], v[40:47], v9
    ds_read_b128 v[88:91], v95 offset:0
    global_load_lds_dwordx4 v0, s[40:41] offset:0 sc1
    s_waitcnt lgkmcnt(4)
    v_smfmac_f32_16x16x64_bf16 v[48:51], v[80:83], a[48:55], v9
    ds_read_b128 v[92:95], v95 offset:1024
    v_smfmac_f32_16x16x64_bf16 v[52:55], v[80:83], a[56:63], v9
    ds_read_b128 v[40:43], v2 offset:34816
    s_waitcnt lgkmcnt(5)
    v_smfmac_f32_16x16x64_bf16 v[48:51], v[84:87], a[64:71], v9
    ds_read_b128 v[44:47], v2 offset:35840
    global_load_lds_dwordx4 v0, s[40:41] offset:1024 sc1
    s_waitcnt lgkmcnt(4)
    v_smfmac_f32_16x16x64_bf16 v[52:55], v[84:87], v[28:35], v9
    s_waitcnt lgkmcnt(3)
    v_smfmac_f32_16x16x64_bf16 v[48:51], v[88:91], a[72:79], v9
    ds_read_b128 v[28:31], v2 offset:49152
    global_store_dwordx2 v36, v[38:39], s[44:45] sc1
    v_smfmac_f32_16x16x64_bf16 v[52:55], v[88:91], a[80:87], v9
    ds_read_b128 v[32:35], v2 offset:50176
    s_waitcnt lgkmcnt(4)
    v_smfmac_f32_16x16x64_bf16 v[48:51], v[92:95], a[88:95], v9
    s_mov_b64 exec, 1
    global_store_dword v10, v37, s[0:1] sc1
    s_mov_b64 exec, -1
    s_waitcnt lgkmcnt(2)
    v_smfmac_f32_16x16x64_bf16 v[52:55], v[92:95], v[40:47], v9
    ds_read_b128 v[40:43], v2 offset:51200
    s_mov_b32 m0, s99
    s_mov_b64 exec, 1
    global_load_lds_dwordx4 v10, s[18:19] sc1
    s_mov_b64 exec, -1
    v_smfmac_f32_16x16x64_bf16 v[56:59], v[80:83], a[128:135], v9
    ds_read_b128 v[44:47], v2 offset:52224
    v_smfmac_f32_16x16x64_bf16 v[60:63], v[80:83], a[136:143], v9
    v_add_f32 v48, v48, v49
    v_add_f32 v50, v50, v51
    v_smfmac_f32_16x16x64_bf16 v[56:59], v[72:75], a[112:119], v9
    v_add_f32 v52, v52, v53
    v_cvt_pk_bf16_f32 v36, v48, v52
    s_waitcnt lgkmcnt(2)
    v_smfmac_f32_16x16x64_bf16 v[60:63], v[72:75], v[28:35], v9
    ds_write_b32 v3, v36 offset:0
    v_add_f32 v54, v54, v55
    v_cvt_pk_bf16_f32 v37, v50, v54
    v_smfmac_f32_16x16x64_bf16 v[56:59], v[84:87], a[144:151], v9
    ds_write_b32 v3, v37 offset:272
    v_smfmac_f32_16x16x64_bf16 v[60:63], v[84:87], a[152:159], v9
    v_smfmac_f32_16x16x64_bf16 v[56:59], v[76:79], a[120:127], v9
    s_waitcnt lgkmcnt(2)
    v_smfmac_f32_16x16x64_bf16 v[60:63], v[76:79], v[40:47], v9
    v_smfmac_f32_16x16x64_bf16 v[56:59], v[88:91], a[160:167], v9
    s_waitcnt vmcnt(8)
    s_waitcnt lgkmcnt(0)
    s_barrier
    ds_read_b128 v[48:51], v4 offset:0
    v_smfmac_f32_16x16x64_bf16 v[60:63], v[88:91], a[168:175], v9
    ds_read_b128 v[52:55], v4 offset:64
    v_smfmac_f32_16x16x64_bf16 v[56:59], v[92:95], a[176:183], v9
    ds_read_b128 v[40:43], v4 offset:128
    v_smfmac_f32_16x16x64_bf16 v[60:63], v[92:95], a[184:191], v9
    ds_read_b128 v[44:47], v4 offset:192
    v_smfmac_f32_16x16x64_bf16 v[20:23], v[72:75], v[160:167], v9
    v_smfmac_f32_16x16x64_bf16 v[24:27], v[72:75], v[168:175], v9
    v_smfmac_f32_16x16x64_bf16 v[20:23], v[76:79], v[176:183], v9
    s_waitcnt lgkmcnt(3)
    v_mfma_f32_16x16x32_bf16 v[28:31], v[96:99], v[48:51], 0
    v_add_f32 v56, v56, v57
    v_add_f32 v60, v60, v61
    v_mfma_f32_16x16x32_bf16 v[32:35], v[112:115], v[48:51], 0
    v_cvt_pk_bf16_f32 v36, v56, v60
    v_add_f32 v58, v58, v59
    s_waitcnt lgkmcnt(2)
    v_mfma_f32_16x16x32_bf16 v[28:31], v[100:103], v[52:55], v[28:31]
    ds_write_b32 v3, v36 offset:2176
    v_add_f32 v62, v62, v63
    v_cvt_pk_bf16_f32 v37, v58, v62
    v_mfma_f32_16x16x32_bf16 v[32:35], v[116:119], v[52:55], v[32:35]
    ds_write_b32 v3, v37 offset:2448
    s_waitcnt lgkmcnt(3)
    v_mfma_f32_16x16x32_bf16 v[28:31], v[104:107], v[40:43], v[28:31]
    v_mfma_f32_16x16x32_bf16 v[32:35], v[120:123], v[40:43], v[32:35]
    s_waitcnt lgkmcnt(2)
    v_mfma_f32_16x16x32_bf16 v[28:31], v[108:111], v[44:47], v[28:31]
    v_mfma_f32_16x16x32_bf16 v[32:35], v[124:127], v[44:47], v[32:35]
    s_mov_b64 vcc, s[46:47]
    s_waitcnt lgkmcnt(0)
    s_barrier
    s_cmp_ge_u32 s24, 63
    s_cbranch_scc1 LAST_slow
    ds_read_b128 v[96:99], v5 offset:0
    v_smfmac_f32_16x16x64_bf16 v[24:27], v[76:79], v[184:191], v9
    ds_read_b128 v[100:103], v5 offset:64
    v_smfmac_f32_16x16x64_bf16 v[20:23], v[80:83], v[192:199], v9
    ds_read_b128 v[104:107], v5 offset:128
    v_smfmac_f32_16x16x64_bf16 v[24:27], v[80:83], v[200:207], v9
    ds_read_b128 v[108:111], v5 offset:192
    v_cndmask_b32 v28, v28, v32, vcc
    v_cndmask_b32 v29, v29, v33, vcc
    v_cndmask_b32 v30, v30, v34, vcc
    v_cndmask_b32 v31, v31, v35, vcc
    s_waitcnt lgkmcnt(3)
    v_mfma_f32_16x16x32_bf16 v[36:39], v[96:99], v[48:51], 0
    ds_read_b128 v[112:115], v1 offset:0
    s_waitcnt lgkmcnt(3)
    v_mfma_f32_16x16x32_bf16 v[36:39], v[100:103], v[52:55], v[36:39]
    ds_read_b128 v[116:119], v1 offset:1024
    s_waitcnt lgkmcnt(3)
    v_mfma_f32_16x16x32_bf16 v[36:39], v[104:107], v[40:43], v[36:39]
    ds_read_b128 v[120:123], v1 offset:2048
    s_waitcnt lgkmcnt(3)
    v_mfma_f32_16x16x32_bf16 v[36:39], v[108:111], v[44:47], v[36:39]
    ds_read_b128 v[124:127], v1 offset:3072
    v_smfmac_f32_16x16x64_bf16 v[20:23], v[84:87], v[208:215], v9
    ds_read_b128 v[96:99], v1 offset:16384
    v_smfmac_f32_16x16x64_bf16 v[24:27], v[84:87], v[216:223], v9
    s_nop 0
    v_cndmask_b32 v32, v36, v37, vcc
    v_max3_f32 v33, v28, v29, v30
    v_max3_f32 v33, v33, v31, v32
    v_smfmac_f32_16x16x64_bf16 v[20:23], v[88:91], v[224:231], v9
    ds_read_b128 v[100:103], v1 offset:17408
    v_max_f32_dpp v33, v33, v33 row_ror:8 row_mask:0xf bank_mask:0xf
    v_mov_b32 v34, v33
    v_smfmac_f32_16x16x64_bf16 v[24:27], v[88:91], v[232:239], v9
    ds_read_b128 v[104:107], v1 offset:18432
    v_permlane16_swap_b32 v33, v34
    v_max_f32 v33, v33, v34
    v_mov_b32 v34, v33
    v_smfmac_f32_16x16x64_bf16 v[20:23], v[92:95], v[240:247], v9
    ds_read_b128 v[108:111], v1 offset:19456
    v_permlane32_swap_b32 v33, v34
    v_max_f32 v33, v33, v34
    v_mul_f32 v33, s50, v33
    v_fma_f32 v28, v28, s50, -v33
    v_fma_f32 v29, v29, s50, -v33
    v_fma_f32 v30, v30, s50, -v33
    v_fma_f32 v31, v31, s50, -v33
    v_fma_f32 v32, v32, s50, -v33
    v_smfmac_f32_16x16x64_bf16 v[24:27], v[92:95], v[248:255], v9
    v_exp_f32 v28, v28
    v_exp_f32 v29, v29
    v_exp_f32 v30, v30
    v_exp_f32 v31, v31
    v_exp_f32 v32, v32
    v_cvt_pk_bf16_f32 v52, v28, v29
    v_cvt_pk_bf16_f32 v53, v30, v31
    v_cvt_pk_bf16_f32 v34, v32, v32
    v_cndmask_b32_dpp v50, v52, v52, vcc row_ror:8 row_mask:0xf bank_mask:0xf
    v_cndmask_b32_dpp v51, v53, v53, vcc row_ror:8 row_mask:0xf bank_mask:0xf
    v_cndmask_b32_dpp v55, v34, v34, vcc row_ror:8 row_mask:0xf bank_mask:0xf
    s_not_b64 vcc, vcc
    v_cndmask_b32_dpp v48, v52, v52, vcc row_ror:8 row_mask:0xf bank_mask:0xf
    v_cndmask_b32_dpp v49, v53, v53, vcc row_ror:8 row_mask:0xf bank_mask:0xf
    v_cndmask_b32_dpp v54, v34, v34, vcc row_ror:8 row_mask:0xf bank_mask:0xf
    v_cvt_pk_bf16_f32 v56, v20, v21
    v_mfma_f32_16x16x32_bf16 v[60:63], v[12:15], v[48:51], 0
    ds_read_b128 v[64:67], v1 offset:32768
    v_cvt_pk_bf16_f32 v57, v22, v23
    v_cvt_pk_bf16_f32 v58, v24, v25
    v_mfma_f32_16x16x32_bf16 v[36:39], v[16:19], v[48:51], 0
    ds_read_b128 v[68:71], v1 offset:33792
    v_cvt_pk_bf16_f32 v59, v26, v27
    v_add_f32 v33, v28, v29
    v_mfma_f32_16x16x16_bf16 v[60:63], v[56:57], v[54:55], v[60:63]
    ds_read_b128 v[72:75], v1 offset:34816
    v_add_f32 v34, v30, v31
    v_add_f32 v33, v33, v32
    v_mfma_f32_16x16x16_bf16 v[36:39], v[58:59], v[54:55], v[36:39]
    ds_read_b128 v[76:79], v1 offset:35840
    v_add_f32 v33, v33, v34
    s_nop 1
    v_add_f32_dpp v33, v33, v33 row_ror:8 row_mask:0xf bank_mask:0xf
    v_mov_b32 v34, v33
    s_nop 1
    v_permlane16_swap_b32 v33, v34
    v_add_f32 v33, v33, v34
    v_mov_b32 v34, v33
    v_cndmask_b32 v28, v36, v60, vcc
    v_cndmask_b32 v29, v37, v61, vcc
    v_permlane32_swap_b32 v33, v34
    v_add_f32 v33, v33, v34
    v_rcp_f32 v33, v33
    v_cndmask_b32 v30, v38, v62, vcc
    v_cndmask_b32 v31, v39, v63, vcc
    v_mul_f32 v28, v28, v33
    v_mul_f32 v29, v29, v33
    v_mul_f32 v30, v30, v33
    v_mul_f32 v31, v31, v33
    v_cvt_pk_bf16_f32 v36, v28, v29
    v_cvt_pk_bf16_f32 v37, v30, v31
    ds_write_b64 v6, v[36:37]
    v_mfma_f32_32x32x8_bf16 v[48:63], v[10:11], v[10:11], 0
    s_waitcnt lgkmcnt(0)
    s_barrier
    ds_read_b128 v[40:43], v7 offset:0
    ds_read_b128 v[44:47], v7 offset:64
    ds_read_b128 v[28:31], v7 offset:128
    ds_read_b128 v[32:35], v7 offset:192
    v_add_f32 v20, v20, v21
    v_add_f32 v22, v22, v23
    v_add_f32 v24, v24, v25
    v_add_f32 v26, v26, v27
    v_cvt_pk_bf16_f32 v38, v20, v22
    v_cvt_pk_bf16_f32 v39, v24, v26
    s_waitcnt lgkmcnt(3)
    v_smfmac_f32_16x16x64_bf16 v[48:51], v[40:43], v[112:119], v9
    ds_read_b128 v[80:83], v1 offset:49152
    s_waitcnt lgkmcnt(3)
    v_smfmac_f32_16x16x64_bf16 v[48:51], v[44:47], v[120:127], v9
    ds_read_b128 v[84:87], v1 offset:50176
    s_waitcnt lgkmcnt(3)
    v_smfmac_f32_16x16x64_bf16 v[48:51], v[28:31], v[96:103], v9
    ds_read_b128 v[88:91], v1 offset:51200
    s_waitcnt lgkmcnt(3)
    v_smfmac_f32_16x16x64_bf16 v[48:51], v[32:35], v[104:111], v9
    ds_read_b128 v[92:95], v1 offset:52224
    v_smfmac_f32_16x16x64_bf16 v[52:55], v[40:43], v[64:71], v9
    v_smfmac_f32_16x16x64_bf16 v[52:55], v[44:47], v[72:79], v9
    s_nop 0
    v_cvt_pk_bf16_f32 v20, v48, v49
    s_waitcnt lgkmcnt(2)
    v_smfmac_f32_16x16x64_bf16 v[52:55], v[28:31], v[80:87], v9
    v_cvt_pk_bf16_f32 v21, v50, v51
    v_and_or_b32 v20, v20, -2, s66
    s_waitcnt lgkmcnt(0)
    v_smfmac_f32_16x16x64_bf16 v[52:55], v[32:35], v[88:95], v9
    global_store_dwordx2 v8, v[20:21], s[26:27] sc1
    v_smfmac_f32_16x16x64_bf16 v[56:59], v[40:43], a[192:199], v9
    v_smfmac_f32_16x16x64_bf16 v[56:59], v[44:47], a[200:207], v9
    s_nop 0
    v_cvt_pk_bf16_f32 v22, v52, v53
    v_smfmac_f32_16x16x64_bf16 v[56:59], v[28:31], a[208:215], v9
    v_cvt_pk_bf16_f32 v23, v54, v55
    v_and_or_b32 v22, v22, -2, s66
    v_smfmac_f32_16x16x64_bf16 v[56:59], v[32:35], a[216:223], v9
    global_store_dwordx2 v8, v[22:23], s[28:29] sc1
    v_smfmac_f32_16x16x64_bf16 v[60:63], v[40:43], a[224:231], v9
    v_smfmac_f32_16x16x64_bf16 v[60:63], v[44:47], a[232:239], v9
    s_nop 0
    v_cvt_pk_bf16_f32 v24, v56, v57
    v_smfmac_f32_16x16x64_bf16 v[60:63], v[28:31], a[240:247], v9
    v_cvt_pk_bf16_f32 v25, v58, v59
    v_and_or_b32 v24, v24, -2, s66
    v_smfmac_f32_16x16x64_bf16 v[60:63], v[32:35], a[248:255], v9
    global_store_dwordx2 v8, v[24:25], s[60:61] sc1
    v_lshrrev_b32 v65, 9, v0
    v_and_b32 v66, 0xf0, v0
    v_lshrrev_b32 v67, 2, v0
    s_nop 3
    s_nop 0
    v_cvt_pk_bf16_f32 v26, v60, v61
    v_cvt_pk_bf16_f32 v27, v62, v63
    v_and_or_b32 v26, v26, -2, s66
    global_store_dwordx2 v8, v[26:27], s[62:63] sc1
    v_lshlrev_b32 v66, 1, v66
    v_add_u32 v66, 143616, v66
    v_add_u32 v67, 143616, v67
    ds_read_b128 v[84:87], v66
    ds_read_b32 v88, v66 offset:16
    ds_read_b32 v89, v67 offset:512
    v_mul_u32_u24 v65, 272, v65
    v_bfe_u32 v90, v0, 1, 8
    v_add3_u32 v65, v65, v90, s98
    ds_read_b64 v[90:91], v65
    v_add_u32 v64, 146432, v0
    v_add_u32 v65, s68, v0
    s_add_u32 s42, s42, 65536
    s_addc_u32 s43, s43, 0
    s_add_u32 s24, s24, 1
    s_add_u32 s44, s44, 65536
    s_addc_u32 s45, s45, 0
    s_and_b32 s51, s24, 3
    s_lshl_b32 s51, s51, 13
    s_add_u32 s51, s51, s56
    s_add_u32 s51, s51, 1048576
    s_add_u32 s32, s16, s51
    s_addc_u32 s33, s17, 0
    s_mov_b32 s25, 0
    v_mov_b32 v28, 0
    v_mov_b32 v29, 0
    v_mov_b32 v30, 0
    v_mov_b32 v31, 0
    v_mov_b32 v33, -1
    s_waitcnt vmcnt(0)
    global_load_dwordx4 v[68:71], v0, s[30:31] sc1
    global_load_dwordx4 v[72:75], v0, s[30:31] offset:1024 sc1
    s_barrier
    v_mov_b32 v92, s99
    ds_read_b128 v[92:95], v92
    ds_read_b128 v[96:99], v64 offset:0
    ds_read_b128 v[100:103], v64 offset:1024
    ds_read_b128 v[104:107], v64 offset:2048
    ds_read_b128 v[108:111], v64 offset:3072
    ds_read_b128 v[112:115], v64 offset:4096
    ds_read_b128 v[116:119], v64 offset:5120
    ds_read_b128 v[120:123], v64 offset:6144
    ds_read_b128 v[124:127], v64 offset:7168
    ds_read_b128 v[12:15], v65 offset:23552
    ds_read_b128 v[16:19], v65 offset:24576
    s_waitcnt vmcnt(0) lgkmcnt(10)
    v_bitop3_b32 v32, v68, v72, s66 bitop3:0x7e
    v_bitop3_b32 v34, v70, v74, s66 bitop3:0x7e
    v_smfmac_f32_16x16x64_bf16 v[28:31], v[84:87], v[68:75], v88
    v_bitop3_b32 v32, v32, v34, 1 bitop3:0xa8
    v_cmp_ne_u32 vcc, 0, v32
    s_cbranch_vccnz P1R_slow
P1OK_slow:
    s_nop 4
    v_add_f32_dpp v28, v28, v28 row_ror:4 row_mask:0xf bank_mask:0xf
    v_add_f32_dpp v29, v29, v29 row_ror:4 row_mask:0xf bank_mask:0xf
    s_nop 0
    v_add_f32_dpp v28, v28, v28 row_ror:8 row_mask:0xf bank_mask:0xf
    v_add_f32_dpp v29, v29, v29 row_ror:8 row_mask:0xf bank_mask:0xf
    s_mov_b64 exec, s[48:49]
    v_cvt_pk_bf16_f32 v28, v28, v29
    v_min_u32 v28, -2, v28
    global_store_dword v89, v28, s[34:35] sc1
    global_store_dword v89, v33, s[36:37] sc1
    s_mov_b64 exec, -1
    s_branch STEP_slow
LAST_slow:
    v_smfmac_f32_16x16x64_bf16 v[24:27], v[76:79], v[184:191], v9
    v_smfmac_f32_16x16x64_bf16 v[20:23], v[80:83], v[192:199], v9
    v_smfmac_f32_16x16x64_bf16 v[24:27], v[80:83], v[200:207], v9
    v_smfmac_f32_16x16x64_bf16 v[20:23], v[84:87], v[208:215], v9
    v_smfmac_f32_16x16x64_bf16 v[24:27], v[84:87], v[216:223], v9
    v_smfmac_f32_16x16x64_bf16 v[20:23], v[88:91], v[224:231], v9
    v_smfmac_f32_16x16x64_bf16 v[24:27], v[88:91], v[232:239], v9
    v_smfmac_f32_16x16x64_bf16 v[20:23], v[92:95], v[240:247], v9
    v_smfmac_f32_16x16x64_bf16 v[24:27], v[92:95], v[248:255], v9
    s_nop 7
    v_add_f32 v20, v20, v21
    v_add_f32 v22, v22, v23
    v_add_f32 v24, v24, v25
    v_add_f32 v26, v26, v27
    v_cvt_pk_bf16_f32 v38, v20, v22
    v_cvt_pk_bf16_f32 v39, v24, v26
    s_branch CH_DONE
KVP_slow:
    s_mov_b32 s25, 0
KVP2_slow:
    global_load_dwordx4 v[84:87], v10, s[18:19] sc1
    s_add_u32 s25, s25, 1
    s_cmp_gt_u32 s25, 200000
    s_cbranch_scc1 CH_ABORT
    s_waitcnt vmcnt(0)
    v_min_u32 v84, v84, v86
    s_nop 0
    v_readfirstlane_b32 s55, v84
    s_nop 1
    s_cmp_ge_u32 s55, 64
    s_cselect_b32 s55, 100, s55
    s_cmp_lt_u32 s55, s51
    s_cbranch_scc1 KVP2_slow
    s_branch KVOK_slow
P1R_slow:
    s_mov_b64 exec, vcc
    global_load_dwordx4 v[68:71], v0, s[30:31] sc1
    global_load_dwordx4 v[72:75], v0, s[30:31] offset:1024 sc1
    s_mov_b64 exec, -1
    s_add_u32 s25, s25, 1
    s_add_u32 s101, s101, 1
    s_cmp_gt_u32 s25, 200000
    s_cbranch_scc1 CH_ABORT
    v_mov_b32 v28, 0
    v_mov_b32 v29, 0
    v_mov_b32 v30, 0
    v_mov_b32 v31, 0
    s_waitcnt vmcnt(0)
    v_bitop3_b32 v32, v68, v72, s66 bitop3:0x7e
    v_bitop3_b32 v34, v70, v74, s66 bitop3:0x7e
    v_smfmac_f32_16x16x64_bf16 v[28:31], v[84:87], v[68:75], v88
    v_bitop3_b32 v32, v32, v34, 1 bitop3:0xa8
    v_cmp_ne_u32 vcc, 0, v32
    s_cbranch_vccnz P1R_slow
    s_branch P1OK_slow
CH_DONE:
    s_add_u32 s42, s42, 65536
    s_addc_u32 s43, s43, 0
    s_add_u32 s44, s44, 65536
    s_addc_u32 s45, s45, 0
    v_lshrrev_b32 v65, 9, v0
    s_waitcnt lgkmcnt(0)
    v_mul_u32_u24 v65, 272, v65
    v_bfe_u32 v88, v0, 1, 8
    v_add3_u32 v65, v65, v88, s98
    ds_read_b64 v[88:89], v65
    v_lshrrev_b32 v36, 1, v0
    v_mov_b32 v37, 64
    v_min_u32 v38, -2, v38
    v_min_u32 v39, -2, v39
    global_store_dwordx2 v36, v[38:39], s[44:45] sc1
    s_waitcnt lgkmcnt(0)
    v_min_u32 v88, -2, v88
    v_min_u32 v89, -2, v89
    global_store_dwordx2 v36, v[88:89], s[42:43] sc1
    s_waitcnt vmcnt(0)
    s_barrier
    s_cmp_eq_u32 s22, 0
    s_cselect_b64 exec, 1, 0
    global_store_dword v10, v37, s[0:1] sc1
    s_mov_b64 exec, -1
CH_ABORT:
CH_EXIT:
    s_endpgm
.p2align 6
CH_TABLE:
.long 0x0, 0x0, 0x10000, 0x22000, 0x22000, 0x22880, 0x20000, 0x20000, 0x0, 0x4444, 0x0, 0x4c4c, 0x3f80, 0x0, 0x3f80, 0x0, 0x0, 0x0, 0x0, 0x0
.long 0x10, 0x10, 0x10010, 0x22010, 0x22110, 0x22990, 0x20110, 0x20000, 0x8, 0xeeee, 0x8, 0x4d4d, 0x3f80, 0x0, 0x3f80, 0x0, 0x10, 0x10, 0x40, 0x0
.long 0x20, 0x20, 0x10020, 0x22020, 0x22220, 0x22880, 0x20220, 0x20110, 0x10, 0x4444, 0x10, 0x4444, 0x0, 0x0, 0x0, 0x0, 0x20, 0x20, 0x400, 0x0
.long 0x30, 0x30, 0x10030, 0x22030, 0x22330, 0x22990, 0x20330, 0x20110, 0x18, 0xeeee, 0x18, 0x4444, 0x0, 0x0, 0x0, 0x0, 0x30, 0x30, 0x440, 0x0
.long 0x40, 0x40, 0x10040, 0x22040, 0x22440, 0x22aa0, 0x20440, 0x20220, 0x20, 0x4444, 0x0, 0x4e4e, 0x3f80, 0x0, 0x3f80, 0x0, 0x40, 0x40, 0x800, 0x0
.long 0x50, 0x50, 0x10050, 0x22050, 0x22550, 0x22bb0, 0x20550, 0x20220, 0x28, 0xeeee, 0x8, 0x4c4c, 0x3f800000, 0x0, 0x3f800000, 0x0, 0x50, 0x50, 0x840, 0x0
.long 0x60, 0x60, 0x10060, 0x22060, 0x22660, 0x22aa0, 0x20660, 0x20330, 0x30, 0x4444, 0x10, 0x4444, 0x0, 0x0, 0x0, 0x0, 0x60, 0x60, 0xc00, 0x0
.long 0x70, 0x70, 0x10070, 0x22070, 0x22770, 0x22bb0, 0x20770, 0x20330, 0x38, 0xeeee, 0x18, 0x4444, 0x0, 0x0, 0x0, 0x0, 0x70, 0x70, 0xc40, 0x0
.long 0x80, 0x80, 0x10080, 0x22080, 0x22000, 0x22cc0, 0x20020, 0x20440, 0x8800, 0x4444, 0x0, 0xc4c4, 0x0, 0x3f80, 0x0, 0x3f80, 0x80, 0x80, 0x1000, 0x0
.long 0x90, 0x90, 0x10090, 0x22090, 0x22110, 0x22dd0, 0x20130, 0x20440, 0x8808, 0xeeee, 0x8, 0xd4d4, 0x0, 0x3f80, 0x0, 0x3f80, 0x90, 0x90, 0x1040, 0x0
.long 0xa0, 0xa0, 0x100a0, 0x220a0, 0x22220, 0x22cc0, 0x20240, 0x20550, 0x8810, 0x4444, 0x10, 0x4444, 0x0, 0x0, 0x0, 0x0, 0xa0, 0xa0, 0x1400, 0x0
.long 0xb0, 0xb0, 0x100b0, 0x220b0, 0x22330, 0x22dd0, 0x20350, 0x20550, 0x8818, 0xeeee, 0x18, 0x4444, 0x0, 0x0, 0x0, 0x0, 0xb0, 0xb0, 0x1440, 0x0
.long 0xc0, 0xc0, 0x100c0, 0x220c0, 0x22440, 0x22ee0, 0x20460, 0x20660, 0x8820, 0x4444, 0x0, 0xe4e4, 0x0, 0x3f80, 0x0, 0x3f80, 0xc0, 0xc0, 0x1800, 0x0
.long 0xd0, 0xd0, 0x100d0, 0x220d0, 0x22550, 0x22ff0, 0x20570, 0x20660, 0x8828, 0xeeee, 0x8, 0xc4c4, 0x0, 0x3f800000, 0x0, 0x3f800000, 0xd0, 0xd0, 0x1840, 0x0
.long 0xe0, 0xe0, 0x100e0, 0x220e0, 0x22660, 0x22ee0, 0x20680, 0x20770, 0x8830, 0x4444, 0x10, 0x4444, 0x0, 0x0, 0x0, 0x0, 0xe0, 0xe0, 0x1c00, 0x0
.long 0xf0, 0xf0, 0x100f0, 0x220f0, 0x22770, 0x22ff0, 0x20790, 0x20770, 0x8838, 0xeeee, 0x18, 0x4444, 0x0, 0x0, 0x0, 0x0, 0xf0, 0xf0, 0x1c40, 0x0
.long 0x100, 0x100, 0x10100, 0x22220, 0x22010, 0x22890, 0x20008, 0x20010, 0x880, 0x4444, 0x20, 0x4c4c, 0x3f80, 0x0, 0x3f80, 0x0, 0x20000, 0x8000, 0x4, 0x0
.long 0x110, 0x110, 0x10110, 0x22230, 0x22120, 0x229a0, 0x20118, 0x20010, 0x888, 0xeeee, 0x28, 0x4d4d, 0x3f80, 0x0, 0x3f80, 0x0, 0x20010, 0x8010, 0x44, 0x0
.long 0x120, 0x120, 0x10120, 0x22240, 0x22230, 0x22890, 0x20228, 0x20120, 0x890, 0x4444, 0x30, 0x4444, 0x0, 0x0, 0x0, 0x0, 0x20020, 0x8020, 0x404, 0x0
.long 0x130, 0x130, 0x10130, 0x22250, 0x22340, 0x229a0, 0x20338, 0x20120, 0x898, 0xeeee, 0x38, 0x4444, 0x0, 0x0, 0x0, 0x0, 0x20030, 0x8030, 0x444, 0x0
.long 0x140, 0x140, 0x10140, 0x22260, 0x22450, 0x22ab0, 0x20448, 0x20230, 0x8a0, 0x4444, 0x20, 0x4e4e, 0x3f80, 0x0, 0x3f80, 0x0, 0x20040, 0x8040, 0x804, 0x0
.long 0x150, 0x150, 0x10150, 0x22270, 0x22560, 0x22bc0, 0x20558, 0x20230, 0x8a8, 0xeeee, 0x28, 0x4c4c, 0x3f800000, 0x0, 0x3f800000, 0x0, 0x20050, 0x8050, 0x844, 0x0
.long 0x160, 0x160, 0x10160, 0x22280, 0x22670, 0x22ab0, 0x20668, 0x20340, 0x8b0, 0x4444, 0x30, 0x4444, 0x0, 0x0, 0x0, 0x0, 0x20060, 0x8060, 0xc04, 0x0
.long 0x170, 0x170, 0x10170, 0x22290, 0x22780, 0x22bc0, 0x20778, 0x20340, 0x8b8, 0xeeee, 0x38, 0x4444, 0x0, 0x0, 0x0, 0x0, 0x20070, 0x8070, 0xc44, 0x0
.long 0x180, 0x180, 0x10180, 0x222a0, 0x22010, 0x22cd0, 0x20028, 0x20450, 0x9080, 0x4444, 0x20, 0xc4c4, 0x0, 0x3f80, 0x0, 0x3f80, 0x20080, 0x8080, 0x1004, 0x0
.long 0x190, 0x190, 0x10190, 0x222b0, 0x22120, 0x22de0, 0x20138, 0x20450, 0x9088, 0xeeee, 0x28, 0xd4d4, 0x0, 0x3f80, 0x0, 0x3f80, 0x20090, 0x8090, 0x1044, 0x0
.long 0x1a0, 0x1a0, 0x101a0, 0x222c0, 0x22230, 0x22cd0, 0x20248, 0x20560, 0x9090, 0x4444, 0x30, 0x4444, 0x0, 0x0, 0x0, 0x0, 0x200a0, 0x80a0, 0x1404, 0x0
.long 0x1b0, 0x1b0, 0x101b0, 0x222d0, 0x22340, 0x22de0, 0x20358, 0x20560, 0x9098, 0xeeee, 0x38, 0x4444, 0x0, 0x0, 0x0, 0x0, 0x200b0, 0x80b0, 0x1444, 0x0
.long 0x1c0, 0x1c0, 0x101c0, 0x222e0, 0x22450, 0x22ef0, 0x20468, 0x20670, 0x90a0, 0x4444, 0x20, 0xe4e4, 0x0, 0x3f80, 0x0, 0x3f80, 0x200c0, 0x80c0, 0x1804, 0x0
.long 0x1d0, 0x1d0, 0x101d0, 0x222f0, 0x22560, 0x23000, 0x20578, 0x20670, 0x90a8, 0xeeee, 0x28, 0xc4c4, 0x0, 0x3f800000, 0x0, 0x3f800000, 0x200d0, 0x80d0, 0x1844, 0x0
.long 0x1e0, 0x1e0, 0x101e0, 0x22300, 0x22670, 0x22ef0, 0x20688, 0x20780, 0x90b0, 0x4444, 0x30, 0x4444, 0x0, 0x0, 0x0, 0x0, 0x200e0, 0x80e0, 0x1c04, 0x0
.long 0x1f0, 0x1f0, 0x101f0, 0x22310, 0x22780, 0x23000, 0x20798, 0x20780, 0x90b8, 0xeeee, 0x38, 0x4444, 0x0, 0x0, 0x0, 0x0, 0x200f0, 0x80f0, 0x1c44, 0x0
.long 0x200, 0x200, 0x10200, 0x22440, 0x22020, 0x228a0, 0x20010, 0x20020, 0x1100, 0x4444, 0x4, 0x4c4c, 0x3f80, 0x0, 0x3f80, 0x0, 0x4000, 0x10000, 0x8, 0x0
.long 0x210, 0x210, 0x10210, 0x22450, 0x22130, 0x229b0, 0x20120, 0x20020, 0x1108, 0xeeee, 0xc, 0x4d4d, 0x3f80, 0x0, 0x3f80, 0x0, 0x4010, 0x10010, 0x48, 0x0
.long 0x220, 0x220, 0x10220, 0x22460, 0x22240, 0x228a0, 0x20230, 0x20130, 0x1110, 0x4444, 0x14, 0x4444, 0x0, 0x0, 0x0, 0x0, 0x4020, 0x10020, 0x408, 0x0
.long 0x230, 0x230, 0x10230, 0x22470, 0x22350, 0x229b0, 0x20340, 0x20130, 0x1118, 0xeeee, 0x1c, 0x4444, 0x0, 0x0, 0x0, 0x0, 0x4030, 0x10030, 0x448, 0x0
.long 0x240, 0x240, 0x10240, 0x22480, 0x22460, 0x22ac0, 0x20450, 0x20240, 0x1120, 0x4444, 0x4, 0x4e4e, 0x3f80, 0x0, 0x3f80, 0x0, 0x4040, 0x10040, 0x808, 0x0
.long 0x250, 0x250, 0x10250, 0x22490, 0x22570, 0x22bd0, 0x20560, 0x20240, 0x1128, 0xeeee, 0xc, 0x4c4c, 0x3f800000, 0x0, 0x3f800000, 0x0, 0x4050, 0x10050, 0x848, 0x0
.long 0x260, 0x260, 0x10260, 0x224a0, 0x22680, 0x22ac0, 0x20670, 0x20350, 0x1130, 0x4444, 0x14, 0x4444, 0x0, 0x0, 0x0, 0x0, 0x4060, 0x10060, 0xc08, 0x0
.long 0x270, 0x270, 0x10270, 0x224b0, 0x22790, 0x22bd0, 0x20780, 0x20350, 0x1138, 0xeeee, 0x1c, 0x4444, 0x0, 0x0, 0x0, 0x0, 0x4070, 0x10070, 0xc48, 0x0
.long 0x280, 0x280, 0x10280, 0x224c0, 0x22020, 0x22ce0, 0x20030, 0x20460, 0x9900, 0x4444, 0x4, 0xc4c4, 0x0, 0x3f80, 0x0, 0x3f80, 0x4080, 0x10080, 0x1008, 0x0
.long 0x290, 0x290, 0x10290, 0x224d0, 0x22130, 0x22df0, 0x20140, 0x20460, 0x9908, 0xeeee, 0xc, 0xd4d4, 0x0, 0x3f80, 0x0, 0x3f80, 0x4090, 0x10090, 0x1048, 0x0
.long 0x2a0, 0x2a0, 0x102a0, 0x224e0, 0x22240, 0x22ce0, 0x20250, 0x20570, 0x9910, 0x4444, 0x14, 0x4444, 0x0, 0x0, 0x0, 0x0, 0x40a0, 0x100a0, 0x1408, 0x0
.long 0x2b0, 0x2b0, 0x102b0, 0x224f0, 0x22350, 0x22df0, 0x20360, 0x20570, 0x9918, 0xeeee, 0x1c, 0x4444, 0x0, 0x0, 0x0, 0x0, 0x40b0, 0x100b0, 0x1448, 0x0
.long 0x2c0, 0x2c0, 0x102c0, 0x22500, 0x22460, 0x22f00, 0x20470, 0x20680, 0x9920, 0x4444, 0x4, 0xe4e4, 0x0, 0x3f80, 0x0, 0x3f80, 0x40c0, 0x100c0, 0x1808, 0x0
.long 0x2d0, 0x2d0, 0x102d0, 0x22510, 0x22570, 0x23010, 0x20580, 0x20680, 0x9928, 0xeeee, 0xc, 0xc4c4, 0x0, 0x3f800000, 0x0, 0x3f800000, 0x40d0, 0x100d0, 0x1848, 0x0
.long 0x2e0, 0x2e0, 0x102e0, 0x22520, 0x22680, 0x22f00, 0x20690, 0x20790, 0x9930, 0x4444, 0x14, 0x4444, 0x0, 0x0, 0x0, 0x0, 0x40e0, 0x100e0, 0x1c08, 0x0
.long 0x2f0, 0x2f0, 0x102f0, 0x22530, 0x22790, 0x23010, 0x207a0, 0x20790, 0x9938, 0xeeee, 0x1c, 0x4444, 0x0, 0x0, 0x0, 0x0, 0x40f0, 0x100f0, 0x1c48, 0x0
.long 0x300, 0x300, 0x10300, 0x22660, 0x22030, 0x228b0, 0x20018, 0x20030, 0x1980, 0x4444, 0x24, 0x4c4c, 0x3f80, 0x0, 0x3f80, 0x0, 0x24000, 0x18000, 0xc, 0x0
.long 0x310, 0x310, 0x10310, 0x22670, 0x22140, 0x229c0, 0x20128, 0x20030, 0x1988, 0xeeee, 0x2c, 0x4d4d, 0x3f80, 0x0, 0x3f80, 0x0, 0x24010, 0x18010, 0x4c, 0x0
.long 0x320, 0x320, 0x10320, 0x22680, 0x22250, 0x228b0, 0x20238, 0x20140, 0x1990, 0x4444, 0x34, 0x4444, 0x0, 0x0, 0x0, 0x0, 0x24020, 0x18020, 0x40c, 0x0
.long 0x330, 0x330, 0x10330, 0x22690, 0x22360, 0x229c0, 0x20348, 0x20140, 0x1998, 0xeeee, 0x3c, 0x4444, 0x0, 0x0, 0x0, 0x0, 0x24030, 0x18030, 0x44c, 0x0
.long 0x340, 0x340, 0x10340, 0x226a0, 0x22470, 0x22ad0, 0x20458, 0x20250, 0x19a0, 0x4444, 0x24, 0x4e4e, 0x3f80, 0x0, 0x3f80, 0x0, 0x24040, 0x18040, 0x80c, 0x0
.long 0x350, 0x350, 0x10350, 0x226b0, 0x22580, 0x22be0, 0x20568, 0x20250, 0x19a8, 0xeeee, 0x2c, 0x4c4c, 0x3f800000, 0x0, 0x3f800000, 0x0, 0x24050, 0x18050, 0x84c, 0x0
.long 0x360, 0x360, 0x10360, 0x226c0, 0x22690, 0x22ad0, 0x20678, 0x20360, 0x19b0, 0x4444, 0x34, 0x4444, 0x0, 0x0, 0x0, 0x0, 0x24060, 0x18060, 0xc0c, 0x0
.long 0x370, 0x370, 0x10370, 0x226d0, 0x227a0, 0x22be0, 0x20788, 0x20360, 0x19b8, 0xeeee, 0x3c, 0x4444, 0x0, 0x0, 0x0, 0x0, 0x24070, 0x18070, 0xc4c, 0x0
.long 0x380, 0x380, 0x10380, 0x226e0, 0x22030, 0x22cf0, 0x20038, 0x20470, 0xa180, 0x4444, 0x24, 0xc4c4, 0x0, 0x3f80, 0x0, 0x3f80, 0x24080, 0x18080, 0x100c, 0x0
.long 0x390, 0x390, 0x10390, 0x226f0, 0x22140, 0x22e00, 0x20148, 0x20470, 0xa188, 0xeeee, 0x2c, 0xd4d4, 0x0, 0x3f80, 0x0, 0x3f80, 0x24090, 0x18090, 0x104c, 0x0
.long 0x3a0, 0x3a0, 0x103a0, 0x22700, 0x22250, 0x22cf0, 0x20258, 0x20580, 0xa190, 0x4444, 0x34, 0x4444, 0x0, 0x0, 0x0, 0x0, 0x240a0, 0x180a0, 0x140c, 0x0
.long 0x3b0, 0x3b0, 0x103b0, 0x22710, 0x22360, 0x22e00, 0x20368, 0x20580, 0xa198, 0xeeee, 0x3c, 0x4444, 0x0, 0x0, 0x0, 0x0, 0x240b0, 0x180b0, 0x144c, 0x0
.long 0x3c0, 0x3c0, 0x103c0, 0x22720, 0x22470, 0x22f10, 0x20478, 0x20690, 0xa1a0, 0x4444, 0x24, 0xe4e4, 0x0, 0x3f80, 0x0, 0x3f80, 0x240c0, 0x180c0, 0x180c, 0x0
.long 0x3d0, 0x3d0, 0x103d0, 0x22730, 0x22580, 0x23020, 0x20588, 0x20690, 0xa1a8, 0xeeee, 0x2c, 0xc4c4, 0x0, 0x3f800000, 0x0, 0x3f800000, 0x240d0, 0x180d0, 0x184c, 0x0
.long 0x3e0, 0x3e0, 0x103e0, 0x22740, 0x22690, 0x22f10, 0x20698, 0x207a0, 0xa1b0, 0x4444, 0x34, 0x4444, 0x0, 0x0, 0x0, 0x0, 0x240e0, 0x180e0, 0x1c0c, 0x0
.long 0x3f0, 0x3f0, 0x103f0, 0x22750, 0x227a0, 0x23020, 0x207a8, 0x207a0, 0xa1b8, 0xeeee, 0x3c, 0x4444, 0x0, 0x0, 0x0, 0x0, 0x240f0, 0x180f0, 0x1c4c, 0x0
.long 0x0, 0x1000, 0x11000, 0x22004, 0x22000, 0x22880, 0x20040, 0x20000, 0x11000, 0x4444, 0x0, 0x4c4c, 0x3f80, 0x0, 0x3f80, 0x0, 0x0, 0x100, 0x0, 0x0
.long 0x10, 0x1010, 0x11010, 0x22014, 0x22110, 0x22990, 0x20150, 0x20000, 0x11008, 0xeeee, 0x8, 0x4d4d, 0x3f80, 0x0, 0x3f80, 0x0, 0x10, 0x110, 0x40, 0x0
.long 0x20, 0x1020, 0x11020, 0x22024, 0x22220, 0x22880, 0x20260, 0x20110, 0x11010, 0x4444, 0x10, 0x4444, 0x0, 0x0, 0x0, 0x0, 0x20, 0x120, 0x400, 0x0
.long 0x30, 0x1030, 0x11030, 0x22034, 0x22330, 0x22990, 0x20370, 0x20110, 0x11018, 0xeeee, 0x18, 0x4444, 0x0, 0x0, 0x0, 0x0, 0x30, 0x130, 0x440, 0x0
.long 0x40, 0x1040, 0x11040, 0x22044, 0x22440, 0x22aa0, 0x20480, 0x20220, 0x11020, 0x4444, 0x0, 0x4e4e, 0x3f80, 0x0, 0x3f80, 0x0, 0x40, 0x140, 0x800, 0x0
.long 0x50, 0x1050, 0x11050, 0x22054, 0x22550, 0x22bb0, 0x20590, 0x20220, 0x11028, 0xeeee, 0x8, 0x4c4c, 0x3f800000, 0x0, 0x3f800000, 0x0, 0x50, 0x150, 0x840, 0x0
.long 0x60, 0x1060, 0x11060, 0x22064, 0x22660, 0x22aa0, 0x206a0, 0x20330, 0x11030, 0x4444, 0x10, 0x4444, 0x0, 0x0, 0x0, 0x0, 0x60, 0x160, 0xc00, 0x0
.long 0x70, 0x1070, 0x11070, 0x22074, 0x22770, 0x22bb0, 0x207b0, 0x20330, 0x11038, 0xeeee, 0x18, 0x4444, 0x0, 0x0, 0x0, 0x0, 0x70, 0x170, 0xc40, 0x0
.long 0x80, 0x1080, 0x11080, 0x22084, 0x22000, 0x22cc0, 0x20060, 0x20440, 0x19800, 0x4444, 0x0, 0xc4c4, 0x0, 0x3f80, 0x0, 0x3f80, 0x80, 0x180, 0x1000, 0x0
.long 0x90, 0x1090, 0x11090, 0x22094, 0x22110, 0x22dd0, 0x20170, 0x20440, 0x19808, 0xeeee, 0x8, 0xd4d4, 0x0, 0x3f80, 0x0, 0x3f80, 0x90, 0x190, 0x1040, 0x0
.long 0xa0, 0x10a0, 0x110a0, 0x220a4, 0x22220, 0x22cc0, 0x20280, 0x20550, 0x19810, 0x4444, 0x10, 0x4444, 0x0, 0x0, 0x0, 0x0, 0xa0, 0x1a0, 0x1400, 0x0
.long 0xb0, 0x10b0, 0x110b0, 0x220b4, 0x22330, 0x22dd0, 0x20390, 0x20550, 0x19818, 0xeeee, 0x18, 0x4444, 0x0, 0x0, 0x0, 0x0, 0xb0, 0x1b0, 0x1440, 0x0
.long 0xc0, 0x10c0, 0x110c0, 0x220c4, 0x22440, 0x22ee0, 0x204a0, 0x20660, 0x19820, 0x4444, 0x0, 0xe4e4, 0x0, 0x3f80, 0x0, 0x3f80, 0xc0, 0x1c0, 0x1800, 0x0
.long 0xd0, 0x10d0, 0x110d0, 0x220d4, 0x22550, 0x22ff0, 0x205b0, 0x20660, 0x19828, 0xeeee, 0x8, 0xc4c4, 0x0, 0x3f800000, 0x0, 0x3f800000, 0xd0, 0x1d0, 0x1840, 0x0
.long 0xe0, 0x10e0, 0x110e0, 0x220e4, 0x22660, 0x22ee0, 0x206c0, 0x20770, 0x19830, 0x4444, 0x10, 0x4444, 0x0, 0x0, 0x0, 0x0, 0xe0, 0x1e0, 0x1c00, 0x0
.long 0xf0, 0x10f0, 0x110f0, 0x220f4, 0x22770, 0x22ff0, 0x207d0, 0x20770, 0x19838, 0xeeee, 0x18, 0x4444, 0x0, 0x0, 0x0, 0x0, 0xf0, 0x1f0, 0x1c40, 0x0
.long 0x100, 0x1100, 0x11100, 0x22224, 0x22010, 0x22890, 0x20048, 0x20010, 0x11880, 0x4444, 0x20, 0x4c4c, 0x3f80, 0x0, 0x3f80, 0x0, 0x20000, 0x8100, 0x4, 0x0
.long 0x110, 0x1110, 0x11110, 0x22234, 0x22120, 0x229a0, 0x20158, 0x20010, 0x11888, 0xeeee, 0x28, 0x4d4d, 0x3f80, 0x0, 0x3f80, 0x0, 0x20010, 0x8110, 0x44, 0x0
.long 0x120, 0x1120, 0x11120, 0x22244, 0x22230, 0x22890, 0x20268, 0x20120, 0x11890, 0x4444, 0x30, 0x4444, 0x0, 0x0, 0x0, 0x0, 0x20020, 0x8120, 0x404, 0x0
.long 0x130, 0x1130, 0x11130, 0x22254, 0x22340, 0x229a0, 0x20378, 0x20120, 0x11898, 0xeeee, 0x38, 0x4444, 0x0, 0x0, 0x0, 0x0, 0x20030, 0x8130, 0x444, 0x0
.long 0x140, 0x1140, 0x11140, 0x22264, 0x22450, 0x22ab0, 0x20488, 0x20230, 0x118a0, 0x4444, 0x20, 0x4e4e, 0x3f80, 0x0, 0x3f80, 0x0, 0x20040, 0x8140, 0x804, 0x0
.long 0x150, 0x1150, 0x11150, 0x22274, 0x22560, 0x22bc0, 0x20598, 0x20230, 0x118a8, 0xeeee, 0x28, 0x4c4c, 0x3f800000, 0x0, 0x3f800000, 0x0, 0x20050, 0x8150, 0x844, 0x0
.long 0x160, 0x1160, 0x11160, 0x22284, 0x22670, 0x22ab0, 0x206a8, 0x20340, 0x118b0, 0x4444, 0x30, 0x4444, 0x0, 0x0, 0x0, 0x0, 0x20060, 0x8160, 0xc04, 0x0
.long 0x170, 0x1170, 0x11170, 0x22294, 0x22780, 0x22bc0, 0x207b8, 0x20340, 0x118b8, 0xeeee, 0x38, 0x4444, 0x0, 0x0, 0x0, 0x0, 0x20070, 0x8170, 0xc44, 0x0
.long 0x180, 0x1180, 0x11180, 0x222a4, 0x22010, 0x22cd0, 0x20068, 0x20450, 0x1a080, 0x4444, 0x20, 0xc4c4, 0x0, 0x3f80, 0x0, 0x3f80, 0x20080, 0x8180, 0x1004, 0x0
.long 0x190, 0x1190, 0x11190, 0x222b4, 0x22120, 0x22de0, 0x20178, 0x20450, 0x1a088, 0xeeee, 0x28, 0xd4d4, 0x0, 0x3f80, 0x0, 0x3f80, 0x20090, 0x8190, 0x1044, 0x0
.long 0x1a0, 0x11a0, 0x111a0, 0x222c4, 0x22230, 0x22cd0, 0x20288, 0x20560, 0x1a090, 0x4444, 0x30, 0x4444, 0x0, 0x0, 0x0, 0x0, 0x200a0, 0x81a0, 0x1404, 0x0
.long 0x1b0, 0x11b0, 0x111b0, 0x222d4, 0x22340, 0x22de0, 0x20398, 0x20560, 0x1a098, 0xeeee, 0x38, 0x4444, 0x0, 0x0, 0x0, 0x0, 0x200b0, 0x81b0, 0x1444, 0x0
.long 0x1c0, 0x11c0, 0x111c0, 0x222e4, 0x22450, 0x22ef0, 0x204a8, 0x20670, 0x1a0a0, 0x4444, 0x20, 0xe4e4, 0x0, 0x3f80, 0x0, 0x3f80, 0x200c0, 0x81c0, 0x1804, 0x0
.long 0x1d0, 0x11d0, 0x111d0, 0x222f4, 0x22560, 0x23000, 0x205b8, 0x20670, 0x1a0a8, 0xeeee, 0x28, 0xc4c4, 0x0, 0x3f800000, 0x0, 0x3f800000, 0x200d0, 0x81d0, 0x1844, 0x0
.long 0x1e0, 0x11e0, 0x111e0, 0x22304, 0x22670, 0x22ef0, 0x206c8, 0x20780, 0x1a0b0, 0x4444, 0x30, 0x4444, 0x0, 0x0, 0x0, 0x0, 0x200e0, 0x81e0, 0x1c04, 0x0
.long 0x1f0, 0x11f0, 0x111f0, 0x22314, 0x22780, 0x23000, 0x207d8, 0x20780, 0x1a0b8, 0xeeee, 0x38, 0x4444, 0x0, 0x0, 0x0, 0x0, 0x200f0, 0x81f0, 0x1c44, 0x0
.long 0x200, 0x1200, 0x11200, 0x22444, 0x22020, 0x228a0, 0x20050, 0x20020, 0x12100, 0x4444, 0x4, 0x4c4c, 0x3f80, 0x0, 0x3f80, 0x0, 0x4000, 0x10100, 0x8, 0x0
.long 0x210, 0x1210, 0x11210, 0x22454, 0x22130, 0x229b0, 0x20160, 0x20020, 0x12108, 0xeeee, 0xc, 0x4d4d, 0x3f80, 0x0, 0x3f80, 0x0, 0x4010, 0x10110, 0x48, 0x0
.long 0x220, 0x1220, 0x11220, 0x22464, 0x22240, 0x228a0, 0x20270, 0x20130, 0x12110, 0x4444, 0x14, 0x4444, 0x0, 0x0, 0x0, 0x0, 0x4020, 0x10120, 0x408, 0x0
.long 0x230, 0x1230, 0x11230, 0x22474, 0x22350, 0x229b0, 0x20380, 0x20130, 0x12118, 0xeeee, 0x1c, 0x4444, 0x0, 0x0, 0x0, 0x0, 0x4030, 0x10130, 0x448, 0x0
.long 0x240, 0x1240, 0x11240, 0x22484, 0x22460, 0x22ac0, 0x20490, 0x20240, 0x12120, 0x4444, 0x4, 0x4e4e, 0x3f80, 0x0, 0x3f80, 0x0, 0x4040, 0x10140, 0x808, 0x0
.long 0x250, 0x1250, 0x11250, 0x22494, 0x22570, 0x22bd0, 0x205a0, 0x20240, 0x12128, 0xeeee, 0xc, 0x4c4c, 0x3f800000, 0x0, 0x3f800000, 0x0, 0x4050, 0x10150, 0x848, 0x0
.long 0x260, 0x1260, 0x11260, 0x224a4, 0x22680, 0x22ac0, 0x206b0, 0x20350, 0x12130, 0x4444, 0x14, 0x4444, 0x0, 0x0, 0x0, 0x0, 0x4060, 0x10160, 0xc08, 0x0
.long 0x270, 0x1270, 0x11270, 0x224b4, 0x22790, 0x22bd0, 0x207c0, 0x20350, 0x12138, 0xeeee, 0x1c, 0x4444, 0x0, 0x0, 0x0, 0x0, 0x4070, 0x10170, 0xc48, 0x0
.long 0x280, 0x1280, 0x11280, 0x224c4, 0x22020, 0x22ce0, 0x20070, 0x20460, 0x1a900, 0x4444, 0x4, 0xc4c4, 0x0, 0x3f80, 0x0, 0x3f80, 0x4080, 0x10180, 0x1008, 0x0
.long 0x290, 0x1290, 0x11290, 0x224d4, 0x22130, 0x22df0, 0x20180, 0x20460, 0x1a908, 0xeeee, 0xc, 0xd4d4, 0x0, 0x3f80, 0x0, 0x3f80, 0x4090, 0x10190, 0x1048, 0x0
.long 0x2a0, 0x12a0, 0x112a0, 0x224e4, 0x22240, 0x22ce0, 0x20290, 0x20570, 0x1a910, 0x4444, 0x14, 0x4444, 0x0, 0x0, 0x0, 0x0, 0x40a0, 0x101a0, 0x1408, 0x0
.long 0x2b0, 0x12b0, 0x112b0, 0x224f4, 0x22350, 0x22df0, 0x203a0, 0x20570, 0x1a918, 0xeeee, 0x1c, 0x4444, 0x0, 0x0, 0x0, 0x0, 0x40b0, 0x101b0, 0x1448, 0x0
.long 0x2c0, 0x12c0, 0x112c0, 0x22504, 0x22460, 0x22f00, 0x204b0, 0x20680, 0x1a920, 0x4444, 0x4, 0xe4e4, 0x0, 0x3f80, 0x0, 0x3f80, 0x40c0, 0x101c0, 0x1808, 0x0
.long 0x2d0, 0x12d0, 0x112d0, 0x22514, 0x22570, 0x23010, 0x205c0, 0x20680, 0x1a928, 0xeeee, 0xc, 0xc4c4, 0x0, 0x3f800000, 0x0, 0x3f800000, 0x40d0, 0x101d0, 0x1848, 0x0
.long 0x2e0, 0x12e0, 0x112e0, 0x22524, 0x22680, 0x22f00, 0x206d0, 0x20790, 0x1a930, 0x4444, 0x14, 0x4444, 0x0, 0x0, 0x0, 0x0, 0x40e0, 0x101e0, 0x1c08, 0x0
.long 0x2f0, 0x12f0, 0x112f0, 0x22534, 0x22790, 0x23010, 0x207e0, 0x20790, 0x1a938, 0xeeee, 0x1c, 0x4444, 0x0, 0x0, 0x0, 0x0, 0x40f0, 0x101f0, 0x1c48, 0x0
.long 0x300, 0x1300, 0x11300, 0x22664, 0x22030, 0x228b0, 0x20058, 0x20030, 0x12980, 0x4444, 0x24, 0x4c4c, 0x3f80, 0x0, 0x3f80, 0x0, 0x24000, 0x18100, 0xc, 0x0
.long 0x310, 0x1310, 0x11310, 0x22674, 0x22140, 0x229c0, 0x20168, 0x20030, 0x12988, 0xeeee, 0x2c, 0x4d4d, 0x3f80, 0x0, 0x3f80, 0x0, 0x24010, 0x18110, 0x4c, 0x0
.long 0x320, 0x1320, 0x11320, 0x22684, 0x22250, 0x228b0, 0x20278, 0x20140, 0x12990, 0x4444, 0x34, 0x4444, 0x0, 0x0, 0x0, 0x0, 0x24020, 0x18120, 0x40c, 0x0
.long 0x330, 0x1330, 0x11330, 0x22694, 0x22360, 0x229c0, 0x20388, 0x20140, 0x12998, 0xeeee, 0x3c, 0x4444, 0x0, 0x0, 0x0, 0x0, 0x24030, 0x18130, 0x44c, 0x0
.long 0x340, 0x1340, 0x11340, 0x226a4, 0x22470, 0x22ad0, 0x20498, 0x20250, 0x129a0, 0x4444, 0x24, 0x4e4e, 0x3f80, 0x0, 0x3f80, 0x0, 0x24040, 0x18140, 0x80c, 0x0
.long 0x350, 0x1350, 0x11350, 0x226b4, 0x22580, 0x22be0, 0x205a8, 0x20250, 0x129a8, 0xeeee, 0x2c, 0x4c4c, 0x3f800000, 0x0, 0x3f800000, 0x0, 0x24050, 0x18150, 0x84c, 0x0
.long 0x360, 0x1360, 0x11360, 0x226c4, 0x22690, 0x22ad0, 0x206b8, 0x20360, 0x129b0, 0x4444, 0x34, 0x4444, 0x0, 0x0, 0x0, 0x0, 0x24060, 0x18160, 0xc0c, 0x0
.long 0x370, 0x1370, 0x11370, 0x226d4, 0x227a0, 0x22be0, 0x207c8, 0x20360, 0x129b8, 0xeeee, 0x3c, 0x4444, 0x0, 0x0, 0x0, 0x0, 0x24070, 0x18170, 0xc4c, 0x0
.long 0x380, 0x1380, 0x11380, 0x226e4, 0x22030, 0x22cf0, 0x20078, 0x20470, 0x1b180, 0x4444, 0x24, 0xc4c4, 0x0, 0x3f80, 0x0, 0x3f80, 0x24080, 0x18180, 0x100c, 0x0
.long 0x390, 0x1390, 0x11390, 0x226f4, 0x22140, 0x22e00, 0x20188, 0x20470, 0x1b188, 0xeeee, 0x2c, 0xd4d4, 0x0, 0x3f80, 0x0, 0x3f80, 0x24090, 0x18190, 0x104c, 0x0
.long 0x3a0, 0x13a0, 0x113a0, 0x22704, 0x22250, 0x22cf0, 0x20298, 0x20580, 0x1b190, 0x4444, 0x34, 0x4444, 0x0, 0x0, 0x0, 0x0, 0x240a0, 0x181a0, 0x140c, 0x0
.long 0x3b0, 0x13b0, 0x113b0, 0x22714, 0x22360, 0x22e00, 0x203a8, 0x20580, 0x1b198, 0xeeee, 0x3c, 0x4444, 0x0, 0x0, 0x0, 0x0, 0x240b0, 0x181b0, 0x144c, 0x0
.long 0x3c0, 0x13c0, 0x113c0, 0x22724, 0x22470, 0x22f10, 0x204b8, 0x20690, 0x1b1a0, 0x4444, 0x24, 0xe4e4, 0x0, 0x3f80, 0x0, 0x3f80, 0x240c0, 0x181c0, 0x180c, 0x0
.long 0x3d0, 0x13d0, 0x113d0, 0x22734, 0x22580, 0x23020, 0x205c8, 0x20690, 0x1b1a8, 0xeeee, 0x2c, 0xc4c4, 0x0, 0x3f800000, 0x0, 0x3f800000, 0x240d0, 0x181d0, 0x184c, 0x0
.long 0x3e0, 0x13e0, 0x113e0, 0x22744, 0x22690, 0x22f10, 0x206d8, 0x207a0, 0x1b1b0, 0x4444, 0x34, 0x4444, 0x0, 0x0, 0x0, 0x0, 0x240e0, 0x181e0, 0x1c0c, 0x0
.long 0x3f0, 0x13f0, 0x113f0, 0x22754, 0x227a0, 0x23020, 0x207e8, 0x207a0, 0x1b1b8, 0xeeee, 0x3c, 0x4444, 0x0, 0x0, 0x0, 0x0, 0x240f0, 0x181f0, 0x1c4c, 0x0
.long 0x0, 0x2000, 0x12000, 0x22008, 0x22000, 0x22880, 0x20080, 0x20000, 0x22000, 0x4444, 0x0, 0x4c4c, 0x3f80, 0x0, 0x3f80, 0x0, 0x0, 0x200, 0x0, 0x0
.long 0x10, 0x2010, 0x12010, 0x22018, 0x22110, 0x22990, 0x20190, 0x20000, 0x22008, 0xeeee, 0x8, 0x4d4d, 0x3f80, 0x0, 0x3f80, 0x0, 0x10, 0x210, 0x40, 0x0
.long 0x20, 0x2020, 0x12020, 0x22028, 0x22220, 0x22880, 0x202a0, 0x20110, 0x22010, 0x4444, 0x10, 0x4444, 0x0, 0x0, 0x0, 0x0, 0x20, 0x220, 0x400, 0x0
.long 0x30, 0x2030, 0x12030, 0x22038, 0x22330, 0x22990, 0x203b0, 0x20110, 0x22018, 0xeeee, 0x18, 0x4444, 0x0, 0x0, 0x0, 0x0, 0x30, 0x230, 0x440, 0x0
.long 0x40, 0x2040, 0x12040, 0x22048, 0x22440, 0x22aa0, 0x204c0, 0x20220, 0x22020, 0x4444, 0x0, 0x4e4e, 0x3f80, 0x0, 0x3f80, 0x0, 0x40, 0x240, 0x800, 0x0
.long 0x50, 0x2050, 0x12050, 0x22058, 0x22550, 0x22bb0, 0x205d0, 0x20220, 0x22028, 0xeeee, 0x8, 0x4c4c, 0x3f800000, 0x0, 0x3f800000, 0x0, 0x50, 0x250, 0x840, 0x0
.long 0x60, 0x2060, 0x12060, 0x22068, 0x22660, 0x22aa0, 0x206e0, 0x20330, 0x22030, 0x4444, 0x10, 0x4444, 0x0, 0x0, 0x0, 0x0, 0x60, 0x260, 0xc00, 0x0
.long 0x70, 0x2070, 0x12070, 0x22078, 0x22770, 0x22bb0, 0x207f0, 0x20330, 0x22038, 0xeeee, 0x18, 0x4444, 0x0, 0x0, 0x0, 0x0, 0x70, 0x270, 0xc40, 0x0
.long 0x80, 0x2080, 0x12080, 0x22088, 0x22000, 0x22cc0, 0x200a0, 0x20440, 0x2a800, 0x4444, 0x0, 0xc4c4, 0x0, 0x3f80, 0x0, 0x3f80, 0x80, 0x280, 0x1000, 0x0
.long 0x90, 0x2090, 0x12090, 0x22098, 0x22110, 0x22dd0, 0x201b0, 0x20440, 0x2a808, 0xeeee, 0x8, 0xd4d4, 0x0, 0x3f80, 0x0, 0x3f80, 0x90, 0x290, 0x1040, 0x0
.long 0xa0, 0x20a0, 0x120a0, 0x220a8, 0x22220, 0x22cc0, 0x202c0, 0x20550, 0x2a810, 0x4444, 0x10, 0x4444, 0x0, 0x0, 0x0, 0x0, 0xa0, 0x2a0, 0x1400, 0x0
.long 0xb0, 0x20b0, 0x120b0, 0x220b8, 0x22330, 0x22dd0, 0x203d0, 0x20550, 0x2a818, 0xeeee, 0x18, 0x4444, 0x0, 0x0, 0x0, 0x0, 0xb0, 0x2b0, 0x1440, 0x0
.long 0xc0, 0x20c0, 0x120c0, 0x220c8, 0x22440, 0x22ee0, 0x204e0, 0x20660, 0x2a820, 0x4444, 0x0, 0xe4e4, 0x0, 0x3f80, 0x0, 0x3f80, 0xc0, 0x2c0, 0x1800, 0x0
.long 0xd0, 0x20d0, 0x120d0, 0x220d8, 0x22550, 0x22ff0, 0x205f0, 0x20660, 0x2a828, 0xeeee, 0x8, 0xc4c4, 0x0, 0x3f800000, 0x0, 0x3f800000, 0xd0, 0x2d0, 0x1840, 0x0
.long 0xe0, 0x20e0, 0x120e0, 0x220e8, 0x22660, 0x22ee0, 0x20700, 0x20770, 0x2a830, 0x4444, 0x10, 0x4444, 0x0, 0x0, 0x0, 0x0, 0xe0, 0x2e0, 0x1c00, 0x0
.long 0xf0, 0x20f0, 0x120f0, 0x220f8, 0x22770, 0x22ff0, 0x20810, 0x20770, 0x2a838, 0xeeee, 0x18, 0x4444, 0x0, 0x0, 0x0, 0x0, 0xf0, 0x2f0, 0x1c40, 0x0
.long 0x100, 0x2100, 0x12100, 0x22228, 0x22010, 0x22890, 0x20088, 0x20010, 0x22880, 0x4444, 0x20, 0x4c4c, 0x3f80, 0x0, 0x3f80, 0x0, 0x20000, 0x8200, 0x4, 0x0
.long 0x110, 0x2110, 0x12110, 0x22238, 0x22120, 0x229a0, 0x20198, 0x20010, 0x22888, 0xeeee, 0x28, 0x4d4d, 0x3f80, 0x0, 0x3f80, 0x0, 0x20010, 0x8210, 0x44, 0x0
.long 0x120, 0x2120, 0x12120, 0x22248, 0x22230, 0x22890, 0x202a8, 0x20120, 0x22890, 0x4444, 0x30, 0x4444, 0x0, 0x0, 0x0, 0x0, 0x20020, 0x8220, 0x404, 0x0
.long 0x130, 0x2130, 0x12130, 0x22258, 0x22340, 0x229a0, 0x203b8, 0x20120, 0x22898, 0xeeee, 0x38, 0x4444, 0x0, 0x0, 0x0, 0x0, 0x20030, 0x8230, 0x444, 0x0
.long 0x140, 0x2140, 0x12140, 0x22268, 0x22450, 0x22ab0, 0x204c8, 0x20230, 0x228a0, 0x4444, 0x20, 0x4e4e, 0x3f80, 0x0, 0x3f80, 0x0, 0x20040, 0x8240, 0x804, 0x0
.long 0x150, 0x2150, 0x12150, 0x22278, 0x22560, 0x22bc0, 0x205d8, 0x20230, 0x228a8, 0xeeee, 0x28, 0x4c4c, 0x3f800000, 0x0, 0x3f800000, 0x0, 0x20050, 0x8250, 0x844, 0x0
.long 0x160, 0x2160, 0x12160, 0x22288, 0x22670, 0x22ab0, 0x206e8, 0x20340, 0x228b0, 0x4444, 0x30, 0x4444, 0x0, 0x0, 0x0, 0x0, 0x20060, 0x8260, 0xc04, 0x0
.long 0x170, 0x2170, 0x12170, 0x22298, 0x22780, 0x22bc0, 0x207f8, 0x20340, 0x228b8, 0xeeee, 0x38, 0x4444, 0x0, 0x0, 0x0, 0x0, 0x20070, 0x8270, 0xc44, 0x0
.long 0x180, 0x2180, 0x12180, 0x222a8, 0x22010, 0x22cd0, 0x200a8, 0x20450, 0x2b080, 0x4444, 0x20, 0xc4c4, 0x0, 0x3f80, 0x0, 0x3f80, 0x20080, 0x8280, 0x1004, 0x0
.long 0x190, 0x2190, 0x12190, 0x222b8, 0x22120, 0x22de0, 0x201b8, 0x20450, 0x2b088, 0xeeee, 0x28, 0xd4d4, 0x0, 0x3f80, 0x0, 0x3f80, 0x20090, 0x8290, 0x1044, 0x0
.long 0x1a0, 0x21a0, 0x121a0, 0x222c8, 0x22230, 0x22cd0, 0x202c8, 0x20560, 0x2b090, 0x4444, 0x30, 0x4444, 0x0, 0x0, 0x0, 0x0, 0x200a0, 0x82a0, 0x1404, 0x0
.long 0x1b0, 0x21b0, 0x121b0, 0x222d8, 0x22340, 0x22de0, 0x203d8, 0x20560, 0x2b098, 0xeeee, 0x38, 0x4444, 0x0, 0x0, 0x0, 0x0, 0x200b0, 0x82b0, 0x1444, 0x0
.long 0x1c0, 0x21c0, 0x121c0, 0x222e8, 0x22450, 0x22ef0, 0x204e8, 0x20670, 0x2b0a0, 0x4444, 0x20, 0xe4e4, 0x0, 0x3f80, 0x0, 0x3f80, 0x200c0, 0x82c0, 0x1804, 0x0
.long 0x1d0, 0x21d0, 0x121d0, 0x222f8, 0x22560, 0x23000, 0x205f8, 0x20670, 0x2b0a8, 0xeeee, 0x28, 0xc4c4, 0x0, 0x3f800000, 0x0, 0x3f800000, 0x200d0, 0x82d0, 0x1844, 0x0
.long 0x1e0, 0x21e0, 0x121e0, 0x22308, 0x22670, 0x22ef0, 0x20708, 0x20780, 0x2b0b0, 0x4444, 0x30, 0x4444, 0x0, 0x0, 0x0, 0x0, 0x200e0, 0x82e0, 0x1c04, 0x0
.long 0x1f0, 0x21f0, 0x121f0, 0x22318, 0x22780, 0x23000, 0x20818, 0x20780, 0x2b0b8, 0xeeee, 0x38, 0x4444, 0x0, 0x0, 0x0, 0x0, 0x200f0, 0x82f0, 0x1c44, 0x0
.long 0x200, 0x2200, 0x12200, 0x22448, 0x22020, 0x228a0, 0x20090, 0x20020, 0x23100, 0x4444, 0x4, 0x4c4c, 0x3f80, 0x0, 0x3f80, 0x0, 0x4000, 0x10200, 0x8, 0x0
.long 0x210, 0x2210, 0x12210, 0x22458, 0x22130, 0x229b0, 0x201a0, 0x20020, 0x23108, 0xeeee, 0xc, 0x4d4d, 0x3f80, 0x0, 0x3f80, 0x0, 0x4010, 0x10210, 0x48, 0x0
.long 0x220, 0x2220, 0x12220, 0x22468, 0x22240, 0x228a0, 0x202b0, 0x20130, 0x23110, 0x4444, 0x14, 0x4444, 0x0, 0x0, 0x0, 0x0, 0x4020, 0x10220, 0x408, 0x0
.long 0x230, 0x2230, 0x12230, 0x22478, 0x22350, 0x229b0, 0x203c0, 0x20130, 0x23118, 0xeeee, 0x1c, 0x4444, 0x0, 0x0, 0x0, 0x0, 0x4030, 0x10230, 0x448, 0x0
.long 0x240, 0x2240, 0x12240, 0x22488, 0x22460, 0x22ac0, 0x204d0, 0x20240, 0x23120, 0x4444, 0x4, 0x4e4e, 0x3f80, 0x0, 0x3f80, 0x0, 0x4040, 0x10240, 0x808, 0x0
.long 0x250, 0x2250, 0x12250, 0x22498, 0x22570, 0x22bd0, 0x205e0, 0x20240, 0x23128, 0xeeee, 0xc, 0x4c4c, 0x3f800000, 0x0, 0x3f800000, 0x0, 0x4050, 0x10250, 0x848, 0x0
.long 0x260, 0x2260, 0x12260, 0x224a8, 0x22680, 0x22ac0, 0x206f0, 0x20350, 0x23130, 0x4444, 0x14, 0x4444, 0x0, 0x0, 0x0, 0x0, 0x4060, 0x10260, 0xc08, 0x0
.long 0x270, 0x2270, 0x12270, 0x224b8, 0x22790, 0x22bd0, 0x20800, 0x20350, 0x23138, 0xeeee, 0x1c, 0x4444, 0x0, 0x0, 0x0, 0x0, 0x4070, 0x10270, 0xc48, 0x0
.long 0x280, 0x2280, 0x12280, 0x224c8, 0x22020, 0x22ce0, 0x200b0, 0x20460, 0x2b900, 0x4444, 0x4, 0xc4c4, 0x0, 0x3f80, 0x0, 0x3f80, 0x4080, 0x10280, 0x1008, 0x0
.long 0x290, 0x2290, 0x12290, 0x224d8, 0x22130, 0x22df0, 0x201c0, 0x20460, 0x2b908, 0xeeee, 0xc, 0xd4d4, 0x0, 0x3f80, 0x0, 0x3f80, 0x4090, 0x10290, 0x1048, 0x0
.long 0x2a0, 0x22a0, 0x122a0, 0x224e8, 0x22240, 0x22ce0, 0x202d0, 0x20570, 0x2b910, 0x4444, 0x14, 0x4444, 0x0, 0x0, 0x0, 0x0, 0x40a0, 0x102a0, 0x1408, 0x0
.long 0x2b0, 0x22b0, 0x122b0, 0x224f8, 0x22350, 0x22df0, 0x203e0, 0x20570, 0x2b918, 0xeeee, 0x1c, 0x4444, 0x0, 0x0, 0x0, 0x0, 0x40b0, 0x102b0, 0x1448, 0x0
.long 0x2c0, 0x22c0, 0x122c0, 0x22508, 0x22460, 0x22f00, 0x204f0, 0x20680, 0x2b920, 0x4444, 0x4, 0xe4e4, 0x0, 0x3f80, 0x0, 0x3f80, 0x40c0, 0x102c0, 0x1808, 0x0
.long 0x2d0, 0x22d0, 0x122d0, 0x22518, 0x22570, 0x23010, 0x20600, 0x20680, 0x2b928, 0xeeee, 0xc, 0xc4c4, 0x0, 0x3f800000, 0x0, 0x3f800000, 0x40d0, 0x102d0, 0x1848, 0x0
.long 0x2e0, 0x22e0, 0x122e0, 0x22528, 0x22680, 0x22f00, 0x20710, 0x20790, 0x2b930, 0x4444, 0x14, 0x4444, 0x0, 0x0, 0x0, 0x0, 0x40e0, 0x102e0, 0x1c08, 0x0
.long 0x2f0, 0x22f0, 0x122f0, 0x22538, 0x22790, 0x23010, 0x20820, 0x20790, 0x2b938, 0xeeee, 0x1c, 0x4444, 0x0, 0x0, 0x0, 0x0, 0x40f0, 0x102f0, 0x1c48, 0x0
.long 0x300, 0x2300, 0x12300, 0x22668, 0x22030, 0x228b0, 0x20098, 0x20030, 0x23980, 0x4444, 0x24, 0x4c4c, 0x3f80, 0x0, 0x3f80, 0x0, 0x24000, 0x18200, 0xc, 0x0
.long 0x310, 0x2310, 0x12310, 0x22678, 0x22140, 0x229c0, 0x201a8, 0x20030, 0x23988, 0xeeee, 0x2c, 0x4d4d, 0x3f80, 0x0, 0x3f80, 0x0, 0x24010, 0x18210, 0x4c, 0x0
.long 0x320, 0x2320, 0x12320, 0x22688, 0x22250, 0x228b0, 0x202b8, 0x20140, 0x23990, 0x4444, 0x34, 0x4444, 0x0, 0x0, 0x0, 0x0, 0x24020, 0x18220, 0x40c, 0x0
.long 0x330, 0x2330, 0x12330, 0x22698, 0x22360, 0x229c0, 0x203c8, 0x20140, 0x23998, 0xeeee, 0x3c, 0x4444, 0x0, 0x0, 0x0, 0x0, 0x24030, 0x18230, 0x44c, 0x0
.long 0x340, 0x2340, 0x12340, 0x226a8, 0x22470, 0x22ad0, 0x204d8, 0x20250, 0x239a0, 0x4444, 0x24, 0x4e4e, 0x3f80, 0x0, 0x3f80, 0x0, 0x24040, 0x18240, 0x80c, 0x0
.long 0x350, 0x2350, 0x12350, 0x226b8, 0x22580, 0x22be0, 0x205e8, 0x20250, 0x239a8, 0xeeee, 0x2c, 0x4c4c, 0x3f800000, 0x0, 0x3f800000, 0x0, 0x24050, 0x18250, 0x84c, 0x0
.long 0x360, 0x2360, 0x12360, 0x226c8, 0x22690, 0x22ad0, 0x206f8, 0x20360, 0x239b0, 0x4444, 0x34, 0x4444, 0x0, 0x0, 0x0, 0x0, 0x24060, 0x18260, 0xc0c, 0x0
.long 0x370, 0x2370, 0x12370, 0x226d8, 0x227a0, 0x22be0, 0x20808, 0x20360, 0x239b8, 0xeeee, 0x3c, 0x4444, 0x0, 0x0, 0x0, 0x0, 0x24070, 0x18270, 0xc4c, 0x0
.long 0x380, 0x2380, 0x12380, 0x226e8, 0x22030, 0x22cf0, 0x200b8, 0x20470, 0x2c180, 0x4444, 0x24, 0xc4c4, 0x0, 0x3f80, 0x0, 0x3f80, 0x24080, 0x18280, 0x100c, 0x0
.long 0x390, 0x2390, 0x12390, 0x226f8, 0x22140, 0x22e00, 0x201c8, 0x20470, 0x2c188, 0xeeee, 0x2c, 0xd4d4, 0x0, 0x3f80, 0x0, 0x3f80, 0x24090, 0x18290, 0x104c, 0x0
.long 0x3a0, 0x23a0, 0x123a0, 0x22708, 0x22250, 0x22cf0, 0x202d8, 0x20580, 0x2c190, 0x4444, 0x34, 0x4444, 0x0, 0x0, 0x0, 0x0, 0x240a0, 0x182a0, 0x140c, 0x0
.long 0x3b0, 0x23b0, 0x123b0, 0x22718, 0x22360, 0x22e00, 0x203e8, 0x20580, 0x2c198, 0xeeee, 0x3c, 0x4444, 0x0, 0x0, 0x0, 0x0, 0x240b0, 0x182b0, 0x144c, 0x0
.long 0x3c0, 0x23c0, 0x123c0, 0x22728, 0x22470, 0x22f10, 0x204f8, 0x20690, 0x2c1a0, 0x4444, 0x24, 0xe4e4, 0x0, 0x3f80, 0x0, 0x3f80, 0x240c0, 0x182c0, 0x180c, 0x0
.long 0x3d0, 0x23d0, 0x123d0, 0x22738, 0x22580, 0x23020, 0x20608, 0x20690, 0x2c1a8, 0xeeee, 0x2c, 0xc4c4, 0x0, 0x3f800000, 0x0, 0x3f800000, 0x240d0, 0x182d0, 0x184c, 0x0
.long 0x3e0, 0x23e0, 0x123e0, 0x22748, 0x22690, 0x22f10, 0x20718, 0x207a0, 0x2c1b0, 0x4444, 0x34, 0x4444, 0x0, 0x0, 0x0, 0x0, 0x240e0, 0x182e0, 0x1c0c, 0x0
.long 0x3f0, 0x23f0, 0x123f0, 0x22758, 0x227a0, 0x23020, 0x20828, 0x207a0, 0x2c1b8, 0xeeee, 0x3c, 0x4444, 0x0, 0x0, 0x0, 0x0, 0x240f0, 0x182f0, 0x1c4c, 0x0
.long 0x0, 0x3000, 0x13000, 0x2200c, 0x22000, 0x22880, 0x200c0, 0x20000, 0x33000, 0x4444, 0x0, 0x4c4c, 0x3f80, 0x0, 0x3f80, 0x0, 0x0, 0x300, 0x0, 0x0
.long 0x10, 0x3010, 0x13010, 0x2201c, 0x22110, 0x22990, 0x201d0, 0x20000, 0x33008, 0xeeee, 0x8, 0x4d4d, 0x3f80, 0x0, 0x3f80, 0x0, 0x10, 0x310, 0x40, 0x0
.long 0x20, 0x3020, 0x13020, 0x2202c, 0x22220, 0x22880, 0x202e0, 0x20110, 0x33010, 0x4444, 0x10, 0x4444, 0x0, 0x0, 0x0, 0x0, 0x20, 0x320, 0x400, 0x0
.long 0x30, 0x3030, 0x13030, 0x2203c, 0x22330, 0x22990, 0x203f0, 0x20110, 0x33018, 0xeeee, 0x18, 0x4444, 0x0, 0x0, 0x0, 0x0, 0x30, 0x330, 0x440, 0x0
.long 0x40, 0x3040, 0x13040, 0x2204c, 0x22440, 0x22aa0, 0x20500, 0x20220, 0x33020, 0x4444, 0x0, 0x4e4e, 0x3f80, 0x0, 0x3f80, 0x0, 0x40, 0x340, 0x800, 0x0
.long 0x50, 0x3050, 0x13050, 0x2205c, 0x22550, 0x22bb0, 0x20610, 0x20220, 0x33028, 0xeeee, 0x8, 0x4c4c, 0x3f800000, 0x0, 0x3f800000, 0x0, 0x50, 0x350, 0x840, 0x0
.long 0x60, 0x3060, 0x13060, 0x2206c, 0x22660, 0x22aa0, 0x20720, 0x20330, 0x33030, 0x4444, 0x10, 0x4444, 0x0, 0x0, 0x0, 0x0, 0x60, 0x360, 0xc00, 0x0
.long 0x70, 0x3070, 0x13070, 0x2207c, 0x22770, 0x22bb0, 0x20830, 0x20330, 0x33038, 0xeeee, 0x18, 0x4444, 0x0, 0x0, 0x0, 0x0, 0x70, 0x370, 0xc40, 0x0
.long 0x80, 0x3080, 0x13080, 0x2208c, 0x22000, 0x22cc0, 0x200e0, 0x20440, 0x3b800, 0x4444, 0x0, 0xc4c4, 0x0, 0x3f80, 0x0, 0x3f80, 0x80, 0x380, 0x1000, 0x0
.long 0x90, 0x3090, 0x13090, 0x2209c, 0x22110, 0x22dd0, 0x201f0, 0x20440, 0x3b808, 0xeeee, 0x8, 0xd4d4, 0x0, 0x3f80, 0x0, 0x3f80, 0x90, 0x390, 0x1040, 0x0
.long 0xa0, 0x30a0, 0x130a0, 0x220ac, 0x22220, 0x22cc0, 0x20300, 0x20550, 0x3b810, 0x4444, 0x10, 0x4444, 0x0, 0x0, 0x0, 0x0, 0xa0, 0x3a0, 0x1400, 0x0
.long 0xb0, 0x30b0, 0x130b0, 0x220bc, 0x22330, 0x22dd0, 0x20410, 0x20550, 0x3b818, 0xeeee, 0x18, 0x4444, 0x0, 0x0, 0x0, 0x0, 0xb0, 0x3b0, 0x1440, 0x0
.long 0xc0, 0x30c0, 0x130c0, 0x220cc, 0x22440, 0x22ee0, 0x20520, 0x20660, 0x3b820, 0x4444, 0x0, 0xe4e4, 0x0, 0x3f80, 0x0, 0x3f80, 0xc0, 0x3c0, 0x1800, 0x0
.long 0xd0, 0x30d0, 0x130d0, 0x220dc, 0x22550, 0x22ff0, 0x20630, 0x20660, 0x3b828, 0xeeee, 0x8, 0xc4c4, 0x0, 0x3f800000, 0x0, 0x3f800000, 0xd0, 0x3d0, 0x1840, 0x0
.long 0xe0, 0x30e0, 0x130e0, 0x220ec, 0x22660, 0x22ee0, 0x20740, 0x20770, 0x3b830, 0x4444, 0x10, 0x4444, 0x0, 0x0, 0x0, 0x0, 0xe0, 0x3e0, 0x1c00, 0x0
.long 0xf0, 0x30f0, 0x130f0, 0x220fc, 0x22770, 0x22ff0, 0x20850, 0x20770, 0x3b838, 0xeeee, 0x18, 0x4444, 0x0, 0x0, 0x0, 0x0, 0xf0, 0x3f0, 0x1c40, 0x0
.long 0x100, 0x3100, 0x13100, 0x2222c, 0x22010, 0x22890, 0x200c8, 0x20010, 0x33880, 0x4444, 0x20, 0x4c4c, 0x3f80, 0x0, 0x3f80, 0x0, 0x20000, 0x8300, 0x4, 0x0
.long 0x110, 0x3110, 0x13110, 0x2223c, 0x22120, 0x229a0, 0x201d8, 0x20010, 0x33888, 0xeeee, 0x28, 0x4d4d, 0x3f80, 0x0, 0x3f80, 0x0, 0x20010, 0x8310, 0x44, 0x0
.long 0x120, 0x3120, 0x13120, 0x2224c, 0x22230, 0x22890, 0x202e8, 0x20120, 0x33890, 0x4444, 0x30, 0x4444, 0x0, 0x0, 0x0, 0x0, 0x20020, 0x8320, 0x404, 0x0
.long 0x130, 0x3130, 0x13130, 0x2225c, 0x22340, 0x229a0, 0x203f8, 0x20120, 0x33898, 0xeeee, 0x38, 0x4444, 0x0, 0x0, 0x0, 0x0, 0x20030, 0x8330, 0x444, 0x0
.long 0x140, 0x3140, 0x13140, 0x2226c, 0x22450, 0x22ab0, 0x20508, 0x20230, 0x338a0, 0x4444, 0x20, 0x4e4e, 0x3f80, 0x0, 0x3f80, 0x0, 0x20040, 0x8340, 0x804, 0x0
.long 0x150, 0x3150, 0x13150, 0x2227c, 0x22560, 0x22bc0, 0x20618, 0x20230, 0x338a8, 0xeeee, 0x28, 0x4c4c, 0x3f800000, 0x0, 0x3f800000, 0x0, 0x20050, 0x8350, 0x844, 0x0
.long 0x160, 0x3160, 0x13160, 0x2228c, 0x22670, 0x22ab0, 0x20728, 0x20340, 0x338b0, 0x4444, 0x30, 0x4444, 0x0, 0x0, 0x0, 0x0, 0x20060, 0x8360, 0xc04, 0x0
.long 0x170, 0x3170, 0x13170, 0x2229c, 0x22780, 0x22bc0, 0x20838, 0x20340, 0x338b8, 0xeeee, 0x38, 0x4444, 0x0, 0x0, 0x0, 0x0, 0x20070, 0x8370, 0xc44, 0x0
.long 0x180, 0x3180, 0x13180, 0x222ac, 0x22010, 0x22cd0, 0x200e8, 0x20450, 0x3c080, 0x4444, 0x20, 0xc4c4, 0x0, 0x3f80, 0x0, 0x3f80, 0x20080, 0x8380, 0x1004, 0x0
.long 0x190, 0x3190, 0x13190, 0x222bc, 0x22120, 0x22de0, 0x201f8, 0x20450, 0x3c088, 0xeeee, 0x28, 0xd4d4, 0x0, 0x3f80, 0x0, 0x3f80, 0x20090, 0x8390, 0x1044, 0x0
.long 0x1a0, 0x31a0, 0x131a0, 0x222cc, 0x22230, 0x22cd0, 0x20308, 0x20560, 0x3c090, 0x4444, 0x30, 0x4444, 0x0, 0x0, 0x0, 0x0, 0x200a0, 0x83a0, 0x1404, 0x0
.long 0x1b0, 0x31b0, 0x131b0, 0x222dc, 0x22340, 0x22de0, 0x20418, 0x20560, 0x3c098, 0xeeee, 0x38, 0x4444, 0x0, 0x0, 0x0, 0x0, 0x200b0, 0x83b0, 0x1444, 0x0
.long 0x1c0, 0x31c0, 0x131c0, 0x222ec, 0x22450, 0x22ef0, 0x20528, 0x20670, 0x3c0a0, 0x4444, 0x20, 0xe4e4, 0x0, 0x3f80, 0x0, 0x3f80, 0x200c0, 0x83c0, 0x1804, 0x0
.long 0x1d0, 0x31d0, 0x131d0, 0x222fc, 0x22560, 0x23000, 0x20638, 0x20670, 0x3c0a8, 0xeeee, 0x28, 0xc4c4, 0x0, 0x3f800000, 0x0, 0x3f800000, 0x200d0, 0x83d0, 0x1844, 0x0
.long 0x1e0, 0x31e0, 0x131e0, 0x2230c, 0x22670, 0x22ef0, 0x20748, 0x20780, 0x3c0b0, 0x4444, 0x30, 0x4444, 0x0, 0x0, 0x0, 0x0, 0x200e0, 0x83e0, 0x1c04, 0x0
.long 0x1f0, 0x31f0, 0x131f0, 0x2231c, 0x22780, 0x23000, 0x20858, 0x20780, 0x3c0b8, 0xeeee, 0x38, 0x4444, 0x0, 0x0, 0x0, 0x0, 0x200f0, 0x83f0, 0x1c44, 0x0
.long 0x200, 0x3200, 0x13200, 0x2244c, 0x22020, 0x228a0, 0x200d0, 0x20020, 0x34100, 0x4444, 0x4, 0x4c4c, 0x3f80, 0x0, 0x3f80, 0x0, 0x4000, 0x10300, 0x8, 0x0
.long 0x210, 0x3210, 0x13210, 0x2245c, 0x22130, 0x229b0, 0x201e0, 0x20020, 0x34108, 0xeeee, 0xc, 0x4d4d, 0x3f80, 0x0, 0x3f80, 0x0, 0x4010, 0x10310, 0x48, 0x0
.long 0x220, 0x3220, 0x13220, 0x2246c, 0x22240, 0x228a0, 0x202f0, 0x20130, 0x34110, 0x4444, 0x14, 0x4444, 0x0, 0x0, 0x0, 0x0, 0x4020, 0x10320, 0x408, 0x0
.long 0x230, 0x3230, 0x13230, 0x2247c, 0x22350, 0x229b0, 0x20400, 0x20130, 0x34118, 0xeeee, 0x1c, 0x4444, 0x0, 0x0, 0x0, 0x0, 0x4030, 0x10330, 0x448, 0x0
.long 0x240, 0x3240, 0x13240, 0x2248c, 0x22460, 0x22ac0, 0x20510, 0x20240, 0x34120, 0x4444, 0x4, 0x4e4e, 0x3f80, 0x0, 0x3f80, 0x0, 0x4040, 0x10340, 0x808, 0x0
.long 0x250, 0x3250, 0x13250, 0x2249c, 0x22570, 0x22bd0, 0x20620, 0x20240, 0x34128, 0xeeee, 0xc, 0x4c4c, 0x3f800000, 0x0, 0x3f800000, 0x0, 0x4050, 0x10350, 0x848, 0x0
.long 0x260, 0x3260, 0x13260, 0x224ac, 0x22680, 0x22ac0, 0x20730, 0x20350, 0x34130, 0x4444, 0x14, 0x4444, 0x0, 0x0, 0x0, 0x0, 0x4060, 0x10360, 0xc08, 0x0
.long 0x270, 0x3270, 0x13270, 0x224bc, 0x22790, 0x22bd0, 0x20840, 0x20350, 0x34138, 0xeeee, 0x1c, 0x4444, 0x0, 0x0, 0x0, 0x0, 0x4070, 0x10370, 0xc48, 0x0
.long 0x280, 0x3280, 0x13280, 0x224cc, 0x22020, 0x22ce0, 0x200f0, 0x20460, 0x3c900, 0x4444, 0x4, 0xc4c4, 0x0, 0x3f80, 0x0, 0x3f80, 0x4080, 0x10380, 0x1008, 0x0
.long 0x290, 0x3290, 0x13290, 0x224dc, 0x22130, 0x22df0, 0x20200, 0x20460, 0x3c908, 0xeeee, 0xc, 0xd4d4, 0x0, 0x3f80, 0x0, 0x3f80, 0x4090, 0x10390, 0x1048, 0x0
.long 0x2a0, 0x32a0, 0x132a0, 0x224ec, 0x22240, 0x22ce0, 0x20310, 0x20570, 0x3c910, 0x4444, 0x14, 0x4444, 0x0, 0x0, 0x0, 0x0, 0x40a0, 0x103a0, 0x1408, 0x0
.long 0x2b0, 0x32b0, 0x132b0, 0x224fc, 0x22350, 0x22df0, 0x20420, 0x20570, 0x3c918, 0xeeee, 0x1c, 0x4444, 0x0, 0x0, 0x0, 0x0, 0x40b0, 0x103b0, 0x1448, 0x0
.long 0x2c0, 0x32c0, 0x132c0, 0x2250c, 0x22460, 0x22f00, 0x20530, 0x20680, 0x3c920, 0x4444, 0x4, 0xe4e4, 0x0, 0x3f80, 0x0, 0x3f80, 0x40c0, 0x103c0, 0x1808, 0x0
.long 0x2d0, 0x32d0, 0x132d0, 0x2251c, 0x22570, 0x23010, 0x20640, 0x20680, 0x3c928, 0xeeee, 0xc, 0xc4c4, 0x0, 0x3f800000, 0x0, 0x3f800000, 0x40d0, 0x103d0, 0x1848, 0x0
.long 0x2e0, 0x32e0, 0x132e0, 0x2252c, 0x22680, 0x22f00, 0x20750, 0x20790, 0x3c930, 0x4444, 0x14, 0x4444, 0x0, 0x0, 0x0, 0x0, 0x40e0, 0x103e0, 0x1c08, 0x0
.long 0x2f0, 0x32f0, 0x132f0, 0x2253c, 0x22790, 0x23010, 0x20860, 0x20790, 0x3c938, 0xeeee, 0x1c, 0x4444, 0x0, 0x0, 0x0, 0x0, 0x40f0, 0x103f0, 0x1c48, 0x0
.long 0x300, 0x3300, 0x13300, 0x2266c, 0x22030, 0x228b0, 0x200d8, 0x20030, 0x34980, 0x4444, 0x24, 0x4c4c, 0x3f80, 0x0, 0x3f80, 0x0, 0x24000, 0x18300, 0xc, 0x0
.long 0x310, 0x3310, 0x13310, 0x2267c, 0x22140, 0x229c0, 0x201e8, 0x20030, 0x34988, 0xeeee, 0x2c, 0x4d4d, 0x3f80, 0x0, 0x3f80, 0x0, 0x24010, 0x18310, 0x4c, 0x0
.long 0x320, 0x3320, 0x13320, 0x2268c, 0x22250, 0x228b0, 0x202f8, 0x20140, 0x34990, 0x4444, 0x34, 0x4444, 0x0, 0x0, 0x0, 0x0, 0x24020, 0x18320, 0x40c, 0x0
.long 0x330, 0x3330, 0x13330, 0x2269c, 0x22360, 0x229c0, 0x20408, 0x20140, 0x34998, 0xeeee, 0x3c, 0x4444, 0x0, 0x0, 0x0, 0x0, 0x24030, 0x18330, 0x44c, 0x0
.long 0x340, 0x3340, 0x13340, 0x226ac, 0x22470, 0x22ad0, 0x20518, 0x20250, 0x349a0, 0x4444, 0x24, 0x4e4e, 0x3f80, 0x0, 0x3f80, 0x0, 0x24040, 0x18340, 0x80c, 0x0
.long 0x350, 0x3350, 0x13350, 0x226bc, 0x22580, 0x22be0, 0x20628, 0x20250, 0x349a8, 0xeeee, 0x2c, 0x4c4c, 0x3f800000, 0x0, 0x3f800000, 0x0, 0x24050, 0x18350, 0x84c, 0x0
.long 0x360, 0x3360, 0x13360, 0x226cc, 0x22690, 0x22ad0, 0x20738, 0x20360, 0x349b0, 0x4444, 0x34, 0x4444, 0x0, 0x0, 0x0, 0x0, 0x24060, 0x18360, 0xc0c, 0x0
.long 0x370, 0x3370, 0x13370, 0x226dc, 0x227a0, 0x22be0, 0x20848, 0x20360, 0x349b8, 0xeeee, 0x3c, 0x4444, 0x0, 0x0, 0x0, 0x0, 0x24070, 0x18370, 0xc4c, 0x0
.long 0x380, 0x3380, 0x13380, 0x226ec, 0x22030, 0x22cf0, 0x200f8, 0x20470, 0x3d180, 0x4444, 0x24, 0xc4c4, 0x0, 0x3f80, 0x0, 0x3f80, 0x24080, 0x18380, 0x100c, 0x0
.long 0x390, 0x3390, 0x13390, 0x226fc, 0x22140, 0x22e00, 0x20208, 0x20470, 0x3d188, 0xeeee, 0x2c, 0xd4d4, 0x0, 0x3f80, 0x0, 0x3f80, 0x24090, 0x18390, 0x104c, 0x0
.long 0x3a0, 0x33a0, 0x133a0, 0x2270c, 0x22250, 0x22cf0, 0x20318, 0x20580, 0x3d190, 0x4444, 0x34, 0x4444, 0x0, 0x0, 0x0, 0x0, 0x240a0, 0x183a0, 0x140c, 0x0
.long 0x3b0, 0x33b0, 0x133b0, 0x2271c, 0x22360, 0x22e00, 0x20428, 0x20580, 0x3d198, 0xeeee, 0x3c, 0x4444, 0x0, 0x0, 0x0, 0x0, 0x240b0, 0x183b0, 0x144c, 0x0
.long 0x3c0, 0x33c0, 0x133c0, 0x2272c, 0x22470, 0x22f10, 0x20538, 0x20690, 0x3d1a0, 0x4444, 0x24, 0xe4e4, 0x0, 0x3f80, 0x0, 0x3f80, 0x240c0, 0x183c0, 0x180c, 0x0
.long 0x3d0, 0x33d0, 0x133d0, 0x2273c, 0x22580, 0x23020, 0x20648, 0x20690, 0x3d1a8, 0xeeee, 0x2c, 0xc4c4, 0x0, 0x3f800000, 0x0, 0x3f800000, 0x240d0, 0x183d0, 0x184c, 0x0
.long 0x3e0, 0x33e0, 0x133e0, 0x2274c, 0x22690, 0x22f10, 0x20758, 0x207a0, 0x3d1b0, 0x4444, 0x34, 0x4444, 0x0, 0x0, 0x0, 0x0, 0x240e0, 0x183e0, 0x1c0c, 0x0
.long 0x3f0, 0x33f0, 0x133f0, 0x2275c, 0x227a0, 0x23020, 0x20868, 0x207a0, 0x3d1b8, 0xeeee, 0x3c, 0x4444, 0x0, 0x0, 0x0, 0x0, 0x240f0, 0x183f0, 0x1c4c, 0x0
.section .rodata,"a"
.p2align 6
.amdhsa_kernel gated_mix__memory_aug_recurrent_mem_tr__sliding_local_dilated__prompt_kernel
  .amdhsa_next_free_vgpr 512
  .amdhsa_next_free_sgpr 102
  .amdhsa_accum_offset 256
  .amdhsa_group_segment_fixed_size 0
  .amdhsa_kernarg_size 112
  .amdhsa_user_sgpr_count 2
  .amdhsa_user_sgpr_kernarg_segment_ptr 1
  .amdhsa_system_sgpr_workgroup_id_x 1
.end_amdhsa_kernel
```
